```python
import torch

def _softmax(x, axis=-1):
    return torch.softmax(x, dim=axis)
def _gelu(x):
    return torch.nn.functional.gelu(x, approximate="tanh")
def _silu(x):
    return torch.nn.functional.silu(x)
def _sigmoid(x):
    return torch.sigmoid(x)
def _layernorm(x, axis=-1, eps=1e-5):
    m = x.mean(dim=axis, keepdim=True)
    v = x.var(dim=axis, keepdim=True, unbiased=False)
    return (x - m) / torch.sqrt(v + eps)
def _scatter_add(tgt, idx, src, axis=0):
    return tgt.clone().index_add_(axis, idx, src)
def _segment_sum(src, seg, n):
    out = torch.zeros((n,) + src.shape[1:], dtype=src.dtype)
    return out.index_add_(0, seg, src)
def _pad(x, pw):
    flat = tuple(v for pair in reversed(pw) for v in pair)
    return torch.nn.functional.pad(x, flat)

kernel_name = 'recurrent_scan__linear_kernel_hedgehog__glu_gated_geglu__prompt'

def setup_inputs():

    _w = (lambda a: (lambda t: t.to(torch.bfloat16) if t.is_floating_point() else t)(torch.as_tensor(a)))
    def _A_setup():
        B, S, D, H = 1, 2048, 448, 16
        Dh = D // H
        return {
            "x": _w((lambda *s: torch.randn(*s, dtype=torch.bfloat16) * 0.05)(B, S, D)),
            "wqkv": _w((lambda *s: torch.randn(*s, dtype=torch.bfloat16) * 0.8)(D, 3 * D)),
            "w_phi": _w((lambda *s: torch.randn(*s, dtype=torch.bfloat16) * 0.8)(H, Dh, Dh) * (Dh ** -0.5)),
            "wo": _w((lambda *s: torch.randn(*s, dtype=torch.bfloat16) * 0.8)(D, D)),
        }
    _A_in = _A_setup()

    def _B_setup():
        B, S, Dm, Df = 1, 2048, 448, 1792
        return {
            "x": _w((lambda *s: torch.randn(*s, dtype=torch.bfloat16) * 0.05)(B, S, Dm)),
            "w_gate": _w((lambda *s: torch.randn(*s, dtype=torch.bfloat16) * 0.2)(Dm, Df) * (Dm ** -0.5)),
            "w_up": _w((lambda *s: torch.randn(*s, dtype=torch.bfloat16) * 0.2)(Dm, Df) * (Dm ** -0.5)),
            "w_down": _w((lambda *s: torch.randn(*s, dtype=torch.bfloat16) * 0.2)(Df, Dm) * (Df ** -0.5)),
        }
    _B_in = _B_setup()

    return {
        "A_x": _A_in["x"],
        "A_wqkv": _A_in["wqkv"],
        "A_w_phi": _A_in["w_phi"],
        "A_wo": _A_in["wo"],
        "B_x": _B_in["x"],
        "B_w_gate": _B_in["w_gate"],
        "B_w_up": _B_in["w_up"],
        "B_w_down": _B_in["w_down"],
    }

def reference(A_x, A_wqkv, A_w_phi, A_wo, B_x, B_w_gate, B_w_up, B_w_down):
    def _A_ref(x, wqkv, w_phi, wo):
        B, S, D = x.shape
        H = 16; Dh = D // H
        qkv = (lambda x, *d: x.permute(*d))((x @ wqkv).reshape(B, S, 3, H, Dh), 2, 0, 3, 1, 4)
        q, k, v = qkv[0], qkv[1], qkv[2]
        pq = torch.einsum("bhsd,hdf->bhsf", q, w_phi)
        pk = torch.einsum("bhsd,hdf->bhsf", k, w_phi)
        phi_q = torch.concatenate([_softmax(pq, axis=-1), _softmax(-pq, axis=-1)], axis=-1)
        phi_k = torch.concatenate([_softmax(pk, axis=-1), _softmax(-pk, axis=-1)], axis=-1)
        kv = torch.einsum("bhsf,bhsd->bhfd", phi_k, v)
        z  = torch.einsum("bhsf->bhf", phi_k)
        num = torch.einsum("bhqf,bhfd->bhqd", phi_q, kv)
        den = torch.einsum("bhqf,bhf->bhq", phi_q, z)[..., None] + 1e-6
        o = num / den
        return (lambda x, *d: x.permute(*d))(o, 0, 2, 1, 3).reshape(B, S, D) @ wo

    def _B_ref(x, w_gate, w_up, w_down):
        g = torch.einsum("bsd,df->bsf", x, w_gate)
        u = torch.einsum("bsd,df->bsf", x, w_up)
        h = _gelu(g) * u
        return torch.einsum("bsf,fd->bsd", h, w_down)

    x = A_x
    xn = _layernorm(x, axis=-1)
    s = _A_ref(xn, A_wqkv, A_w_phi, A_wo)
    g = _silu(_B_ref(xn, B_w_gate, B_w_up, B_w_down))
    return x + s * g
```

```asm
; @launch grid=(256,1,1) block=(512,1,1) lds=163840
.amdgcn_target "amdgcn-amd-amdhsa--gfx950"
.text
.globl recurrent_scan__linear_kernel_hedgehog__glu_gated_geglu__prompt_kernel
.p2align 8
.type recurrent_scan__linear_kernel_hedgehog__glu_gated_geglu__prompt_kernel,@function
recurrent_scan__linear_kernel_hedgehog__glu_gated_geglu__prompt_kernel:
L_start:
    s_cmp_ge_u32 s2, 256
    s_cbranch_scc1 L_end
    s_load_dwordx16 s[48:63], s[0:1], 0
    s_load_dwordx4 s[64:67], s[0:1], 64
    s_load_dwordx2 s[68:69], s[0:1], 80
    s_memrealtime s[44:45]
    s_setprio 3
    v_lshrrev_b32 v21, 6, v0
    v_and_b32_e64 v0, 63, v0
    v_readfirstlane_b32 s3, v21
    s_and_b32 s42, s2, 1
    s_cmp_lg_u32 s3, 7
    s_cbranch_scc1 L_ct1
    s_getpc_b64 s[80:81]
L_pc:
    s_sub_u32 s80, s80, L_pc-L_start
    s_subb_u32 s81, s81, 0
    s_lshr_b32 s82, s2, 3
    v_and_b32_e64 v21, 15, v0
    v_lshl_add_u32 v21, s82, 4, v21
    v_lshlrev_b32_e64 v21, 7, v21
    v_min_u32 v21, L_end-L_start, v21
    global_load_dword v20, v21, s[80:81]
L_ct1:
    s_bfe_u32 s6, s2, 0x20001
    s_lshl_b32 s6, s6, 2
    s_bfe_u32 s80, s2, 0x20003
    s_add_u32 s6, s6, s80
    s_lshr_b32 s7, s2, 5
    v_lshrrev_b32 v21, 3, v0
    v_mul_u32_u24 v1, 896, v21
    v_and_b32_e64 v22, 7, v0
    v_lshl_add_u32 v1, v22, 4, v1
    s_add_u32 s81, s3, s7
    s_and_b32 s81, s81, 7
    s_lshl_b32 s81, s81, 1
    s_and_b32 s80, s7, 1
    s_add_u32 s81, s81, s80
    s_lshl_b32 s96, s81, 3
    s_lshl_b32 s90, s6, 7
    s_add_u32 s90, s90, s96
    s_xor_b32 s91, s90, 8
    s_mul_i32 s90, s90, 896
    s_mul_i32 s91, s91, 896
    s_mov_b32 s10, 1835008
    s_mov_b32 s11, 0x20000
    s_cmp_ge_u32 s3, 4
    s_cbranch_scc1 L_e2
    s_waitcnt lgkmcnt(0)
    s_mov_b32 s8, s48
    s_mov_b32 s9, s49
    buffer_load_dwordx4 v[144:147], v1, s[8:11], s90 offen offset:0
    buffer_load_dwordx4 v[148:151], v1, s[8:11], s90 offen offset:128
    buffer_load_dwordx4 v[152:155], v1, s[8:11], s90 offen offset:256
    buffer_load_dwordx4 v[156:159], v1, s[8:11], s90 offen offset:384
    buffer_load_dwordx4 v[160:163], v1, s[8:11], s90 offen offset:512
    buffer_load_dwordx4 v[164:167], v1, s[8:11], s90 offen offset:640
    buffer_load_dwordx4 v[168:171], v1, s[8:11], s90 offen offset:768
L_e2:
    s_add_u32 s80, s7, 1
    s_and_b32 s80, s80, 7
    s_lshl_b32 s43, s42, 3
    s_add_u32 s43, s43, s80
    s_and_b32 s47, s43, 1
    s_lshl_b32 s47, s47, 3
    s_waitcnt lgkmcnt(0)
    s_mov_b32 s8, s48
    s_mov_b32 s9, s49
    s_mov_b32 s40, s66
    s_mov_b32 s41, s67
    s_mov_b32 s32, s64
    s_mov_b32 s33, s65
    s_mov_b32 s34, 1835008
    s_mov_b32 s35, 0x20000
    s_cmp_ge_u32 s3, 4
    s_cbranch_scc1 L_proB
    s_or_b32 s80, s2, s3
    s_cbranch_scc0 L_rare3
L_back4:
    s_mov_b32 s12, s50
    s_mov_b32 s13, s51
    s_mov_b32 s14, 1204224
    s_mov_b32 s15, 0x20000
    s_and_b32 s80, s3, 2
    s_lshl_b32 s80, s80, 3
    s_mul_i32 s81, s6, 28
    s_add_u32 s80, s80, s81
    v_lshrrev_b32 v40, 2, v0
    v_add_u32 v40, s80, v40
    v_and_b32 v41, 3, v0
    v_lshlrev_b32_e64 v41, 4, v41
    v_mul_u32_u24 v42, 2688, v40
    v_add_u32 v42, v42, v41
    s_and_b32 s92, s3, 1
    s_mul_i32 s80, s92, 896
    s_mul_i32 s81, s43, 56
    s_add_u32 s80, s80, s81
    s_add_u32 s80, s80, 896
    s_sub_u32 s80, s80, s47
    s_cmp_ge_u32 s3, 2
    s_cselect_b32 exec_hi, 0xffff, -1
    buffer_load_dwordx4 v[36:39], v42, s[12:15], s80 offen
    s_mov_b32 exec_hi, -1
    s_mov_b32 s76, 0x3f803f80
    v_mov_b32 v4, 0
    v_mov_b32_e64 v73, 0
    v_bfe_u32 v21, v0, 2, 2
    v_lshrrev_b32 v22, 4, v0
    v_cmp_eq_u32 vcc, v21, v22
    v_mov_b32 v21, s76
    v_mov_b32 v24, 0
    v_cndmask_b32 v30, 0, v21, vcc
    v_and_b32 v22, 1, v0
    v_lshlrev_b32_e64 v22, 4, v22
    v_mov_b32 v21, 0xffff
    v_lshlrev_b32 v21, v22, v21
    v_and_b32 v21, v21, v30
    v_and_b32 v22, 2, v0
    v_cmp_eq_u32 vcc, 0, v22
    v_mov_b32 v25, 0
    v_mov_b32_e64 v28, 0
    v_cndmask_b32 v26, 0, v21, vcc
    v_cndmask_b32 v27, v21, 0, vcc
    v_mov_b32 v29, 0
    v_mov_b32 v31, v30
    v_mov_b32 v32, v30
    v_mov_b32 v33, v30
    v_lshrrev_b32 v21, 3, v0
    v_add_u32 v21, s96, v21
    v_bfe_u32 v22, v21, 1, 3
    v_and_b32 v23, 7, v0
    v_xor_b32 v22, v22, v23
    v_lshlrev_b32_e64 v22, 4, v22
    v_lshl_add_u32 v88, v21, 7, v22
    v_xor_b32 v89, 0x440, v88
    v_add_u32 v90, 0x10000, v88
    v_add_u32 v91, 0x10000, v89
    s_mov_b32 s80, 155648
    v_lshl_add_u32 v92, v21, 2, s80
    s_mov_b32 s80, 156160
    v_lshl_add_u32 v93, v21, 1, s80
    v_xor_b32 v94, 32, v92
    v_xor_b32 v95, 16, v93
    v_lshrrev_b32_e64 v43, 6, v40
    v_lshl_add_u32 v43, v43, 12, v41
    v_lshl_add_u32 v43, v40, 6, v43
    v_mov_b32_e64 v40, 0
    s_lshl_b32 s92, s92, 12
    s_lshl_b32 s96, s43, 4
    s_add_u32 s96, s96, s6
    s_lshl_b32 s96, s96, 4
    s_add_u32 s96, s96, s3
    s_lshl_b32 s96, s96, 3
    s_add_u32 s96, s96, 16908288
    s_mov_b32 s16, s52
    s_mov_b32 s17, s53
    s_mov_b32 s18, 25088
    s_mov_b32 s19, 0x20000
    s_mov_b32 s36, s68
    s_mov_b32 s37, s69
    s_mov_b32 s38, 18874368
    s_mov_b32 s39, 0x20000
    s_lshr_b32 s82, s3, 2
    s_lshr_b32 s4, s3, 1
    s_xor_b32 s4, s4, s82
    s_and_b32 s4, s4, 1
    s_xor_b32 s5, s82, s42
    s_xor_b32 s5, s5, 1
    s_lshl_b32 s5, s5, 1
    s_and_b32 s80, s3, 1
    s_add_u32 s5, s5, s80
    s_lshl_b32 s46, s3, 10
    s_and_b32 s100, s46, 0xfff
    v_lshlrev_b32 v14, 4, v0
    v_and_b32 v21, 31, v0
    s_lshl_b32 s80, s5, 5
    v_add_u32 v21, s80, v21
    v_bfe_u32 v22, v0, 1, 3
    v_lshrrev_b32 v23, 5, v0
    v_xor_b32 v22, v22, v23
    v_lshlrev_b32_e64 v22, 4, v22
    v_lshl_add_u32 v60, v21, 7, v22
    v_xor_b32 v61, 32, v60
    v_xor_b32 v62, 64, v60
    v_xor_b32 v63, 0x60, v60
    v_xor_b32 v64, 0x10000, v60
    v_xor_b32 v65, 0x10020, v60
    v_xor_b32 v66, 0x10040, v60
    v_xor_b32 v67, 0x10060, v60
    s_mov_b32 s80, 155648
    v_lshl_add_u32 v68, v21, 2, s80
    v_mov_b32 v74, 156416
    s_mov_b32 s27, 0x20000
    v_bfe_u32 v77, v0, 2, 2
    v_lshl_add_u32 v76, v23, 3, v77
    v_lshlrev_b32_e64 v76, 7, v76
    v_bfe_u32 v77, v0, 4, 1
    v_and_b32 v78, 3, v0
    v_and_b32 v79, 8, v0
    v_lshlrev_b32 v79, 3, v79
    v_lshlrev_b32 v80, 2, v77
    v_and_b32 v81, 7, v0
    v_xor_b32 v80, v80, v81
    v_lshrrev_b32 v81, 3, v0
    s_and_b32 s81, s3, 1
    s_lshl_b32 s81, s81, 3
    v_add_u32 v81, s81, v81
    s_and_b32 s81, s3, 2
    s_cmp_eq_u32 s81, 0
    s_cselect_b32 s24, s58, s60
    s_cselect_b32 s25, s59, s61
    s_mov_b32 s26, 1605632
    s_mov_b32 s71, 114688
    v_xor_b32_e64 v83, s81, v80
    v_mul_u32_u24 v2, 3584, v81
    s_mul_i32 s101, s42, 1792
    s_lshl_b32 s80, s7, 8
    s_add_u32 s101, s101, s80
    s_add_u32 s72, s101, 128
    s_mov_b32 s95, s101
    s_mov_b32 s93, s43
    s_mov_b32 s94, 2
    v_mul_u32_u24 v82, 0x820, v77
    v_lshl_add_u32 v82, v78, 3, v82
    s_lshl_b32 s80, s4, 6
    v_xor_b32_e64 v84, s80, v79
    v_add3_u32 v5, v82, v84, v76
    v_xor_b32_e64 v6, 32, v5
    s_cmp_eq_u32 s7, 7
    s_cbranch_scc1 L_rare5
L_back6:
    v_lshl_add_u32 v2, v83, 4, v2
    v_add_u32 v7, 0x10000, v5
    v_add_u32 v8, 0x10000, v6
    v_add_u32 v9, 0x20000, v5
    v_add_u32 v10, 0x20000, v6
    s_lshr_b32 s70, s71, 1
    s_mul_i32 s70, s70, s82
    s_add_u32 s70, s70, s101
    s_sub_u32 s70, s70, s71
    s_mul_i32 s93, s93, 1568
    s_add_u32 s93, s93, s46
    s_mul_i32 s73, s43, 57344
    s_add_u32 s73, s73, 7340032
    s_mov_b32 s20, s54
    s_mov_b32 s21, s55
    s_mov_b32 s22, 401408
    s_mov_b32 s23, 0x20000
    s_mov_b32 s28, s62
    s_mov_b32 s29, s63
    s_nop 0
    s_mov_b32 s30, 1605632
    s_mov_b32 s31, 0x20000
    buffer_load_dwordx4 v[172:175], v1, s[8:11], s91 offen offset:0
    buffer_load_dwordx4 v[176:179], v1, s[8:11], s91 offen offset:128
    buffer_load_dwordx4 v[180:183], v1, s[8:11], s91 offen offset:256
    buffer_load_dwordx4 v[184:187], v1, s[8:11], s91 offen offset:384
    buffer_load_dwordx4 v[188:191], v1, s[8:11], s91 offen offset:512
    buffer_load_dwordx4 v[192:195], v1, s[8:11], s91 offen offset:640
    buffer_load_dwordx4 v[196:199], v1, s[8:11], s91 offen offset:768
    s_waitcnt vmcnt(14)
    v_mfma_f32_16x16x32_bf16 v[112:115], v[30:33], v[144:147], 0
    v_dot2_f32_bf16 v96, v144, v144, 0
    v_dot2_f32_bf16 v97, v145, v145, 0
    v_dot2_f32_bf16 v96, v146, v146, v96
    v_dot2_f32_bf16 v97, v147, v147, v97
    s_waitcnt vmcnt(13)
    v_mfma_f32_16x16x32_bf16 v[112:115], v[30:33], v[148:151], v[112:115]
    v_dot2_f32_bf16 v96, v148, v148, v96
    v_dot2_f32_bf16 v97, v149, v149, v97
    v_dot2_f32_bf16 v96, v150, v150, v96
    v_dot2_f32_bf16 v97, v151, v151, v97
    s_waitcnt vmcnt(12)
    v_mfma_f32_16x16x32_bf16 v[112:115], v[30:33], v[152:155], v[112:115]
    v_dot2_f32_bf16 v96, v152, v152, v96
    v_dot2_f32_bf16 v97, v153, v153, v97
    v_dot2_f32_bf16 v96, v154, v154, v96
    v_dot2_f32_bf16 v97, v155, v155, v97
    s_waitcnt vmcnt(11)
    v_mfma_f32_16x16x32_bf16 v[112:115], v[30:33], v[156:159], v[112:115]
    v_dot2_f32_bf16 v96, v156, v156, v96
    v_dot2_f32_bf16 v97, v157, v157, v97
    v_dot2_f32_bf16 v96, v158, v158, v96
    v_dot2_f32_bf16 v97, v159, v159, v97
    s_waitcnt vmcnt(10)
    v_mfma_f32_16x16x32_bf16 v[112:115], v[30:33], v[160:163], v[112:115]
    v_dot2_f32_bf16 v96, v160, v160, v96
    v_dot2_f32_bf16 v97, v161, v161, v97
    v_dot2_f32_bf16 v96, v162, v162, v96
    v_dot2_f32_bf16 v97, v163, v163, v97
    s_waitcnt vmcnt(9)
    v_mfma_f32_16x16x32_bf16 v[112:115], v[30:33], v[164:167], v[112:115]
    v_dot2_f32_bf16 v96, v164, v164, v96
    v_dot2_f32_bf16 v97, v165, v165, v97
    v_dot2_f32_bf16 v96, v166, v166, v96
    v_dot2_f32_bf16 v97, v167, v167, v97
    s_waitcnt vmcnt(8)
    v_mfma_f32_16x16x32_bf16 v[112:115], v[30:33], v[168:171], v[112:115]
    v_dot2_f32_bf16 v96, v168, v168, v96
    v_dot2_f32_bf16 v97, v169, v169, v97
    v_dot2_f32_bf16 v96, v170, v170, v96
    v_dot2_f32_bf16 v97, v171, v171, v97
    s_nop 2
    v_add_f32_e64 v96, v96, v97
    v_add_f32_dpp v112, v112, v112 quad_perm:[1,0,3,2] row_mask:0xf bank_mask:0xf
    s_nop 0
    v_add_f32_dpp v96, v96, v96 quad_perm:[1,0,3,2] row_mask:0xf bank_mask:0xf
    v_add_f32_dpp v112, v112, v112 quad_perm:[2,3,0,1] row_mask:0xf bank_mask:0xf
    s_nop 0
    v_add_f32_dpp v96, v96, v96 quad_perm:[2,3,0,1] row_mask:0xf bank_mask:0xf
    v_add_f32_dpp v112, v112, v112 row_half_mirror row_mask:0xf bank_mask:0xf
    s_nop 0
    s_nop 0
    v_add_f32_dpp v96, v96, v96 row_half_mirror row_mask:0xf bank_mask:0xf
    v_mul_f32 v112, 0xbb124925, v112
    v_cvt_pk_bf16_f32 v116, 0, v112
    v_cvt_pk_bf16_f32 v117, 0, v112
    v_cvt_pk_bf16_f32 v118, 0, v112
    v_cvt_pk_bf16_f32 v119, 0, v112
    v_mul_f32 v96, 0x3b124925, v96
    s_nop 0
    s_nop 0
    v_mfma_f32_16x16x32_bf16 v[120:123], v[26:29], v[144:147], v[116:119]
    v_mfma_f32_16x16x32_bf16 v[124:127], v[24:27], v[144:147], v[116:119]
    v_mfma_f32_16x16x32_bf16 v[128:131], v[26:29], v[148:151], v[116:119]
    v_mfma_f32_16x16x32_bf16 v[132:135], v[24:27], v[148:151], v[116:119]
    v_mfma_f32_16x16x32_bf16 v[136:139], v[26:29], v[152:155], v[116:119]
    v_mfma_f32_16x16x32_bf16 v[140:143], v[24:27], v[152:155], v[116:119]
    v_fma_f32 v96, -v112, v112, v96
    s_nop 1
    s_nop 0
    v_cvt_pk_bf16_f32 v144, v120, v121
    v_cvt_pk_bf16_f32 v145, v122, v123
    v_cvt_pk_bf16_f32 v146, v124, v125
    v_cvt_pk_bf16_f32 v147, v126, v127
    ds_write_b128 v88, v[144:147] offset:0
    v_mfma_f32_16x16x32_bf16 v[120:123], v[26:29], v[156:159], v[116:119]
    v_mfma_f32_16x16x32_bf16 v[124:127], v[24:27], v[156:159], v[116:119]
    v_max_f32_e64 v96, 0, v96
    v_cvt_pk_bf16_f32 v148, v128, v129
    v_cvt_pk_bf16_f32 v149, v130, v131
    v_cvt_pk_bf16_f32 v150, v132, v133
    v_cvt_pk_bf16_f32 v151, v134, v135
    ds_write_b128 v88, v[148:151] offset:16384
    v_mfma_f32_16x16x32_bf16 v[128:131], v[26:29], v[160:163], v[116:119]
    v_mfma_f32_16x16x32_bf16 v[132:135], v[24:27], v[160:163], v[116:119]
    v_cvt_pk_bf16_f32 v96, 0, v96
    v_cvt_pk_bf16_f32 v152, v136, v137
    v_cvt_pk_bf16_f32 v153, v138, v139
    v_cvt_pk_bf16_f32 v154, v140, v141
    v_cvt_pk_bf16_f32 v155, v142, v143
    ds_write_b128 v88, v[152:155] offset:32768
    v_mfma_f32_16x16x32_bf16 v[136:139], v[26:29], v[164:167], v[116:119]
    v_mfma_f32_16x16x32_bf16 v[140:143], v[24:27], v[164:167], v[116:119]
    v_add_f32 v96, 0x3727c5ac, v96
    v_cvt_pk_bf16_f32 v156, v120, v121
    v_cvt_pk_bf16_f32 v157, v122, v123
    v_cvt_pk_bf16_f32 v158, v124, v125
    v_cvt_pk_bf16_f32 v159, v126, v127
    ds_write_b128 v88, v[156:159] offset:49152
    v_mfma_f32_16x16x32_bf16 v[120:123], v[26:29], v[168:171], v[116:119]
    v_mfma_f32_16x16x32_bf16 v[124:127], v[24:27], v[168:171], v[116:119]
    v_cvt_pk_bf16_f32 v96, 0, v96
    v_cvt_pk_bf16_f32 v160, v128, v129
    v_cvt_pk_bf16_f32 v161, v130, v131
    v_cvt_pk_bf16_f32 v162, v132, v133
    v_cvt_pk_bf16_f32 v163, v134, v135
    ds_write_b128 v90, v[160:163] offset:0
    v_sqrt_f32_e64 v96, v96
    v_cvt_pk_bf16_f32 v164, v136, v137
    v_cvt_pk_bf16_f32 v165, v138, v139
    v_cvt_pk_bf16_f32 v166, v140, v141
    v_cvt_pk_bf16_f32 v167, v142, v143
    ds_write_b128 v90, v[164:167] offset:16384
    v_cvt_pk_bf16_f32 v96, 0, v96
    v_cvt_pk_bf16_f32 v168, v120, v121
    v_cvt_pk_bf16_f32 v169, v122, v123
    v_cvt_pk_bf16_f32 v170, v124, v125
    v_cvt_pk_bf16_f32 v171, v126, v127
    ds_write_b128 v90, v[168:171] offset:32768
    ds_write_b32 v92, v96
    ds_write_b16_d16_hi v93, v96
    s_add_u32 s92, s92, s73
    s_add_u32 s73, s73, s100
    s_cmp_ge_u32 s3, 2
    s_cselect_b32 exec_hi, 0xffff, -1
    s_waitcnt vmcnt(7)
    buffer_store_dwordx4 v[36:39], v43, s[36:39], s92 offen sc1
    s_mov_b32 exec_hi, -1
    global_load_dwordx2 v[44:45], v40, s[40:41] sc1
    s_waitcnt vmcnt(8)
    v_mfma_f32_16x16x32_bf16 v[112:115], v[30:33], v[172:175], 0
    v_dot2_f32_bf16 v96, v172, v172, 0
    v_dot2_f32_bf16 v97, v173, v173, 0
    v_dot2_f32_bf16 v96, v174, v174, v96
    v_dot2_f32_bf16 v97, v175, v175, v97
    s_waitcnt vmcnt(7)
    v_mfma_f32_16x16x32_bf16 v[112:115], v[30:33], v[176:179], v[112:115]
    v_dot2_f32_bf16 v96, v176, v176, v96
    v_dot2_f32_bf16 v97, v177, v177, v97
    v_dot2_f32_bf16 v96, v178, v178, v96
    v_dot2_f32_bf16 v97, v179, v179, v97
    s_waitcnt vmcnt(6)
    v_mfma_f32_16x16x32_bf16 v[112:115], v[30:33], v[180:183], v[112:115]
    v_dot2_f32_bf16 v96, v180, v180, v96
    v_dot2_f32_bf16 v97, v181, v181, v97
    v_dot2_f32_bf16 v96, v182, v182, v96
    v_dot2_f32_bf16 v97, v183, v183, v97
    s_waitcnt vmcnt(5)
    v_mfma_f32_16x16x32_bf16 v[112:115], v[30:33], v[184:187], v[112:115]
    v_dot2_f32_bf16 v96, v184, v184, v96
    v_dot2_f32_bf16 v97, v185, v185, v97
    v_dot2_f32_bf16 v96, v186, v186, v96
    v_dot2_f32_bf16 v97, v187, v187, v97
    s_waitcnt vmcnt(4)
    v_mfma_f32_16x16x32_bf16 v[112:115], v[30:33], v[188:191], v[112:115]
    v_dot2_f32_bf16 v96, v188, v188, v96
    v_dot2_f32_bf16 v97, v189, v189, v97
    v_dot2_f32_bf16 v96, v190, v190, v96
    v_dot2_f32_bf16 v97, v191, v191, v97
    s_waitcnt vmcnt(3)
    v_mfma_f32_16x16x32_bf16 v[112:115], v[30:33], v[192:195], v[112:115]
    v_dot2_f32_bf16 v96, v192, v192, v96
    v_dot2_f32_bf16 v97, v193, v193, v97
    v_dot2_f32_bf16 v96, v194, v194, v96
    v_dot2_f32_bf16 v97, v195, v195, v97
    s_waitcnt vmcnt(2)
    v_mfma_f32_16x16x32_bf16 v[112:115], v[30:33], v[196:199], v[112:115]
    v_dot2_f32_bf16 v96, v196, v196, v96
    v_dot2_f32_bf16 v97, v197, v197, v97
    v_dot2_f32_bf16 v96, v198, v198, v96
    v_dot2_f32_bf16 v97, v199, v199, v97
    s_nop 2
    v_add_f32 v96, v96, v97
    v_add_f32_dpp v112, v112, v112 quad_perm:[1,0,3,2] row_mask:0xf bank_mask:0xf
    s_nop 0
    v_add_f32_dpp v96, v96, v96 quad_perm:[1,0,3,2] row_mask:0xf bank_mask:0xf
    v_add_f32_dpp v112, v112, v112 quad_perm:[2,3,0,1] row_mask:0xf bank_mask:0xf
    s_nop 0
    v_add_f32_dpp v96, v96, v96 quad_perm:[2,3,0,1] row_mask:0xf bank_mask:0xf
    v_add_f32_dpp v112, v112, v112 row_half_mirror row_mask:0xf bank_mask:0xf
    s_nop 0
    s_nop 0
    v_add_f32_dpp v96, v96, v96 row_half_mirror row_mask:0xf bank_mask:0xf
    v_mul_f32 v112, 0xbb124925, v112
    v_cvt_pk_bf16_f32 v116, 0, v112
    v_cvt_pk_bf16_f32 v117, 0, v112
    v_cvt_pk_bf16_f32 v118, 0, v112
    v_cvt_pk_bf16_f32 v119, 0, v112
    v_mul_f32 v96, 0x3b124925, v96
    s_nop 0
    s_nop 0
    v_mfma_f32_16x16x32_bf16 v[120:123], v[26:29], v[172:175], v[116:119]
    v_mfma_f32_16x16x32_bf16 v[124:127], v[24:27], v[172:175], v[116:119]
    v_mfma_f32_16x16x32_bf16 v[128:131], v[26:29], v[176:179], v[116:119]
    v_mfma_f32_16x16x32_bf16 v[132:135], v[24:27], v[176:179], v[116:119]
    v_mfma_f32_16x16x32_bf16 v[136:139], v[26:29], v[180:183], v[116:119]
    v_mfma_f32_16x16x32_bf16 v[140:143], v[24:27], v[180:183], v[116:119]
    v_fma_f32 v96, -v112, v112, v96
    s_nop 1
    s_nop 0
    v_cvt_pk_bf16_f32 v172, v120, v121
    v_cvt_pk_bf16_f32 v173, v122, v123
    v_cvt_pk_bf16_f32 v174, v124, v125
    v_cvt_pk_bf16_f32 v175, v126, v127
    ds_write_b128 v89, v[172:175] offset:0
    v_mfma_f32_16x16x32_bf16 v[120:123], v[26:29], v[184:187], v[116:119]
    v_mfma_f32_16x16x32_bf16 v[124:127], v[24:27], v[184:187], v[116:119]
    v_max_f32_e64 v96, 0, v96
    v_cvt_pk_bf16_f32 v176, v128, v129
    v_cvt_pk_bf16_f32 v177, v130, v131
    v_cvt_pk_bf16_f32 v178, v132, v133
    v_cvt_pk_bf16_f32 v179, v134, v135
    ds_write_b128 v89, v[176:179] offset:16384
    v_mfma_f32_16x16x32_bf16 v[128:131], v[26:29], v[188:191], v[116:119]
    v_mfma_f32_16x16x32_bf16 v[132:135], v[24:27], v[188:191], v[116:119]
    v_cvt_pk_bf16_f32 v96, 0, v96
    v_cvt_pk_bf16_f32 v180, v136, v137
    v_cvt_pk_bf16_f32 v181, v138, v139
    v_cvt_pk_bf16_f32 v182, v140, v141
    v_cvt_pk_bf16_f32 v183, v142, v143
    ds_write_b128 v89, v[180:183] offset:32768
    v_mfma_f32_16x16x32_bf16 v[136:139], v[26:29], v[192:195], v[116:119]
    v_mfma_f32_16x16x32_bf16 v[140:143], v[24:27], v[192:195], v[116:119]
    v_add_f32 v96, 0x3727c5ac, v96
    v_cvt_pk_bf16_f32 v184, v120, v121
    v_cvt_pk_bf16_f32 v185, v122, v123
    v_cvt_pk_bf16_f32 v186, v124, v125
    v_cvt_pk_bf16_f32 v187, v126, v127
    ds_write_b128 v89, v[184:187] offset:49152
    v_mfma_f32_16x16x32_bf16 v[120:123], v[26:29], v[196:199], v[116:119]
    v_mfma_f32_16x16x32_bf16 v[124:127], v[24:27], v[196:199], v[116:119]
    v_cvt_pk_bf16_f32 v96, 0, v96
    v_cvt_pk_bf16_f32 v188, v128, v129
    v_cvt_pk_bf16_f32 v189, v130, v131
    v_cvt_pk_bf16_f32 v190, v132, v133
    v_cvt_pk_bf16_f32 v191, v134, v135
    ds_write_b128 v91, v[188:191] offset:0
    v_sqrt_f32_e64 v96, v96
    v_cvt_pk_bf16_f32 v192, v136, v137
    v_cvt_pk_bf16_f32 v193, v138, v139
    v_cvt_pk_bf16_f32 v194, v140, v141
    v_cvt_pk_bf16_f32 v195, v142, v143
    ds_write_b128 v91, v[192:195] offset:16384
    v_cvt_pk_bf16_f32 v96, 0, v96
    v_cvt_pk_bf16_f32 v196, v120, v121
    v_cvt_pk_bf16_f32 v197, v122, v123
    v_cvt_pk_bf16_f32 v198, v124, v125
    v_cvt_pk_bf16_f32 v199, v126, v127
    s_waitcnt lgkmcnt(14)
    ds_write_b128 v91, v[196:199] offset:32768
    s_waitcnt lgkmcnt(14)
    ds_write_b32 v94, v96
    s_waitcnt lgkmcnt(14)
    ds_write_b16_d16_hi v95, v96
    s_waitcnt vmcnt(0)
    v_readfirstlane_b32 s44, v44
    v_readfirstlane_b32 s45, v45
    s_cmp_eq_u32 s45, 0
    s_cbranch_scc1 L_rare7
L_back8:
    s_mov_b64 exec, 1
    buffer_store_dwordx2 v[44:45], off, s[36:39], s96 sc1
    s_waitcnt lgkmcnt(14)
    ds_write_b64 v74, v[44:45]
    s_mov_b64 exec, -1
    s_setprio 0
    s_add_u32 m0, s46, 114688
    s_add_u32 s70, s70, s71
    buffer_load_dwordx4 v2, s[24:27], s70 offen lds
    s_add_u32 m0, s46, 122880
    s_add_u32 s70, s70, s71
    buffer_load_dwordx4 v2, s[24:27], s70 offen lds
    s_add_u32 m0, s46, 131072
    s_add_u32 s70, s70, s71
    buffer_load_dwordx4 v2, s[24:27], s70 offen lds
    s_add_u32 m0, s46, 139264
    s_add_u32 s70, s70, s71
    buffer_load_dwordx4 v2, s[24:27], s70 offen lds
    s_add_u32 m0, s46, 147456
    s_add_u32 s70, s70, s71
    buffer_load_dwordx4 v2, s[24:27], s70 offen lds
    s_lshr_b32 s80, s71, 5
    v_min_u32 v21, 27, v0
    s_mul_i32 s81, s6, 28
    v_add_u32_e64 v21, s81, v21
    v_mul_lo_u32 v21, v21, s80
    s_and_b32 s80, s3, 1
    s_lshl_b32 s80, s80, 7
    s_add_u32 s95, s95, s80
    s_mov_b32 exec_hi, 0
    buffer_load_dword v20, v21, s[24:27], s95 offen
    s_mov_b32 exec_hi, -1
    s_mov_b32 s68, 0
    s_mov_b32 s69, -1
    s_lshl_b32 s75, s6, 1
    s_add_u32 s75, s75, s42
    s_lshl_b32 s75, s75, 3
    s_add_u32 s75, s75, s7
    v_lshrrev_b32 v76, 5, v0
    v_bfe_u32 v77, v0, 2, 2
    v_bfe_u32 v78, v0, 4, 1
    v_and_b32_e64 v79, 3, v0
    v_lshl_add_u32 v78, v78, 2, v79
    v_min_u32 v78, 6, v78
    v_lshlrev_b32 v78, 3, v78
    v_lshl_add_u32 v79, v76, 3, v77
    v_lshl_add_u32 v12, v79, 6, v78
    s_lshl_b32 s80, s4, 12
    s_add_u32 s80, s80, s47
    v_add_u32_e64 v12, s80, v12
    v_lshl_add_u32 v79, v76, 2, v77
    v_mul_u32_u24 v79, 56, v79
    v_add_u32 v3, v79, v78
    v_and_b32_e64 v76, 31, v0
    v_bfe_u32 v77, v0, 1, 1
    v_bfe_u32 v78, v0, 2, 2
    v_lshl_or_b32 v77, v77, 2, v78
    v_lshlrev_b32_e64 v77, 4, v77
    v_lshl_add_u32 v76, v76, 7, v77
    v_lshrrev_b32_e64 v77, 5, v0
    v_lshl_add_u32 v76, v77, 3, v76
    s_lshl_b32 s81, s5, 12
    s_add_u32 s81, s81, 0
    v_add_u32_e64 v76, s81, v76
    v_add_u32 v75, 156672, v3
    v_xor_b32 v77, 16, v76
    v_xor_b32 v78, 32, v76
    v_xor_b32 v79, 48, v76
    v_xor_b32 v80, 64, v76
    v_xor_b32 v81, 80, v76
    v_xor_b32 v82, 96, v76
    v_xor_b32 v83, 112, v76
    s_lshl_b32 s80, s6, 2
    s_add_u32 s80, s80, s5
    s_mul_i32 s80, s80, 112
    s_mul_i32 s81, s42, 56
    s_add_u32 s80, s80, s81
    s_lshl_b32 s81, s4, 1
    s_add_u32 s80, s80, s81
    s_lshl_b32 s77, s80, 10
    s_lshl_b32 s81, s7, 13
    s_add_u32 s74, s77, s81
    s_and_b32 s78, s75, 0xf8
    s_add_u32 s78, s78, s3
    s_lshl_b32 s78, s78, 7
    s_add_u32 s78, s78, 16973824
    v_and_b32 v21, 16, v0
    v_lshlrev_b32 v21, 2, v21
    v_xor_b32 v4, v21, v1
    s_mul_i32 s81, s100, 7
    v_add_u32 v4, s81, v4
    s_mul_i32 s81, s42, 802816
    s_lshl_b32 s67, s7, 7
    s_add_u32 s81, s81, s67
    s_and_b32 s82, s6, 3
    s_mul_i32 s82, s82, 3
    s_lshr_b32 s54, s82, 1
    s_add_u32 s82, s54, s7
    s_cmp_ge_u32 s82, 7
    s_cselect_b32 s83, 7, 0
    s_sub_u32 s82, s82, s83
    s_mul_i32 s83, s7, 114688
    s_add_u32 s61, s81, s83
    s_add_u32 s80, s7, 1
    s_cmp_eq_u32 s80, 7
    s_cselect_b32 s80, 0, s80
    s_add_u32 s82, s82, 1
    s_cmp_eq_u32 s82, 7
    s_cselect_b32 s82, 0, s82
    s_cmp_eq_u32 s82, s7
    s_cselect_b32 s82, s80, s82
    s_lshl_b32 s83, s82, 13
    s_add_u32 s48, s77, s83
    s_mul_i32 s83, s82, 114688
    s_add_u32 s55, s81, s83
    s_add_u32 s82, s82, 1
    s_cmp_eq_u32 s82, 7
    s_cselect_b32 s82, 0, s82
    s_cmp_eq_u32 s82, s7
    s_cselect_b32 s82, s80, s82
    s_lshl_b32 s83, s82, 13
    s_add_u32 s49, s77, s83
    s_mul_i32 s83, s82, 114688
    s_add_u32 s56, s81, s83
    s_add_u32 s82, s82, 1
    s_cmp_eq_u32 s82, 7
    s_cselect_b32 s82, 0, s82
    s_cmp_eq_u32 s82, s7
    s_cselect_b32 s82, s80, s82
    s_lshl_b32 s83, s82, 13
    s_add_u32 s50, s77, s83
    s_mul_i32 s83, s82, 114688
    s_add_u32 s57, s81, s83
    s_add_u32 s82, s82, 1
    s_cmp_eq_u32 s82, 7
    s_cselect_b32 s82, 0, s82
    s_cmp_eq_u32 s82, s7
    s_cselect_b32 s82, s80, s82
    s_lshl_b32 s83, s82, 13
    s_add_u32 s51, s77, s83
    s_mul_i32 s83, s82, 114688
    s_add_u32 s58, s81, s83
    s_add_u32 s82, s82, 1
    s_cmp_eq_u32 s82, 7
    s_cselect_b32 s82, 0, s82
    s_cmp_eq_u32 s82, s7
    s_cselect_b32 s82, s80, s82
    s_lshl_b32 s83, s82, 13
    s_add_u32 s52, s77, s83
    s_mul_i32 s83, s82, 114688
    s_add_u32 s59, s81, s83
    s_add_u32 s82, s82, 1
    s_cmp_eq_u32 s82, 7
    s_cselect_b32 s82, 0, s82
    s_cmp_eq_u32 s82, s7
    s_cselect_b32 s82, s80, s82
    s_lshl_b32 s83, s82, 13
    s_add_u32 s53, s77, s83
    s_mul_i32 s83, s82, 114688
    s_add_u32 s60, s81, s83
    s_and_b32 s81, s3, 1
    s_lshr_b32 s80, s75, 3
    s_lshl_b32 s80, s80, 1
    s_add_u32 s80, s80, s81
    s_mul_i32 s80, s80, 28672
    s_lshl_b32 s82, s7, 7
    s_add_u32 s80, s80, s82
    s_lshl_b32 s82, s4, 6
    s_add_u32 s80, s80, s82
    v_and_b32 v11, 31, v0
    v_mul_u32_u24 v11, 896, v11
    v_lshrrev_b32 v21, 5, v0
    v_lshlrev_b32 v21, 4, v21
    v_add3_u32 v11, v11, v21, s80
    s_waitcnt vmcnt(1)
    s_cmp_lt_u32 s3, s94
    s_cbranch_scc1 L_rare11
L_back12:
    s_cmp_eq_u32 s3, 3
    s_cbranch_scc1 L_rare13
L_back14:
    s_waitcnt lgkmcnt(0)
    s_barrier
    s_cmp_eq_u32 s7, 7
    s_cbranch_scc1 L_QA
    s_setprio 2
    ds_read_b128 v[144:147], v60 offset:0
    ds_read_b128 v[148:151], v61 offset:0
    ds_read_b64_tr_b16 v[88:89], v7 offset:49152
    ds_read_b64_tr_b16 v[90:91], v7 offset:49664
    ds_read_b64_tr_b16 v[92:93], v8 offset:49152
    ds_read_b64_tr_b16 v[94:95], v8 offset:49664
    ds_read_b128 v[152:155], v62 offset:0
    ds_read_b128 v[156:159], v63 offset:0
    ds_read_b64_tr_b16 v[96:97], v7 offset:53248
    ds_read_b64_tr_b16 v[98:99], v7 offset:53760
    ds_read_b64_tr_b16 v[100:101], v8 offset:53248
    ds_read_b64_tr_b16 v[102:103], v8 offset:53760
    ds_read_b64_tr_b16 v[104:105], v7 offset:57344
    ds_read_b64_tr_b16 v[106:107], v7 offset:57856
    s_waitcnt lgkmcnt(10)
    v_mfma_f32_32x32x16_bf16 v[112:127], v[88:91], v[144:147], 0
    ds_read_b64_tr_b16 v[108:109], v8 offset:57344
    ds_read_b64_tr_b16 v[110:111], v8 offset:57856
    s_waitcnt lgkmcnt(10)
    v_mfma_f32_32x32x16_bf16 v[128:143], v[92:95], v[144:147], 0
    ds_read_b128 v[160:163], v60 offset:16384
    ds_read_b128 v[164:167], v61 offset:16384
    ds_read_b128 v[168:171], v62 offset:16384
    ds_read_b64_tr_b16 v[88:89], v7 offset:61440
    ds_read_b64_tr_b16 v[90:91], v7 offset:61952
    s_waitcnt lgkmcnt(11)
    v_mfma_f32_32x32x16_bf16 v[112:127], v[96:99], v[148:151], v[112:127]
    ds_read_b64_tr_b16 v[92:93], v8 offset:61440
    ds_read_b64_tr_b16 v[94:95], v8 offset:61952
    s_waitcnt lgkmcnt(11)
    v_mfma_f32_32x32x16_bf16 v[128:143], v[100:103], v[148:151], v[128:143]
    ds_read_b128 v[172:175], v63 offset:16384
    ds_read_b128 v[176:179], v60 offset:32768
    ds_read_b128 v[180:183], v61 offset:32768
    ds_read_b64_tr_b16 v[96:97], v9 offset:0
    s_waitcnt lgkmcnt(14)
    ds_read_b64_tr_b16 v[98:99], v9 offset:512
    s_waitcnt lgkmcnt(14)
    v_mfma_f32_32x32x16_bf16 v[112:127], v[104:107], v[152:155], v[112:127]
    ds_read_b64_tr_b16 v[100:101], v10 offset:0
    s_waitcnt lgkmcnt(14)
    ds_read_b64_tr_b16 v[102:103], v10 offset:512
    s_waitcnt lgkmcnt(14)
    v_mfma_f32_32x32x16_bf16 v[128:143], v[108:111], v[152:155], v[128:143]
    ds_read_b128 v[184:187], v62 offset:32768
    s_waitcnt lgkmcnt(14)
    ds_read_b128 v[188:191], v63 offset:32768
    s_waitcnt lgkmcnt(14)
    ds_read_b128 v[192:195], v60 offset:49152
    s_waitcnt lgkmcnt(14)
    ds_read_b64_tr_b16 v[104:105], v9 offset:4096
    s_waitcnt lgkmcnt(14)
    ds_read_b64_tr_b16 v[106:107], v9 offset:4608
    s_waitcnt lgkmcnt(14)
    v_mfma_f32_32x32x16_bf16 v[112:127], v[88:91], v[156:159], v[112:127]
    ds_read_b64_tr_b16 v[108:109], v10 offset:4096
    s_waitcnt lgkmcnt(14)
    ds_read_b64_tr_b16 v[110:111], v10 offset:4608
    s_waitcnt lgkmcnt(14)
    v_mfma_f32_32x32x16_bf16 v[128:143], v[92:95], v[156:159], v[128:143]
    ds_read_b128 v[196:199], v61 offset:49152
    s_waitcnt lgkmcnt(14)
    ds_read_b128 v[200:203], v62 offset:49152
    s_waitcnt lgkmcnt(14)
    ds_read_b128 v[204:207], v63 offset:49152
    s_waitcnt lgkmcnt(14)
    ds_read_b64_tr_b16 v[88:89], v9 offset:8192
    s_waitcnt lgkmcnt(14)
    ds_read_b64_tr_b16 v[90:91], v9 offset:8704
    s_waitcnt lgkmcnt(14)
    v_mfma_f32_32x32x16_bf16 v[112:127], v[96:99], v[160:163], v[112:127]
    ds_read_b64_tr_b16 v[92:93], v10 offset:8192
    s_waitcnt lgkmcnt(14)
    ds_read_b64_tr_b16 v[94:95], v10 offset:8704
    s_waitcnt lgkmcnt(14)
    v_mfma_f32_32x32x16_bf16 v[128:143], v[100:103], v[160:163], v[128:143]
    s_waitcnt lgkmcnt(4)
    s_barrier
    ds_read_b128 v[208:211], v64 offset:0
    ds_read_b128 v[212:215], v65 offset:0
    ds_read_b64_tr_b16 v[96:97], v9 offset:12288
    ds_read_b64_tr_b16 v[98:99], v9 offset:12800
    v_mfma_f32_32x32x16_bf16 v[112:127], v[104:107], v[164:167], v[112:127]
    ds_read_b64_tr_b16 v[100:101], v10 offset:12288
    ds_read_b64_tr_b16 v[102:103], v10 offset:12800
    v_mfma_f32_32x32x16_bf16 v[128:143], v[108:111], v[164:167], v[128:143]
    ds_read_b128 v[216:219], v66 offset:0
    ds_read_b128 v[220:223], v67 offset:0
    ds_read_b64_tr_b16 v[104:105], v9 offset:16384
    ds_read_b64_tr_b16 v[106:107], v9 offset:16896
    s_waitcnt lgkmcnt(12)
    v_mfma_f32_32x32x16_bf16 v[112:127], v[88:91], v[168:171], v[112:127]
    ds_read_b64_tr_b16 v[108:109], v10 offset:16384
    ds_read_b64_tr_b16 v[110:111], v10 offset:16896
    s_waitcnt lgkmcnt(12)
    v_mfma_f32_32x32x16_bf16 v[128:143], v[92:95], v[168:171], v[128:143]
    ds_read_b128 v[224:227], v64 offset:16384
    ds_read_b128 v[228:231], v65 offset:16384
    s_add_u32 m0, s100, 40960
    s_add_u32 s80, s73, 40960
    buffer_load_dwordx4 v14, s[36:39], s80 offen sc1 lds
    ds_read_b64_tr_b16 v[88:89], v9 offset:20480
    s_waitcnt lgkmcnt(14)
    ds_read_b64_tr_b16 v[90:91], v9 offset:20992
    s_waitcnt lgkmcnt(12)
    v_mfma_f32_32x32x16_bf16 v[112:127], v[96:99], v[172:175], v[112:127]
    ds_read_b64_tr_b16 v[92:93], v10 offset:20480
    ds_read_b64_tr_b16 v[94:95], v10 offset:20992
    s_waitcnt lgkmcnt(12)
    s_nop 0
    v_mfma_f32_32x32x16_bf16 v[128:143], v[100:103], v[172:175], v[128:143]
    ds_read_b128 v[232:235], v66 offset:16384
    ds_read_b128 v[236:239], v67 offset:16384
    s_add_u32 m0, s100, 45056
    s_add_u32 s80, s73, 45056
    buffer_load_dwordx4 v14, s[36:39], s80 offen sc1 lds
    s_waitcnt lgkmcnt(10)
    v_mfma_f32_32x32x16_bf16 v[112:127], v[104:107], v[176:179], v[112:127]
    s_waitcnt lgkmcnt(8)
    v_mfma_f32_32x32x16_bf16 v[128:143], v[108:111], v[176:179], v[128:143]
    ds_read_b128 v[240:243], v64 offset:32768
    ds_read_b128 v[244:247], v65 offset:32768
    s_add_u32 m0, s100, 49152
    s_add_u32 s80, s73, 49152
    buffer_load_dwordx4 v14, s[36:39], s80 offen sc1 lds
    s_waitcnt lgkmcnt(6)
    v_mfma_f32_32x32x16_bf16 v[112:127], v[88:91], v[180:183], v[112:127]
    s_waitcnt lgkmcnt(4)
    v_mfma_f32_32x32x16_bf16 v[128:143], v[92:95], v[180:183], v[128:143]
    ds_read_b128 v[248:251], v66 offset:32768
    ds_read_b128 v[252:255], v67 offset:32768
    ds_read_b32 v69, v68
    s_add_u32 m0, s100, 53248
    s_add_u32 s80, s73, 53248
    buffer_load_dwordx4 v14, s[36:39], s80 offen sc1 lds
    s_setprio 0
    s_waitcnt lgkmcnt(0)
    v_rcp_f32 v19, v69
    v_mul_f32 v17, v69, v69
    v_mul_f32 v18, 0x3fb8aa3b, v19
    v_mul_f32 v15, 0xc0135761, v19
    v_mul_f32 v16, v19, v19
    v_mul_f32 v16, v16, v19
    v_mul_f32 v16, 0xbdd2d3e8, v16
    s_barrier
    s_nop 0
    s_add_u32 m0, s100, 57344
    s_add_u32 s80, s101, 573440
    buffer_load_dwordx4 v2, s[24:27], s80 offen  lds
    s_add_u32 m0, s100, 61440
    s_add_u32 s80, s101, 630784
    buffer_load_dwordx4 v2, s[24:27], s80 offen  lds
    s_add_u32 m0, s100, 65536
    s_add_u32 s80, s101, 688128
    buffer_load_dwordx4 v2, s[24:27], s80 offen  lds
    s_add_u32 m0, s100, 69632
    s_add_u32 s80, s101, 745472
    buffer_load_dwordx4 v2, s[24:27], s80 offen  lds
    s_add_u32 m0, s100, 73728
    s_add_u32 s80, s101, 802816
    buffer_load_dwordx4 v2, s[24:27], s80 offen  lds
    s_add_u32 m0, s100, 77824
    s_add_u32 s80, s101, 860160
    buffer_load_dwordx4 v2, s[24:27], s80 offen  lds
    s_add_u32 m0, s100, 81920
    s_add_u32 s80, s101, 917504
    buffer_load_dwordx4 v2, s[24:27], s80 offen  lds
    s_add_u32 m0, s100, 86016
    s_add_u32 s80, s101, 974848
    buffer_load_dwordx4 v2, s[24:27], s80 offen  lds
    v_lshrrev_b32_e64 v84, 5, v0
    v_bfe_u32 v85, v0, 2, 2
    v_lshl_add_u32 v86, v84, 2, v85
    v_lshlrev_b32 v86, 7, v86
    v_lshrrev_b32 v85, 1, v85
    v_lshl_add_u32 v84, v85, 2, v84
    v_lshlrev_b32_e64 v84, 4, v84
    v_bfe_u32 v85, v0, 4, 1
    v_lshlrev_b32 v85, 5, v85
    v_and_b32 v87, 3, v0
    v_lshl_add_u32 v85, v87, 3, v85
    s_and_b32 s81, s3, 1
    s_lshl_b32 s80, s81, 6
    v_add_u32 v85, s80, v85
    v_xor_b32_e64 v84, v84, v85
    s_mov_b32 s80, 0
    v_add3_u32 v84, v84, v86, s80
    v_xor_b32_e64 v85, 32, v84
    v_add_u32 v86, 16384, v14
    s_lshl_b32 s80, s43, 4
    s_add_u32 s80, s80, s6
    s_lshl_b32 s73, s80, 1
    s_add_u32 s73, s73, s81
    s_lshl_b32 s73, s73, 11
    s_add_u32 s73, s73, 14680064
    s_lshl_b32 s80, s80, 4
    s_add_u32 s80, s80, s81
    s_lshl_b32 s80, s80, 3
    s_add_u32 s47, s80, 16941056
    s_waitcnt vmcnt(8)
    s_barrier
    s_cmp_eq_u32 s4, 1
    s_cbranch_scc1 L_FV
L_FK:
    s_setprio 2
    s_nop 0
    ds_read_b64_tr_b16 v[88:89], v12 offset:0
    ds_read_b64_tr_b16 v[90:91], v12 offset:256
    ds_read_b64_tr_b16 v[92:93], v12 offset:1024
    ds_read_b64_tr_b16 v[94:95], v12 offset:1280
    ds_read_b64_tr_b16 v[96:97], v12 offset:2048
    ds_read_b64_tr_b16 v[98:99], v12 offset:2304
    ds_read_b64_tr_b16 v[100:101], v12 offset:3072
    ds_read_b64_tr_b16 v[102:103], v12 offset:3328
    ds_read_b64_tr_b16 v[104:105], v12 offset:8192
    ds_read_b64_tr_b16 v[106:107], v12 offset:8448
    ds_read_b64_tr_b16 v[108:109], v12 offset:9216
    ds_read_b64_tr_b16 v[110:111], v12 offset:9472
    s_waitcnt lgkmcnt(10)
    v_mfma_f32_32x32x16_bf16 v[24:39], v[88:91], v[144:147], 0
    ds_read_b64_tr_b16 v[88:89], v12 offset:10240
    ds_read_b64_tr_b16 v[90:91], v12 offset:10496
    s_waitcnt lgkmcnt(10)
    v_mfma_f32_32x32x16_bf16 v[24:39], v[92:95], v[148:151], v[24:39]
    ds_read_b64_tr_b16 v[92:93], v12 offset:11264
    ds_read_b64_tr_b16 v[94:95], v12 offset:11520
    s_waitcnt lgkmcnt(10)
    v_mfma_f32_32x32x16_bf16 v[24:39], v[96:99], v[152:155], v[24:39]
    ds_read_b64_tr_b16 v[96:97], v12 offset:16384
    ds_read_b64_tr_b16 v[98:99], v12 offset:16640
    s_waitcnt lgkmcnt(10)
    v_mfma_f32_32x32x16_bf16 v[24:39], v[100:103], v[156:159], v[24:39]
    ds_read_b64_tr_b16 v[100:101], v12 offset:17408
    ds_read_b64_tr_b16 v[102:103], v12 offset:17664
    s_waitcnt lgkmcnt(10)
    v_mfma_f32_32x32x16_bf16 v[24:39], v[104:107], v[160:163], v[24:39]
    ds_read_b64_tr_b16 v[104:105], v12 offset:18432
    ds_read_b64_tr_b16 v[106:107], v12 offset:18688
    s_waitcnt lgkmcnt(10)
    v_mfma_f32_32x32x16_bf16 v[24:39], v[108:111], v[164:167], v[24:39]
    ds_read_b64_tr_b16 v[108:109], v12 offset:19456
    ds_read_b64_tr_b16 v[110:111], v12 offset:19712
    s_waitcnt lgkmcnt(10)
    v_mfma_f32_32x32x16_bf16 v[24:39], v[88:91], v[168:171], v[24:39]
    ds_read_b64_tr_b16 v[88:89], v12 offset:24576
    ds_read_b64_tr_b16 v[90:91], v12 offset:24832
    s_waitcnt lgkmcnt(10)
    v_mfma_f32_32x32x16_bf16 v[24:39], v[92:95], v[172:175], v[24:39]
    ds_read_b64_tr_b16 v[92:93], v12 offset:25600
    ds_read_b64_tr_b16 v[94:95], v12 offset:25856
    s_waitcnt lgkmcnt(10)
    v_mfma_f32_32x32x16_bf16 v[24:39], v[96:99], v[176:179], v[24:39]
    ds_read_b64_tr_b16 v[96:97], v12 offset:26624
    ds_read_b64_tr_b16 v[98:99], v12 offset:26880
    s_waitcnt lgkmcnt(10)
    v_mfma_f32_32x32x16_bf16 v[24:39], v[100:103], v[180:183], v[24:39]
    ds_read_b64_tr_b16 v[100:101], v12 offset:27648
    ds_read_b64_tr_b16 v[102:103], v12 offset:27904
    s_waitcnt lgkmcnt(10)
    v_mfma_f32_32x32x16_bf16 v[24:39], v[104:107], v[184:187], v[24:39]
    ds_read_b64_tr_b16 v[104:105], v12 offset:32768
    ds_read_b64_tr_b16 v[106:107], v12 offset:33024
    s_waitcnt lgkmcnt(10)
    v_mfma_f32_32x32x16_bf16 v[24:39], v[108:111], v[188:191], v[24:39]
    ds_read_b64_tr_b16 v[108:109], v12 offset:33792
    ds_read_b64_tr_b16 v[110:111], v12 offset:34048
    s_waitcnt lgkmcnt(10)
    v_mfma_f32_32x32x16_bf16 v[24:39], v[88:91], v[192:195], v[24:39]
    ds_read_b64_tr_b16 v[88:89], v12 offset:34816
    ds_read_b64_tr_b16 v[90:91], v12 offset:35072
    s_waitcnt lgkmcnt(10)
    v_mfma_f32_32x32x16_bf16 v[24:39], v[92:95], v[196:199], v[24:39]
    ds_read_b64_tr_b16 v[92:93], v12 offset:35840
    ds_read_b64_tr_b16 v[94:95], v12 offset:36096
    s_waitcnt lgkmcnt(10)
    v_mfma_f32_32x32x16_bf16 v[24:39], v[96:99], v[200:203], v[24:39]
    ds_read_b64_tr_b16 v[96:97], v12 offset:40960
    ds_read_b64_tr_b16 v[98:99], v12 offset:41216
    s_waitcnt lgkmcnt(10)
    v_mfma_f32_32x32x16_bf16 v[24:39], v[100:103], v[204:207], v[24:39]
    ds_read_b64_tr_b16 v[100:101], v12 offset:41984
    ds_read_b64_tr_b16 v[102:103], v12 offset:42240
    s_waitcnt lgkmcnt(10)
    v_mfma_f32_32x32x16_bf16 v[24:39], v[104:107], v[208:211], v[24:39]
    ds_read_b64_tr_b16 v[104:105], v12 offset:43008
    ds_read_b64_tr_b16 v[106:107], v12 offset:43264
    s_waitcnt lgkmcnt(10)
    v_mfma_f32_32x32x16_bf16 v[24:39], v[108:111], v[212:215], v[24:39]
    ds_read_b64_tr_b16 v[108:109], v12 offset:44032
    ds_read_b64_tr_b16 v[110:111], v12 offset:44288
    s_waitcnt lgkmcnt(10)
    s_nop 0
    v_mfma_f32_32x32x16_bf16 v[24:39], v[88:91], v[216:219], v[24:39]
    s_add_u32 m0, s100, 122880
    s_add_u32 s80, s101, 1490944
    buffer_load_dwordx4 v2, s[24:27], s80 offen  lds
    ds_read_b64_tr_b16 v[88:89], v12 offset:49152
    ds_read_b64_tr_b16 v[90:91], v12 offset:49408
    s_waitcnt lgkmcnt(10)
    v_mfma_f32_32x32x16_bf16 v[24:39], v[92:95], v[220:223], v[24:39]
    ds_read_b64_tr_b16 v[92:93], v12 offset:50176
    ds_read_b64_tr_b16 v[94:95], v12 offset:50432
    s_waitcnt lgkmcnt(10)
    v_mfma_f32_32x32x16_bf16 v[24:39], v[96:99], v[224:227], v[24:39]
    s_add_u32 m0, s100, 126976
    s_add_u32 s80, s101, 1548288
    buffer_load_dwordx4 v2, s[24:27], s80 offen  lds
    ds_read_b64_tr_b16 v[96:97], v12 offset:51200
    ds_read_b64_tr_b16 v[98:99], v12 offset:51456
    s_waitcnt lgkmcnt(10)
    v_mfma_f32_32x32x16_bf16 v[24:39], v[100:103], v[228:231], v[24:39]
    ds_read_b64_tr_b16 v[100:101], v12 offset:52224
    ds_read_b64_tr_b16 v[102:103], v12 offset:52480
    s_waitcnt lgkmcnt(10)
    v_mfma_f32_32x32x16_bf16 v[24:39], v[104:107], v[232:235], v[24:39]
    s_waitcnt lgkmcnt(8)
    v_mfma_f32_32x32x16_bf16 v[24:39], v[108:111], v[236:239], v[24:39]
    ds_read_b64_tr_b16 v[60:61], v75 offset:0
    ds_read_b64_tr_b16 v[62:63], v75 offset:448
    ds_read_b64_tr_b16 v[64:65], v75 offset:896
    ds_read_b64_tr_b16 v[66:67], v75 offset:1344
    s_waitcnt lgkmcnt(10)
    v_mfma_f32_32x32x16_bf16 v[24:39], v[88:91], v[240:243], v[24:39]
    s_waitcnt lgkmcnt(8)
    v_mfma_f32_32x32x16_bf16 v[24:39], v[92:95], v[244:247], v[24:39]
    s_waitcnt lgkmcnt(6)
    v_mfma_f32_32x32x16_bf16 v[24:39], v[96:99], v[248:251], v[24:39]
    s_waitcnt lgkmcnt(4)
    v_mfma_f32_32x32x16_bf16 v[24:39], v[100:103], v[252:255], v[24:39]
    s_cmp_ge_u32 s3, 4
    s_cbranch_scc1 L_rare17
L_back18:
    s_waitcnt lgkmcnt(0)
    v_cndmask_b32 v66, v66, 0, s[68:69]
    v_cndmask_b32 v67, v67, 0, s[68:69]
    s_nop 6
    s_nop 0
    v_cvt_pk_bf16_f32 v96, v24, v25
    v_cvt_pk_bf16_f32 v97, v26, v27
    v_cvt_pk_bf16_f32 v98, v28, v29
    v_cvt_pk_bf16_f32 v99, v30, v31
    v_cvt_pk_bf16_f32 v100, v32, v33
    v_cvt_pk_bf16_f32 v101, v34, v35
    v_cvt_pk_bf16_f32 v102, v36, v37
    v_cvt_pk_bf16_f32 v103, v38, v39
    v_mfma_f32_32x32x16_bf16 v[40:55], v[60:63], v[96:99], 0
    s_nop 0
    v_mfma_f32_32x32x16_bf16 v[40:55], v[64:67], v[100:103], v[40:55]
    s_setprio 0
    s_nop 10
    s_nop 0
    v_max3_f32 v104, v40, v41, v42
    v_min3_f32 v105, v40, v41, v42
    v_cndmask_b32 v52, v52, v54, s[68:69]
    v_cndmask_b32 v53, v53, v55, s[68:69]
    v_max3_f32 v104, v104, v43, v44
    v_min3_f32 v105, v105, v43, v44
    v_max3_f32 v104, v104, v45, v46
    v_min3_f32 v105, v105, v45, v46
    v_max3_f32 v104, v104, v47, v48
    v_min3_f32 v105, v105, v47, v48
    v_max3_f32 v104, v104, v49, v50
    v_min3_f32 v105, v105, v49, v50
    v_max3_f32 v104, v104, v51, v52
    v_min3_f32 v105, v105, v51, v52
    v_max_f32 v104, v104, v53
    v_min_f32 v105, v105, v53
    v_mul_f32 v106, v104, v18
    v_mul_f32 v107, v105, v18
    v_mul_f32 v104, v104, v18
    v_mul_f32 v105, v105, v18
    s_nop 0
    v_permlane32_swap_b32 v104, v106
    v_permlane32_swap_b32 v105, v107
    v_max_f32 v104, v104, v106
    v_min_f32_e64 v105, v105, v107
    v_fma_f32 v24, v40, v18, -v104
    v_fma_f32 v40, -v40, v18, v105
    v_fma_f32 v25, v41, v18, -v104
    v_fma_f32 v41, -v41, v18, v105
    v_fma_f32 v26, v42, v18, -v104
    v_fma_f32 v42, -v42, v18, v105
    v_fma_f32 v27, v43, v18, -v104
    v_fma_f32 v43, -v43, v18, v105
    v_fma_f32 v28, v44, v18, -v104
    v_fma_f32 v44, -v44, v18, v105
    v_fma_f32 v29, v45, v18, -v104
    v_fma_f32 v45, -v45, v18, v105
    v_fma_f32 v30, v46, v18, -v104
    v_fma_f32 v46, -v46, v18, v105
    v_fma_f32 v31, v47, v18, -v104
    v_fma_f32 v47, -v47, v18, v105
    v_fma_f32 v32, v48, v18, -v104
    v_fma_f32 v48, -v48, v18, v105
    v_fma_f32 v33, v49, v18, -v104
    v_fma_f32 v49, -v49, v18, v105
    v_fma_f32 v34, v50, v18, -v104
    v_fma_f32 v50, -v50, v18, v105
    v_fma_f32 v35, v51, v18, -v104
    v_fma_f32 v51, -v51, v18, v105
    v_fma_f32 v36, v52, v18, -v104
    v_fma_f32 v52, -v52, v18, v105
    v_fma_f32 v37, v53, v18, -v104
    v_fma_f32 v53, -v53, v18, v105
    v_exp_f32 v24, v24
    v_exp_f32 v40, v40
    v_exp_f32 v25, v25
    v_exp_f32 v41, v41
    v_exp_f32 v26, v26
    v_exp_f32 v42, v42
    v_exp_f32 v27, v27
    v_exp_f32 v43, v43
    v_exp_f32 v28, v28
    v_exp_f32 v44, v44
    v_exp_f32 v29, v29
    v_exp_f32 v45, v45
    v_exp_f32 v30, v30
    v_exp_f32 v46, v46
    v_exp_f32 v31, v31
    v_exp_f32 v47, v47
    v_exp_f32 v32, v32
    v_exp_f32 v48, v48
    v_exp_f32 v33, v33
    v_exp_f32 v49, v49
    v_exp_f32 v34, v34
    v_exp_f32 v50, v50
    v_exp_f32 v35, v35
    v_exp_f32 v51, v51
    v_exp_f32 v36, v36
    v_exp_f32 v52, v52
    v_exp_f32 v37, v37
    v_exp_f32 v53, v53
    v_add_f32 v104, v24, v25
    v_add_f32 v105, v26, v27
    v_add_f32 v106, v40, v41
    v_add_f32 v107, v42, v43
    v_add_f32 v104, v104, v28
    v_add_f32 v106, v106, v44
    v_add_f32 v105, v105, v29
    v_add_f32 v107, v107, v45
    v_add_f32 v104, v104, v30
    v_add_f32 v106, v106, v46
    v_add_f32 v105, v105, v31
    v_add_f32 v107, v107, v47
    v_add_f32 v104, v104, v32
    v_add_f32 v106, v106, v48
    v_add_f32 v105, v105, v33
    v_add_f32 v107, v107, v49
    v_add_f32 v104, v104, v34
    s_setprio 3
    s_waitcnt vmcnt(0)
    s_barrier
    v_add_f32 v106, v106, v50
    v_add_f32 v105, v105, v35
    v_add_f32 v107, v107, v51
    v_add_f32 v104, v104, v36
    v_add_f32 v106, v106, v52
    v_add_f32 v105, v105, v37
    v_add_f32 v107, v107, v53
    v_add_f32 v104, v104, v105
    v_add_f32 v106, v106, v107
    s_nop 1
    v_permlane32_swap_b32 v104, v106
    v_add_f32 v104, v104, v106
    v_rcp_f32 v104, v104
    s_nop 0
    v_mul_f32 v106, v104, v19
    v_mul_f32 v104, v104, v19
    s_nop 1
    v_permlane32_swap_b32 v104, v106
    v_mul_f32 v24, v24, v104
    v_mul_f32 v25, v25, v104
    v_mul_f32 v26, v26, v104
    v_mul_f32 v27, v27, v104
    v_mul_f32 v28, v28, v104
    v_mul_f32 v29, v29, v104
    v_mul_f32 v30, v30, v104
    v_mul_f32 v31, v31, v104
    v_mul_f32 v32, v32, v104
    v_mul_f32 v33, v33, v104
    v_mul_f32 v34, v34, v104
    v_mul_f32 v35, v35, v104
    v_mul_f32 v36, v36, v104
    v_mul_f32 v37, v37, v104
    v_cvt_pk_bf16_f32 v88, v24, v25
    v_cvt_pk_bf16_f32 v89, v26, v27
    v_cvt_pk_bf16_f32 v90, v28, v29
    v_cvt_pk_bf16_f32 v91, v30, v31
    v_cvt_pk_bf16_f32 v92, v32, v33
    v_cvt_pk_bf16_f32 v93, v34, v35
    v_cvt_pk_bf16_f32 v94, v36, v37
    ds_write_b64 v76, v[88:89]
    ds_write_b64 v77, v[90:91]
    ds_write_b64 v78, v[92:93]
    ds_write_b64 v79, v[94:95]
    v_mul_f32 v40, v40, v106
    v_mul_f32 v41, v41, v106
    v_mul_f32 v42, v42, v106
    v_mul_f32 v43, v43, v106
    v_mul_f32 v44, v44, v106
    v_mul_f32 v45, v45, v106
    v_mul_f32 v46, v46, v106
    v_mul_f32 v47, v47, v106
    v_mul_f32 v48, v48, v106
    v_mul_f32 v49, v49, v106
    v_mul_f32 v50, v50, v106
    v_mul_f32 v51, v51, v106
    v_mul_f32 v52, v52, v106
    v_mul_f32 v53, v53, v106
    v_cvt_pk_bf16_f32 v96, v40, v41
    v_cvt_pk_bf16_f32 v97, v42, v43
    v_cvt_pk_bf16_f32 v98, v44, v45
    v_cvt_pk_bf16_f32 v99, v46, v47
    v_cvt_pk_bf16_f32 v100, v48, v49
    v_cvt_pk_bf16_f32 v101, v50, v51
    v_cvt_pk_bf16_f32 v102, v52, v53
    ds_write_b64 v80, v[96:97]
    ds_write_b64 v81, v[98:99]
    ds_write_b64 v82, v[100:101]
    ds_write_b64 v83, v[102:103]
    s_setprio 0
    s_waitcnt lgkmcnt(0)
    s_barrier
    s_cmp_ge_u32 s3, 4
    s_cbranch_scc1 L_nokv20
    s_setprio 3
    ds_read_b64_tr_b16 v[24:25], v84 offset:0
    ds_read_b64_tr_b16 v[26:27], v85 offset:1024
    ds_read_b128 v[28:31], v86 offset:0
    ds_read_b64_tr_b16 v[32:33], v84 offset:2048
    ds_read_b64_tr_b16 v[34:35], v85 offset:3072
    ds_read_b128 v[36:39], v86 offset:1024
    ds_read_b64_tr_b16 v[40:41], v84 offset:4096
    ds_read_b64_tr_b16 v[42:43], v85 offset:5120
    ds_read_b128 v[44:47], v86 offset:2048
    ds_read_b64_tr_b16 v[48:49], v84 offset:6144
    ds_read_b64_tr_b16 v[50:51], v85 offset:7168
    ds_read_b128 v[52:55], v86 offset:3072
    ds_read_b64_tr_b16 v[88:89], v84 offset:8192
    ds_read_b64_tr_b16 v[90:91], v85 offset:9216
    ds_read_b128 v[92:95], v86 offset:4096
    s_waitcnt lgkmcnt(12)
    v_mfma_f32_32x32x16_bf16 v[60:75], v[24:27], v[28:31], 0
    ds_read_b64_tr_b16 v[96:97], v84 offset:10240
    ds_read_b64_tr_b16 v[98:99], v85 offset:11264
    ds_read_b128 v[100:103], v86 offset:5120
    s_waitcnt lgkmcnt(12)
    v_mfma_f32_32x32x16_bf16 v[60:75], v[32:35], v[36:39], v[60:75]
    ds_read_b64_tr_b16 v[104:105], v84 offset:12288
    ds_read_b64_tr_b16 v[106:107], v85 offset:13312
    ds_read_b128 v[108:111], v86 offset:6144
    s_waitcnt lgkmcnt(12)
    v_mfma_f32_32x32x16_bf16 v[60:75], v[40:43], v[44:47], v[60:75]
    ds_read_b64_tr_b16 v[24:25], v84 offset:14336
    ds_read_b64_tr_b16 v[26:27], v85 offset:15360
    ds_read_b128 v[28:31], v86 offset:7168
    s_waitcnt lgkmcnt(12)
    v_mfma_f32_32x32x16_bf16 v[60:75], v[48:51], v[52:55], v[60:75]
    s_waitcnt lgkmcnt(9)
    v_mfma_f32_32x32x16_bf16 v[60:75], v[88:91], v[92:95], v[60:75]
    s_waitcnt lgkmcnt(6)
    v_mfma_f32_32x32x16_bf16 v[60:75], v[96:99], v[100:103], v[60:75]
    s_waitcnt lgkmcnt(3)
    v_mfma_f32_32x32x16_bf16 v[60:75], v[104:107], v[108:111], v[60:75]
    s_waitcnt lgkmcnt(0)
    v_mfma_f32_32x32x16_bf16 v[60:75], v[24:27], v[28:31], v[60:75]
    s_nop 11
    s_nop 0
    v_cvt_pk_bf16_f32 v60, v60, v61
    v_cvt_pk_bf16_f32 v61, v62, v63
    v_cvt_pk_bf16_f32 v62, v64, v65
    v_cvt_pk_bf16_f32 v63, v66, v67
    v_cvt_pk_bf16_f32 v64, v68, v69
    v_cvt_pk_bf16_f32 v65, v70, v71
    v_cvt_pk_bf16_f32 v66, v72, v73
    v_mov_b32_e64 v67, 0
    buffer_store_dwordx4 v[60:63], v14, s[36:39], s73 offen offset:0 sc1
    buffer_store_dwordx4 v[64:67], v14, s[36:39], s73 offen offset:1024 sc1
    s_setprio 0
L_nokv20:
    s_nop 0
    s_add_u32 m0, s100, 24576
    s_add_u32 s80, s72, 344064
    buffer_load_dwordx4 v2, s[24:27], s80 offen  lds
    s_add_u32 m0, s100, 28672
    s_add_u32 s80, s72, 401408
    buffer_load_dwordx4 v2, s[24:27], s80 offen  lds
    s_add_u32 m0, s100, 32768
    s_add_u32 s80, s72, 458752
    buffer_load_dwordx4 v2, s[24:27], s80 offen  lds
    s_add_u32 m0, s100, 36864
    s_add_u32 s80, s72, 516096
    buffer_load_dwordx4 v2, s[24:27], s80 offen  lds
    s_add_u32 m0, s100, 40960
    s_add_u32 s80, s72, 573440
    buffer_load_dwordx4 v2, s[24:27], s80 offen  lds
    s_add_u32 m0, s100, 45056
    s_add_u32 s80, s72, 630784
    buffer_load_dwordx4 v2, s[24:27], s80 offen  lds
    s_add_u32 m0, s100, 49152
    s_add_u32 s80, s72, 688128
    buffer_load_dwordx4 v2, s[24:27], s80 offen  lds
    s_add_u32 m0, s100, 53248
    s_add_u32 s80, s72, 745472
    buffer_load_dwordx4 v2, s[24:27], s80 offen  lds
    s_setprio 1
    s_nop 0
    ds_read_b64_tr_b16 v[88:89], v5 offset:57344
    ds_read_b64_tr_b16 v[90:91], v5 offset:57856
    ds_read_b64_tr_b16 v[92:93], v6 offset:57344
    ds_read_b64_tr_b16 v[94:95], v6 offset:57856
    ds_read_b64_tr_b16 v[96:97], v5 offset:61440
    ds_read_b64_tr_b16 v[98:99], v5 offset:61952
    ds_read_b64_tr_b16 v[100:101], v6 offset:61440
    ds_read_b64_tr_b16 v[102:103], v6 offset:61952
    ds_read_b64_tr_b16 v[104:105], v7 offset:0
    ds_read_b64_tr_b16 v[106:107], v7 offset:512
    s_waitcnt lgkmcnt(8)
    v_mfma_f32_32x32x16_bf16 v[112:127], v[88:91], v[184:187], v[112:127]
    ds_read_b64_tr_b16 v[108:109], v8 offset:0
    ds_read_b64_tr_b16 v[110:111], v8 offset:512
    s_waitcnt lgkmcnt(8)
    v_mfma_f32_32x32x16_bf16 v[128:143], v[92:95], v[184:187], v[128:143]
    ds_read_b64_tr_b16 v[88:89], v7 offset:4096
    ds_read_b64_tr_b16 v[90:91], v7 offset:4608
    s_waitcnt lgkmcnt(8)
    v_mfma_f32_32x32x16_bf16 v[112:127], v[96:99], v[188:191], v[112:127]
    ds_read_b64_tr_b16 v[92:93], v8 offset:4096
    ds_read_b64_tr_b16 v[94:95], v8 offset:4608
    s_waitcnt lgkmcnt(8)
    v_mfma_f32_32x32x16_bf16 v[128:143], v[100:103], v[188:191], v[128:143]
    ds_read_b64_tr_b16 v[96:97], v7 offset:8192
    ds_read_b64_tr_b16 v[98:99], v7 offset:8704
    s_waitcnt lgkmcnt(8)
    v_mfma_f32_32x32x16_bf16 v[112:127], v[104:107], v[192:195], v[112:127]
    ds_read_b64_tr_b16 v[100:101], v8 offset:8192
    ds_read_b64_tr_b16 v[102:103], v8 offset:8704
    s_waitcnt lgkmcnt(8)
    v_mfma_f32_32x32x16_bf16 v[128:143], v[108:111], v[192:195], v[128:143]
    ds_read_b64_tr_b16 v[104:105], v7 offset:12288
    ds_read_b64_tr_b16 v[106:107], v7 offset:12800
    s_waitcnt lgkmcnt(8)
    v_mfma_f32_32x32x16_bf16 v[112:127], v[88:91], v[196:199], v[112:127]
    ds_read_b64_tr_b16 v[108:109], v8 offset:12288
    ds_read_b64_tr_b16 v[110:111], v8 offset:12800
    s_waitcnt lgkmcnt(8)
    v_mfma_f32_32x32x16_bf16 v[128:143], v[92:95], v[196:199], v[128:143]
    ds_read_b64_tr_b16 v[88:89], v7 offset:16384
    ds_read_b64_tr_b16 v[90:91], v7 offset:16896
    s_waitcnt lgkmcnt(8)
    v_mfma_f32_32x32x16_bf16 v[112:127], v[96:99], v[200:203], v[112:127]
    ds_read_b64_tr_b16 v[92:93], v8 offset:16384
    ds_read_b64_tr_b16 v[94:95], v8 offset:16896
    s_waitcnt lgkmcnt(8)
    v_mfma_f32_32x32x16_bf16 v[128:143], v[100:103], v[200:203], v[128:143]
    s_cmp_lt_u32 s3, 4
    s_cbranch_scc1 L_rare22
L_back23:
    ds_read_b64_tr_b16 v[96:97], v7 offset:20480
    ds_read_b64_tr_b16 v[98:99], v7 offset:20992
    s_waitcnt lgkmcnt(8)
    v_mfma_f32_32x32x16_bf16 v[112:127], v[104:107], v[204:207], v[112:127]
    ds_read_b64_tr_b16 v[100:101], v8 offset:20480
    ds_read_b64_tr_b16 v[102:103], v8 offset:20992
    s_waitcnt lgkmcnt(8)
    v_mfma_f32_32x32x16_bf16 v[128:143], v[108:111], v[204:207], v[128:143]
    ds_read_b64_tr_b16 v[104:105], v7 offset:24576
    ds_read_b64_tr_b16 v[106:107], v7 offset:25088
    s_waitcnt lgkmcnt(8)
    v_mfma_f32_32x32x16_bf16 v[112:127], v[88:91], v[208:211], v[112:127]
    ds_read_b64_tr_b16 v[108:109], v8 offset:24576
    ds_read_b64_tr_b16 v[110:111], v8 offset:25088
    s_waitcnt lgkmcnt(8)
    v_mfma_f32_32x32x16_bf16 v[128:143], v[92:95], v[208:211], v[128:143]
    ds_read_b64_tr_b16 v[88:89], v7 offset:28672
    ds_read_b64_tr_b16 v[90:91], v7 offset:29184
    s_waitcnt lgkmcnt(8)
    v_mfma_f32_32x32x16_bf16 v[112:127], v[96:99], v[212:215], v[112:127]
    ds_read_b64_tr_b16 v[92:93], v8 offset:28672
    ds_read_b64_tr_b16 v[94:95], v8 offset:29184
    s_waitcnt lgkmcnt(8)
    v_mfma_f32_32x32x16_bf16 v[128:143], v[100:103], v[212:215], v[128:143]
    s_barrier
    ds_read_b64_tr_b16 v[96:97], v7 offset:32768
    ds_read_b64_tr_b16 v[98:99], v7 offset:33280
    s_waitcnt lgkmcnt(8)
    v_mfma_f32_32x32x16_bf16 v[112:127], v[104:107], v[216:219], v[112:127]
    ds_read_b64_tr_b16 v[100:101], v8 offset:32768
    ds_read_b64_tr_b16 v[102:103], v8 offset:33280
    s_waitcnt lgkmcnt(8)
    s_nop 0
    v_mfma_f32_32x32x16_bf16 v[128:143], v[108:111], v[216:219], v[128:143]
    s_add_u32 m0, s100, 57344
    s_add_u32 s80, s72, 802816
    buffer_load_dwordx4 v2, s[24:27], s80 offen  lds
    ds_read_b64_tr_b16 v[104:105], v7 offset:36864
    ds_read_b64_tr_b16 v[106:107], v7 offset:37376
    s_waitcnt lgkmcnt(8)
    v_mfma_f32_32x32x16_bf16 v[112:127], v[88:91], v[220:223], v[112:127]
    ds_read_b64_tr_b16 v[108:109], v8 offset:36864
    ds_read_b64_tr_b16 v[110:111], v8 offset:37376
    s_waitcnt lgkmcnt(8)
    v_mfma_f32_32x32x16_bf16 v[128:143], v[92:95], v[220:223], v[128:143]
    s_add_u32 m0, s100, 61440
    s_add_u32 s80, s72, 860160
    buffer_load_dwordx4 v2, s[24:27], s80 offen  lds
    ds_read_b64_tr_b16 v[88:89], v7 offset:40960
    ds_read_b64_tr_b16 v[90:91], v7 offset:41472
    s_waitcnt lgkmcnt(8)
    v_mfma_f32_32x32x16_bf16 v[112:127], v[96:99], v[224:227], v[112:127]
    ds_read_b64_tr_b16 v[92:93], v8 offset:40960
    ds_read_b64_tr_b16 v[94:95], v8 offset:41472
    s_waitcnt lgkmcnt(8)
    v_mfma_f32_32x32x16_bf16 v[128:143], v[100:103], v[224:227], v[128:143]
    s_add_u32 m0, s100, 65536
    s_add_u32 s80, s72, 917504
    buffer_load_dwordx4 v2, s[24:27], s80 offen  lds
    ds_read_b64_tr_b16 v[96:97], v7 offset:45056
    ds_read_b64_tr_b16 v[98:99], v7 offset:45568
    s_waitcnt lgkmcnt(8)
    v_mfma_f32_32x32x16_bf16 v[112:127], v[104:107], v[228:231], v[112:127]
    ds_read_b64_tr_b16 v[100:101], v8 offset:45056
    ds_read_b64_tr_b16 v[102:103], v8 offset:45568
    s_waitcnt lgkmcnt(8)
    v_mfma_f32_32x32x16_bf16 v[128:143], v[108:111], v[228:231], v[128:143]
    s_add_u32 m0, s100, 69632
    s_add_u32 s80, s72, 974848
    buffer_load_dwordx4 v2, s[24:27], s80 offen  lds
    ds_read_b64_tr_b16 v[104:105], v7 offset:49152
    ds_read_b64_tr_b16 v[106:107], v7 offset:49664
    s_waitcnt lgkmcnt(8)
    v_mfma_f32_32x32x16_bf16 v[112:127], v[88:91], v[232:235], v[112:127]
    ds_read_b64_tr_b16 v[108:109], v8 offset:49152
    ds_read_b64_tr_b16 v[110:111], v8 offset:49664
    s_waitcnt lgkmcnt(8)
    v_mfma_f32_32x32x16_bf16 v[128:143], v[92:95], v[232:235], v[128:143]
    s_add_u32 m0, s100, 73728
    s_add_u32 s80, s72, 1032192
    buffer_load_dwordx4 v2, s[24:27], s80 offen  lds
    ds_read_b64_tr_b16 v[88:89], v7 offset:53248
    ds_read_b64_tr_b16 v[90:91], v7 offset:53760
    s_waitcnt lgkmcnt(8)
    v_mfma_f32_32x32x16_bf16 v[112:127], v[96:99], v[236:239], v[112:127]
    ds_read_b64_tr_b16 v[92:93], v8 offset:53248
    ds_read_b64_tr_b16 v[94:95], v8 offset:53760
    s_waitcnt lgkmcnt(8)
    v_mfma_f32_32x32x16_bf16 v[128:143], v[100:103], v[236:239], v[128:143]
    s_add_u32 m0, s100, 77824
    s_add_u32 s80, s72, 1089536
    buffer_load_dwordx4 v2, s[24:27], s80 offen  lds
    ds_read_b64_tr_b16 v[96:97], v7 offset:57344
    ds_read_b64_tr_b16 v[98:99], v7 offset:57856
    s_waitcnt lgkmcnt(8)
    v_mfma_f32_32x32x16_bf16 v[112:127], v[104:107], v[240:243], v[112:127]
    ds_read_b64_tr_b16 v[100:101], v8 offset:57344
    ds_read_b64_tr_b16 v[102:103], v8 offset:57856
    s_waitcnt lgkmcnt(8)
    v_mfma_f32_32x32x16_bf16 v[128:143], v[108:111], v[240:243], v[128:143]
    s_add_u32 m0, s100, 81920
    s_add_u32 s80, s72, 1146880
    buffer_load_dwordx4 v2, s[24:27], s80 offen  lds
    ds_read_b64_tr_b16 v[104:105], v7 offset:61440
    ds_read_b64_tr_b16 v[106:107], v7 offset:61952
    s_waitcnt lgkmcnt(8)
    v_mfma_f32_32x32x16_bf16 v[112:127], v[88:91], v[244:247], v[112:127]
    ds_read_b64_tr_b16 v[108:109], v8 offset:61440
    ds_read_b64_tr_b16 v[110:111], v8 offset:61952
    s_waitcnt lgkmcnt(8)
    v_mfma_f32_32x32x16_bf16 v[128:143], v[92:95], v[244:247], v[128:143]
    s_add_u32 m0, s100, 86016
    s_add_u32 s80, s72, 1204224
    buffer_load_dwordx4 v2, s[24:27], s80 offen  lds
    s_waitcnt vmcnt(8) lgkmcnt(0)
    s_barrier
    v_mfma_f32_32x32x16_bf16 v[112:127], v[96:99], v[248:251], v[112:127]
    v_mfma_f32_32x32x16_bf16 v[128:143], v[100:103], v[248:251], v[128:143]
    v_mfma_f32_32x32x16_bf16 v[112:127], v[104:107], v[252:255], v[112:127]
    v_mfma_f32_32x32x16_bf16 v[128:143], v[108:111], v[252:255], v[128:143]
    s_setprio 0
    s_nop 9
    v_mul_f32 v88, v112, v112
    v_mul_f32 v89, v113, v113
    v_mul_f32 v90, v114, v114
    v_mul_f32 v91, v115, v115
    v_mul_f32 v92, v116, v116
    v_mul_f32 v93, v117, v117
    v_mul_f32 v94, v118, v118
    v_mul_f32 v95, v119, v119
    v_fma_f32 v88, v88, v16, v15
    v_fma_f32 v89, v89, v16, v15
    v_fma_f32 v90, v90, v16, v15
    v_fma_f32 v91, v91, v16, v15
    v_fma_f32 v92, v92, v16, v15
    v_fma_f32 v93, v93, v16, v15
    v_fma_f32 v94, v94, v16, v15
    v_fma_f32 v95, v95, v16, v15
    v_mul_f32 v88, v88, v112
    v_mul_f32 v89, v89, v113
    v_mul_f32 v90, v90, v114
    v_mul_f32 v91, v91, v115
    v_mul_f32 v92, v92, v116
    v_mul_f32 v93, v93, v117
    v_mul_f32 v94, v94, v118
    v_mul_f32 v95, v95, v119
    v_exp_f32 v88, v88
    v_mul_f32 v112, v112, v120
    v_exp_f32 v89, v89
    v_mul_f32 v113, v113, v121
    v_exp_f32 v90, v90
    v_mul_f32 v114, v114, v122
    v_exp_f32 v91, v91
    v_mul_f32 v115, v115, v123
    v_exp_f32 v92, v92
    v_mul_f32 v116, v116, v124
    v_exp_f32 v93, v93
    v_mul_f32 v117, v117, v125
    v_exp_f32 v94, v94
    v_mul_f32 v118, v118, v126
    v_exp_f32 v95, v95
    v_mul_f32 v119, v119, v127
    v_fma_f32 v88, v88, v17, v17
    v_fma_f32 v89, v89, v17, v17
    v_fma_f32 v90, v90, v17, v17
    v_fma_f32 v91, v91, v17, v17
    v_fma_f32 v92, v92, v17, v17
    v_fma_f32 v93, v93, v17, v17
    v_fma_f32 v94, v94, v17, v17
    v_fma_f32 v95, v95, v17, v17
    v_rcp_f32 v88, v88
    v_rcp_f32 v89, v89
    v_rcp_f32 v90, v90
    v_rcp_f32 v91, v91
    v_rcp_f32 v92, v92
    v_rcp_f32 v93, v93
    v_rcp_f32 v94, v94
    v_rcp_f32 v95, v95
    v_mul_f32 v88, v88, v112
    v_mul_f32 v89, v89, v113
    v_mul_f32 v90, v90, v114
    v_mul_f32 v91, v91, v115
    v_mul_f32 v92, v92, v116
    v_mul_f32 v93, v93, v117
    v_mul_f32 v94, v94, v118
    v_mul_f32 v95, v95, v119
    v_cvt_pk_bf16_f32 v40, v88, v89
    v_cvt_pk_bf16_f32 v41, v90, v91
    v_cvt_pk_bf16_f32 v42, v92, v93
    v_cvt_pk_bf16_f32 v43, v94, v95
    buffer_store_dwordx4 v[40:43], v14, s[36:39], s74 offen offset:0 sc1
    v_mul_f32 v96, v128, v128
    v_mul_f32 v97, v129, v129
    v_mul_f32 v98, v130, v130
    v_mul_f32 v99, v131, v131
    v_mul_f32 v100, v132, v132
    v_mul_f32 v101, v133, v133
    v_mul_f32 v102, v134, v134
    v_mul_f32 v103, v135, v135
    v_fma_f32 v96, v96, v16, v15
    v_fma_f32 v97, v97, v16, v15
    v_fma_f32 v98, v98, v16, v15
    v_fma_f32 v99, v99, v16, v15
    v_fma_f32 v100, v100, v16, v15
    v_fma_f32 v101, v101, v16, v15
    v_fma_f32 v102, v102, v16, v15
    v_fma_f32 v103, v103, v16, v15
    v_mul_f32 v96, v96, v128
    v_mul_f32 v97, v97, v129
    v_mul_f32 v98, v98, v130
    v_mul_f32 v99, v99, v131
    v_mul_f32 v100, v100, v132
    v_mul_f32 v101, v101, v133
    v_mul_f32 v102, v102, v134
    v_mul_f32 v103, v103, v135
    v_exp_f32 v96, v96
    v_mul_f32 v128, v128, v136
    v_exp_f32 v97, v97
    v_mul_f32 v129, v129, v137
    v_exp_f32 v98, v98
    v_mul_f32 v130, v130, v138
    v_exp_f32 v99, v99
    v_mul_f32 v131, v131, v139
    v_exp_f32 v100, v100
    v_mul_f32 v132, v132, v140
    v_exp_f32 v101, v101
    v_mul_f32 v133, v133, v141
    v_exp_f32 v102, v102
    v_mul_f32 v134, v134, v142
    v_exp_f32 v103, v103
    v_mul_f32 v135, v135, v143
    v_fma_f32 v96, v96, v17, v17
    v_fma_f32 v97, v97, v17, v17
    v_fma_f32 v98, v98, v17, v17
    v_fma_f32 v99, v99, v17, v17
    v_fma_f32 v100, v100, v17, v17
    v_fma_f32 v101, v101, v17, v17
    v_fma_f32 v102, v102, v17, v17
    v_fma_f32 v103, v103, v17, v17
    v_rcp_f32 v96, v96
    v_rcp_f32 v97, v97
    v_rcp_f32 v98, v98
    v_rcp_f32 v99, v99
    v_rcp_f32 v100, v100
    v_rcp_f32 v101, v101
    v_rcp_f32 v102, v102
    v_rcp_f32 v103, v103
    v_mul_f32 v96, v96, v128
    v_mul_f32 v97, v97, v129
    v_mul_f32 v98, v98, v130
    v_mul_f32 v99, v99, v131
    v_mul_f32 v100, v100, v132
    v_mul_f32 v101, v101, v133
    v_mul_f32 v102, v102, v134
    v_mul_f32 v103, v103, v135
    v_cvt_pk_bf16_f32 v44, v96, v97
    v_cvt_pk_bf16_f32 v45, v98, v99
    v_cvt_pk_bf16_f32 v46, v100, v101
    v_cvt_pk_bf16_f32 v47, v102, v103
    buffer_store_dwordx4 v[44:47], v14, s[36:39], s74 offen offset:1024 sc1
    s_setprio 1
    s_nop 0
    ds_read_b64_tr_b16 v[88:89], v9 offset:0
    ds_read_b64_tr_b16 v[90:91], v9 offset:512
    ds_read_b64_tr_b16 v[92:93], v10 offset:0
    ds_read_b64_tr_b16 v[94:95], v10 offset:512
    ds_read_b64_tr_b16 v[96:97], v9 offset:4096
    ds_read_b64_tr_b16 v[98:99], v9 offset:4608
    ds_read_b64_tr_b16 v[100:101], v10 offset:4096
    ds_read_b64_tr_b16 v[102:103], v10 offset:4608
    ds_read_b64_tr_b16 v[104:105], v9 offset:8192
    ds_read_b64_tr_b16 v[106:107], v9 offset:8704
    s_waitcnt lgkmcnt(8)
    v_mfma_f32_32x32x16_bf16 v[112:127], v[88:91], v[144:147], 0
    ds_read_b64_tr_b16 v[108:109], v10 offset:8192
    ds_read_b64_tr_b16 v[110:111], v10 offset:8704
    s_waitcnt lgkmcnt(8)
    v_mfma_f32_32x32x16_bf16 v[128:143], v[92:95], v[144:147], 0
    ds_read_b64_tr_b16 v[88:89], v9 offset:12288
    ds_read_b64_tr_b16 v[90:91], v9 offset:12800
    s_waitcnt lgkmcnt(8)
    v_mfma_f32_32x32x16_bf16 v[112:127], v[96:99], v[148:151], v[112:127]
    ds_read_b64_tr_b16 v[92:93], v10 offset:12288
    ds_read_b64_tr_b16 v[94:95], v10 offset:12800
    s_waitcnt lgkmcnt(8)
    v_mfma_f32_32x32x16_bf16 v[128:143], v[100:103], v[148:151], v[128:143]
    ds_read_b64_tr_b16 v[96:97], v9 offset:16384
    ds_read_b64_tr_b16 v[98:99], v9 offset:16896
    s_waitcnt lgkmcnt(8)
    v_mfma_f32_32x32x16_bf16 v[112:127], v[104:107], v[152:155], v[112:127]
    ds_read_b64_tr_b16 v[100:101], v10 offset:16384
    ds_read_b64_tr_b16 v[102:103], v10 offset:16896
    s_waitcnt lgkmcnt(8)
    v_mfma_f32_32x32x16_bf16 v[128:143], v[108:111], v[152:155], v[128:143]
    ds_read_b64_tr_b16 v[104:105], v9 offset:20480
    ds_read_b64_tr_b16 v[106:107], v9 offset:20992
    s_waitcnt lgkmcnt(8)
    v_mfma_f32_32x32x16_bf16 v[112:127], v[88:91], v[156:159], v[112:127]
    ds_read_b64_tr_b16 v[108:109], v10 offset:20480
    ds_read_b64_tr_b16 v[110:111], v10 offset:20992
    s_waitcnt lgkmcnt(8)
    v_mfma_f32_32x32x16_bf16 v[128:143], v[92:95], v[156:159], v[128:143]
    ds_read_b64_tr_b16 v[88:89], v5 offset:24576
    ds_read_b64_tr_b16 v[90:91], v5 offset:25088
    s_waitcnt lgkmcnt(8)
    v_mfma_f32_32x32x16_bf16 v[112:127], v[96:99], v[160:163], v[112:127]
    ds_read_b64_tr_b16 v[92:93], v6 offset:24576
    ds_read_b64_tr_b16 v[94:95], v6 offset:25088
    s_waitcnt lgkmcnt(8)
    v_mfma_f32_32x32x16_bf16 v[128:143], v[100:103], v[160:163], v[128:143]
    ds_read_b64_tr_b16 v[96:97], v5 offset:28672
    ds_read_b64_tr_b16 v[98:99], v5 offset:29184
    s_waitcnt lgkmcnt(8)
    v_mfma_f32_32x32x16_bf16 v[112:127], v[104:107], v[164:167], v[112:127]
    ds_read_b64_tr_b16 v[100:101], v6 offset:28672
    ds_read_b64_tr_b16 v[102:103], v6 offset:29184
    s_waitcnt lgkmcnt(8)
    v_mfma_f32_32x32x16_bf16 v[128:143], v[108:111], v[164:167], v[128:143]
    s_barrier
    ds_read_b64_tr_b16 v[104:105], v5 offset:32768
    ds_read_b64_tr_b16 v[106:107], v5 offset:33280
    s_waitcnt lgkmcnt(8)
    v_mfma_f32_32x32x16_bf16 v[112:127], v[88:91], v[168:171], v[112:127]
    ds_read_b64_tr_b16 v[108:109], v6 offset:32768
    ds_read_b64_tr_b16 v[110:111], v6 offset:33280
    s_waitcnt lgkmcnt(8)
    v_mfma_f32_32x32x16_bf16 v[128:143], v[92:95], v[168:171], v[128:143]
    ds_read_b64_tr_b16 v[88:89], v5 offset:36864
    ds_read_b64_tr_b16 v[90:91], v5 offset:37376
    s_waitcnt lgkmcnt(8)
    v_mfma_f32_32x32x16_bf16 v[112:127], v[96:99], v[172:175], v[112:127]
    ds_read_b64_tr_b16 v[92:93], v6 offset:36864
    ds_read_b64_tr_b16 v[94:95], v6 offset:37376
    s_waitcnt lgkmcnt(8)
    v_mfma_f32_32x32x16_bf16 v[128:143], v[100:103], v[172:175], v[128:143]
    ds_read_b64_tr_b16 v[96:97], v5 offset:40960
    ds_read_b64_tr_b16 v[98:99], v5 offset:41472
    s_waitcnt lgkmcnt(8)
    v_mfma_f32_32x32x16_bf16 v[112:127], v[104:107], v[176:179], v[112:127]
    ds_read_b64_tr_b16 v[100:101], v6 offset:40960
    ds_read_b64_tr_b16 v[102:103], v6 offset:41472
    s_waitcnt lgkmcnt(8)
    v_mfma_f32_32x32x16_bf16 v[128:143], v[108:111], v[176:179], v[128:143]
    ds_read_b64_tr_b16 v[104:105], v5 offset:45056
    ds_read_b64_tr_b16 v[106:107], v5 offset:45568
    s_waitcnt lgkmcnt(8)
    v_mfma_f32_32x32x16_bf16 v[112:127], v[88:91], v[180:183], v[112:127]
    ds_read_b64_tr_b16 v[108:109], v6 offset:45056
    ds_read_b64_tr_b16 v[110:111], v6 offset:45568
    s_waitcnt lgkmcnt(8)
    v_mfma_f32_32x32x16_bf16 v[128:143], v[92:95], v[180:183], v[128:143]
    ds_read_b64_tr_b16 v[88:89], v5 offset:49152
    ds_read_b64_tr_b16 v[90:91], v5 offset:49664
    s_waitcnt lgkmcnt(8)
    v_mfma_f32_32x32x16_bf16 v[112:127], v[96:99], v[184:187], v[112:127]
    ds_read_b64_tr_b16 v[92:93], v6 offset:49152
    ds_read_b64_tr_b16 v[94:95], v6 offset:49664
    s_waitcnt lgkmcnt(8)
    v_mfma_f32_32x32x16_bf16 v[128:143], v[100:103], v[184:187], v[128:143]
    ds_read_b64_tr_b16 v[96:97], v5 offset:53248
    ds_read_b64_tr_b16 v[98:99], v5 offset:53760
    s_waitcnt lgkmcnt(8)
    v_mfma_f32_32x32x16_bf16 v[112:127], v[104:107], v[188:191], v[112:127]
    ds_read_b64_tr_b16 v[100:101], v6 offset:53248
    ds_read_b64_tr_b16 v[102:103], v6 offset:53760
    s_waitcnt lgkmcnt(8)
    v_mfma_f32_32x32x16_bf16 v[128:143], v[108:111], v[188:191], v[128:143]
    s_waitcnt vmcnt(2) lgkmcnt(0)
    s_barrier
    v_mfma_f32_32x32x16_bf16 v[112:127], v[88:91], v[192:195], v[112:127]
    v_mfma_f32_32x32x16_bf16 v[128:143], v[92:95], v[192:195], v[128:143]
    s_waitcnt vmcnt(0)
    s_lshl_b32 s80, s7, 3
    s_add_u32 s80, s80, s78
    v_mov_b32 v22, s44
    v_mov_b32_e64 v23, s45
    s_mov_b64 exec, 1
    buffer_store_dwordx2 v[22:23], off, s[36:39], s80 sc1
    s_mov_b64 exec, -1
    v_mfma_f32_32x32x16_bf16 v[112:127], v[96:99], v[196:199], v[112:127]
    v_mfma_f32_32x32x16_bf16 v[128:143], v[100:103], v[196:199], v[128:143]
    s_setprio 0
    s_cmp_ge_u32 s3, 4
    s_cbranch_scc1 L_FB4
L_FA4:
    s_setprio 2
    s_nop 0
    ds_read_b64_tr_b16 v[88:89], v5 offset:57344
    ds_read_b64_tr_b16 v[90:91], v5 offset:57856
    ds_read_b64_tr_b16 v[92:93], v6 offset:57344
    ds_read_b64_tr_b16 v[94:95], v6 offset:57856
    ds_read_b64_tr_b16 v[96:97], v5 offset:61440
    ds_read_b64_tr_b16 v[98:99], v5 offset:61952
    ds_read_b64_tr_b16 v[100:101], v6 offset:61440
    ds_read_b64_tr_b16 v[102:103], v6 offset:61952
    ds_read_b64_tr_b16 v[104:105], v7 offset:0
    ds_read_b64_tr_b16 v[106:107], v7 offset:512
    s_waitcnt lgkmcnt(8)
    v_mfma_f32_32x32x16_bf16 v[112:127], v[88:91], v[200:203], v[112:127]
    ds_read_b64_tr_b16 v[108:109], v8 offset:0
    ds_read_b64_tr_b16 v[110:111], v8 offset:512
    s_waitcnt lgkmcnt(8)
    v_mfma_f32_32x32x16_bf16 v[128:143], v[92:95], v[200:203], v[128:143]
    ds_read_b64_tr_b16 v[88:89], v7 offset:4096
    ds_read_b64_tr_b16 v[90:91], v7 offset:4608
    s_waitcnt lgkmcnt(8)
    v_mfma_f32_32x32x16_bf16 v[112:127], v[96:99], v[204:207], v[112:127]
    ds_read_b64_tr_b16 v[92:93], v8 offset:4096
    ds_read_b64_tr_b16 v[94:95], v8 offset:4608
    s_waitcnt lgkmcnt(8)
    v_mfma_f32_32x32x16_bf16 v[128:143], v[100:103], v[204:207], v[128:143]
    ds_read_b64_tr_b16 v[96:97], v7 offset:8192
    ds_read_b64_tr_b16 v[98:99], v7 offset:8704
    s_waitcnt lgkmcnt(8)
    v_mfma_f32_32x32x16_bf16 v[112:127], v[104:107], v[208:211], v[112:127]
    ds_read_b64_tr_b16 v[100:101], v8 offset:8192
    ds_read_b64_tr_b16 v[102:103], v8 offset:8704
    s_waitcnt lgkmcnt(8)
    v_mfma_f32_32x32x16_bf16 v[128:143], v[108:111], v[208:211], v[128:143]
    ds_read_b64_tr_b16 v[104:105], v7 offset:12288
    ds_read_b64_tr_b16 v[106:107], v7 offset:12800
    s_waitcnt lgkmcnt(8)
    v_mfma_f32_32x32x16_bf16 v[112:127], v[88:91], v[212:215], v[112:127]
    ds_read_b64_tr_b16 v[108:109], v8 offset:12288
    ds_read_b64_tr_b16 v[110:111], v8 offset:12800
    s_waitcnt lgkmcnt(8)
    v_mfma_f32_32x32x16_bf16 v[128:143], v[92:95], v[212:215], v[128:143]
    ds_read_b64_tr_b16 v[88:89], v7 offset:16384
    ds_read_b64_tr_b16 v[90:91], v7 offset:16896
    s_waitcnt lgkmcnt(8)
    v_mfma_f32_32x32x16_bf16 v[112:127], v[96:99], v[216:219], v[112:127]
    ds_read_b64_tr_b16 v[92:93], v8 offset:16384
    ds_read_b64_tr_b16 v[94:95], v8 offset:16896
    s_waitcnt lgkmcnt(8)
    v_mfma_f32_32x32x16_bf16 v[128:143], v[100:103], v[216:219], v[128:143]
    ds_read_b64_tr_b16 v[96:97], v7 offset:20480
    ds_read_b64_tr_b16 v[98:99], v7 offset:20992
    s_waitcnt lgkmcnt(8)
    v_mfma_f32_32x32x16_bf16 v[112:127], v[104:107], v[220:223], v[112:127]
    ds_read_b64_tr_b16 v[100:101], v8 offset:20480
    ds_read_b64_tr_b16 v[102:103], v8 offset:20992
    s_waitcnt lgkmcnt(8)
    v_mfma_f32_32x32x16_bf16 v[128:143], v[108:111], v[220:223], v[128:143]
    ds_read_b64_tr_b16 v[104:105], v7 offset:24576
    ds_read_b64_tr_b16 v[106:107], v7 offset:25088
    s_waitcnt lgkmcnt(8)
    v_mfma_f32_32x32x16_bf16 v[112:127], v[88:91], v[224:227], v[112:127]
    ds_read_b64_tr_b16 v[108:109], v8 offset:24576
    ds_read_b64_tr_b16 v[110:111], v8 offset:25088
    s_waitcnt lgkmcnt(8)
    v_mfma_f32_32x32x16_bf16 v[128:143], v[92:95], v[224:227], v[128:143]
    ds_read_b64_tr_b16 v[88:89], v7 offset:28672
    ds_read_b64_tr_b16 v[90:91], v7 offset:29184
    s_waitcnt lgkmcnt(8)
    v_mfma_f32_32x32x16_bf16 v[112:127], v[96:99], v[228:231], v[112:127]
    ds_read_b64_tr_b16 v[92:93], v8 offset:28672
    ds_read_b64_tr_b16 v[94:95], v8 offset:29184
    s_waitcnt lgkmcnt(8)
    v_mfma_f32_32x32x16_bf16 v[128:143], v[100:103], v[228:231], v[128:143]
    ds_read_b64_tr_b16 v[96:97], v7 offset:32768
    ds_read_b64_tr_b16 v[98:99], v7 offset:33280
    s_waitcnt lgkmcnt(8)
    v_mfma_f32_32x32x16_bf16 v[112:127], v[104:107], v[232:235], v[112:127]
    ds_read_b64_tr_b16 v[100:101], v8 offset:32768
    ds_read_b64_tr_b16 v[102:103], v8 offset:33280
    s_waitcnt lgkmcnt(8)
    v_mfma_f32_32x32x16_bf16 v[128:143], v[108:111], v[232:235], v[128:143]
    s_buffer_load_dwordx16 s[84:99], s[36:39], s78 offset:0 glc
    ds_read_b64_tr_b16 v[104:105], v7 offset:36864
    ds_read_b64_tr_b16 v[106:107], v7 offset:37376
    s_waitcnt lgkmcnt(8)
    v_mfma_f32_32x32x16_bf16 v[112:127], v[88:91], v[236:239], v[112:127]
    ds_read_b64_tr_b16 v[108:109], v8 offset:36864
    ds_read_b64_tr_b16 v[110:111], v8 offset:37376
    s_waitcnt lgkmcnt(8)
    v_mfma_f32_32x32x16_bf16 v[128:143], v[92:95], v[236:239], v[128:143]
    ds_read_b64_tr_b16 v[88:89], v7 offset:40960
    ds_read_b64_tr_b16 v[90:91], v7 offset:41472
    s_waitcnt lgkmcnt(8)
    v_mfma_f32_32x32x16_bf16 v[112:127], v[96:99], v[240:243], v[112:127]
    ds_read_b64_tr_b16 v[92:93], v8 offset:40960
    ds_read_b64_tr_b16 v[94:95], v8 offset:41472
    s_waitcnt lgkmcnt(8)
    v_mfma_f32_32x32x16_bf16 v[128:143], v[100:103], v[240:243], v[128:143]
    s_barrier
    ds_read_b64_tr_b16 v[96:97], v7 offset:45056
    ds_read_b64_tr_b16 v[98:99], v7 offset:45568
    s_waitcnt lgkmcnt(8)
    v_mfma_f32_32x32x16_bf16 v[112:127], v[104:107], v[244:247], v[112:127]
    ds_read_b64_tr_b16 v[100:101], v8 offset:45056
    ds_read_b64_tr_b16 v[102:103], v8 offset:45568
    s_waitcnt lgkmcnt(8)
    v_mfma_f32_32x32x16_bf16 v[128:143], v[108:111], v[244:247], v[128:143]
    s_waitcnt lgkmcnt(6)
    v_mfma_f32_32x32x16_bf16 v[112:127], v[88:91], v[248:251], v[112:127]
    s_waitcnt lgkmcnt(4)
    v_mfma_f32_32x32x16_bf16 v[128:143], v[92:95], v[248:251], v[128:143]
    s_waitcnt lgkmcnt(2)
    v_mfma_f32_32x32x16_bf16 v[112:127], v[96:99], v[252:255], v[112:127]
    s_waitcnt lgkmcnt(0)
    v_mfma_f32_32x32x16_bf16 v[128:143], v[100:103], v[252:255], v[128:143]
    s_setprio 0
    s_waitcnt lgkmcnt(0)
    s_cmp_eq_u64 s[84:85], s[44:45]
    s_cbranch_scc0 L_spr26
    s_cmp_eq_u64 s[86:87], s[44:45]
    s_cbranch_scc0 L_spr26
    s_cmp_eq_u64 s[88:89], s[44:45]
    s_cbranch_scc0 L_spr26
    s_cmp_eq_u64 s[90:91], s[44:45]
    s_cbranch_scc0 L_spr26
    s_cmp_eq_u64 s[92:93], s[44:45]
    s_cbranch_scc0 L_spr26
    s_cmp_eq_u64 s[94:95], s[44:45]
    s_cbranch_scc0 L_spr26
    s_cmp_eq_u64 s[96:97], s[44:45]
    s_cbranch_scc0 L_spr26
L_spb27:
    v_mul_f32 v88, v112, v112
    v_mul_f32 v89, v113, v113
    v_mul_f32 v90, v114, v114
    v_mul_f32 v91, v115, v115
    v_mul_f32 v92, v116, v116
    v_mul_f32 v93, v117, v117
    v_mul_f32 v94, v118, v118
    buffer_load_dwordx4 v[144:147], v14, s[36:39], s48 offen offset:0 sc1
    v_mul_f32_e64 v95, v119, v119
    v_fma_f32 v88, v88, v16, v15
    v_fma_f32 v89, v89, v16, v15
    v_fma_f32 v90, v90, v16, v15
    v_fma_f32 v91, v91, v16, v15
    v_fma_f32 v92, v92, v16, v15
    v_fma_f32 v93, v93, v16, v15
    buffer_load_dwordx4 v[148:151], v14, s[36:39], s48 offen offset:1024 sc1
    v_fma_f32 v94, v94, v16, v15
    v_fma_f32 v95, v95, v16, v15
    v_mul_f32 v88, v88, v112
    v_mul_f32 v89, v89, v113
    v_mul_f32 v90, v90, v114
    v_mul_f32 v91, v91, v115
    v_mul_f32_e64 v92, v92, v116
    buffer_load_dwordx4 v[152:155], v14, s[36:39], s49 offen offset:0 sc1
    v_mul_f32 v93, v93, v117
    v_mul_f32 v94, v94, v118
    v_mul_f32 v95, v95, v119
    v_exp_f32 v88, v88
    v_mul_f32 v112, v112, v120
    v_exp_f32 v89, v89
    v_mul_f32_e64 v113, v113, v121
    buffer_load_dwordx4 v[156:159], v14, s[36:39], s49 offen offset:1024 sc1
    v_exp_f32 v90, v90
    v_mul_f32 v114, v114, v122
    v_exp_f32 v91, v91
    v_mul_f32 v115, v115, v123
    v_exp_f32 v92, v92
    v_mul_f32 v116, v116, v124
    v_exp_f32_e64 v93, v93
    buffer_load_dwordx4 v[160:163], v14, s[36:39], s50 offen offset:0 sc1
    v_mul_f32 v117, v117, v125
    v_exp_f32 v94, v94
    v_mul_f32 v118, v118, v126
    v_exp_f32 v95, v95
    v_mul_f32_e64 v119, v119, v127
    v_fma_f32 v88, v88, v17, v17
    v_fma_f32 v89, v89, v17, v17
    buffer_load_dwordx4 v[164:167], v14, s[36:39], s50 offen offset:1024 sc1
    v_fma_f32 v90, v90, v17, v17
    v_fma_f32 v91, v91, v17, v17
    v_fma_f32 v92, v92, v17, v17
    v_fma_f32 v93, v93, v17, v17
    v_fma_f32 v94, v94, v17, v17
    v_fma_f32 v95, v95, v17, v17
    v_rcp_f32_e64 v88, v88
    buffer_load_dwordx4 v[168:171], v14, s[36:39], s51 offen offset:0 sc1
    v_rcp_f32 v89, v89
    v_rcp_f32 v90, v90
    v_rcp_f32 v91, v91
    v_rcp_f32 v92, v92
    v_rcp_f32 v93, v93
    v_rcp_f32 v94, v94
    v_rcp_f32_e64 v95, v95
    buffer_load_dwordx4 v[172:175], v14, s[36:39], s51 offen offset:1024 sc1
    v_mul_f32 v88, v88, v112
    v_mul_f32 v89, v89, v113
    v_mul_f32 v90, v90, v114
    v_mul_f32 v91, v91, v115
    v_mul_f32 v92, v92, v116
    v_mul_f32 v93, v93, v117
    v_mul_f32 v94, v94, v118
    v_mul_f32 v95, v95, v119
    v_cvt_pk_bf16_f32 v48, v88, v89
    v_cvt_pk_bf16_f32 v49, v90, v91
    v_cvt_pk_bf16_f32 v50, v92, v93
    v_cvt_pk_bf16_f32 v51, v94, v95
    s_add_u32 s74, s74, 4096
    s_waitcnt vmcnt(8)
    s_barrier
    buffer_store_dwordx4 v[48:51], v14, s[36:39], s74 offen offset:0 sc1
    v_mul_f32 v96, v128, v128
    v_mul_f32 v97, v129, v129
    v_mul_f32 v98, v130, v130
    v_mul_f32 v99, v131, v131
    v_mul_f32 v100, v132, v132
    v_mul_f32 v101, v133, v133
    v_mul_f32 v102, v134, v134
    v_mul_f32 v103, v135, v135
    v_fma_f32 v96, v96, v16, v15
    v_fma_f32 v97, v97, v16, v15
    buffer_load_dwordx4 v[176:179], v14, s[36:39], s52 offen offset:0 sc1
    v_fma_f32 v98, v98, v16, v15
    v_fma_f32 v99, v99, v16, v15
    v_fma_f32 v100, v100, v16, v15
    v_fma_f32 v101, v101, v16, v15
    v_fma_f32 v102, v102, v16, v15
    v_fma_f32 v103, v103, v16, v15
    v_mul_f32 v96, v96, v128
    v_mul_f32 v97, v97, v129
    v_mul_f32 v98, v98, v130
    v_mul_f32 v99, v99, v131
    v_mul_f32_e64 v100, v100, v132
    buffer_load_dwordx4 v[180:183], v14, s[36:39], s52 offen offset:1024 sc1
    v_mul_f32 v101, v101, v133
    v_mul_f32 v102, v102, v134
    v_mul_f32 v103, v103, v135
    v_exp_f32 v96, v96
    v_mul_f32 v128, v128, v136
    v_exp_f32 v97, v97
    v_mul_f32 v129, v129, v137
    v_exp_f32 v98, v98
    v_mul_f32 v130, v130, v138
    v_exp_f32 v99, v99
    v_mul_f32_e64 v131, v131, v139
    buffer_load_dwordx4 v[184:187], v14, s[36:39], s53 offen offset:0 sc1
    v_exp_f32 v100, v100
    v_mul_f32 v132, v132, v140
    v_exp_f32 v101, v101
    v_mul_f32 v133, v133, v141
    v_exp_f32 v102, v102
    v_mul_f32 v134, v134, v142
    v_exp_f32 v103, v103
    v_mul_f32 v135, v135, v143
    v_fma_f32 v96, v96, v17, v17
    v_fma_f32 v97, v97, v17, v17
    v_fma_f32 v98, v98, v17, v17
    buffer_load_dwordx4 v[188:191], v14, s[36:39], s53 offen offset:1024 sc1
    v_fma_f32 v99, v99, v17, v17
    v_fma_f32 v100, v100, v17, v17
    v_fma_f32 v101, v101, v17, v17
    v_fma_f32 v102, v102, v17, v17
    v_fma_f32 v103, v103, v17, v17
    v_rcp_f32 v96, v96
    v_rcp_f32 v97, v97
    v_rcp_f32 v98, v98
    v_rcp_f32 v99, v99
    v_rcp_f32 v100, v100
    v_rcp_f32 v101, v101
    v_rcp_f32 v102, v102
    v_rcp_f32 v103, v103
    v_mul_f32 v96, v96, v128
    v_mul_f32 v97, v97, v129
    v_mul_f32 v98, v98, v130
    v_mul_f32 v99, v99, v131
    v_mul_f32 v100, v100, v132
    v_mul_f32 v101, v101, v133
    v_mul_f32 v102, v102, v134
    v_mul_f32 v103, v103, v135
    v_cvt_pk_bf16_f32 v52, v96, v97
    v_cvt_pk_bf16_f32 v53, v98, v99
    v_cvt_pk_bf16_f32 v54, v100, v101
    v_cvt_pk_bf16_f32 v55, v102, v103
    buffer_store_dwordx4 v[52:55], v14, s[36:39], s74 offen offset:1024 sc1
    v_lshrrev_b32_e64 v68, 5, v0
    v_bfe_u32 v69, v0, 2, 2
    v_lshl_add_u32 v68, v68, 2, v69
    v_lshlrev_b32_e64 v68, 7, v68
    v_bfe_u32 v69, v0, 3, 1
    v_lshl_add_u32 v68, v69, 6, v68
    v_bfe_u32 v69, v0, 4, 1
    v_lshlrev_b32 v69, 5, v69
    v_and_b32 v70, 3, v0
    v_lshl_add_u32 v70, v70, 3, v69
    s_mul_i32 s80, s4, 0x1040
    v_add_u32 v68, v68, v70
    v_xor_b32 v5, s80, v68
    v_xor_b32_e64 v6, 64, v5
    v_add_u32 v7, 0x10000, v5
    v_add_u32 v8, 0x10000, v6
    v_add_u32 v9, 0x20000, v5
    v_add_u32 v10, 0x20000, v6
    s_setprio 2
    s_nop 0
    ds_read_b64_tr_b16 v[88:89], v7 offset:49152
    ds_read_b64_tr_b16 v[90:91], v7 offset:50176
    ds_read_b64_tr_b16 v[92:93], v8 offset:49152
    ds_read_b64_tr_b16 v[94:95], v8 offset:50176
    ds_read_b64_tr_b16 v[96:97], v7 offset:51200
    ds_read_b64_tr_b16 v[98:99], v7 offset:52224
    ds_read_b64_tr_b16 v[100:101], v8 offset:51200
    ds_read_b64_tr_b16 v[102:103], v8 offset:52224
    ds_read_b64_tr_b16 v[104:105], v7 offset:57344
    ds_read_b64_tr_b16 v[106:107], v7 offset:58368
    s_waitcnt vmcnt(13) lgkmcnt(8)
    v_mfma_f32_32x32x16_bf16 v[112:127], v[88:91], v[144:147], 0
    ds_read_b64_tr_b16 v[108:109], v8 offset:57344
    ds_read_b64_tr_b16 v[110:111], v8 offset:58368
    s_waitcnt lgkmcnt(8)
    v_mfma_f32_32x32x16_bf16 v[128:143], v[92:95], v[144:147], 0
    s_and_b32 s81, s3, 1
    s_lshr_b32 s80, s75, 3
    s_lshl_b32 s80, s80, 1
    s_add_u32 s80, s80, s81
    ds_read_b64_tr_b16 v[88:89], v7 offset:59392
    ds_read_b64_tr_b16 v[90:91], v7 offset:60416
    s_waitcnt vmcnt(12) lgkmcnt(8)
    v_mfma_f32_32x32x16_bf16 v[112:127], v[96:99], v[148:151], v[112:127]
    ds_read_b64_tr_b16 v[92:93], v8 offset:59392
    ds_read_b64_tr_b16 v[94:95], v8 offset:60416
    s_waitcnt lgkmcnt(8)
    v_mfma_f32_32x32x16_bf16 v[128:143], v[100:103], v[148:151], v[128:143]
    s_lshl_b32 s77, s80, 1
    s_add_u32 s77, s77, s4
    s_lshl_b32 s82, s4, 1
    s_add_u32 s81, s81, s82
    ds_read_b64_tr_b16 v[96:97], v9 offset:0
    ds_read_b64_tr_b16 v[98:99], v9 offset:1024
    s_waitcnt vmcnt(11) lgkmcnt(8)
    v_mfma_f32_32x32x16_bf16 v[112:127], v[104:107], v[152:155], v[112:127]
    ds_read_b64_tr_b16 v[100:101], v10 offset:0
    ds_read_b64_tr_b16 v[102:103], v10 offset:1024
    s_waitcnt lgkmcnt(8)
    v_mfma_f32_32x32x16_bf16 v[128:143], v[108:111], v[152:155], v[128:143]
    s_lshl_b32 s82, s81, 11
    v_add_u32 v72, s82, v14
    v_xor_b32 v73, 0x1000, v72
    v_add_u32 v74, 122880, v72
    ds_read_b64_tr_b16 v[104:105], v9 offset:2048
    ds_read_b64_tr_b16 v[106:107], v9 offset:3072
    s_waitcnt vmcnt(10) lgkmcnt(8)
    v_mfma_f32_32x32x16_bf16 v[112:127], v[88:91], v[156:159], v[112:127]
    ds_read_b64_tr_b16 v[108:109], v10 offset:2048
    ds_read_b64_tr_b16 v[110:111], v10 offset:3072
    s_waitcnt lgkmcnt(8)
    v_mfma_f32_32x32x16_bf16 v[128:143], v[92:95], v[156:159], v[128:143]
    v_add_u32 v75, 122880, v73
    s_xor_b32 s80, s75, 0
    s_lshl_b32 s80, s80, 2
    s_add_u32 s80, s80, s81
    ds_read_b64_tr_b16 v[88:89], v9 offset:8192
    ds_read_b64_tr_b16 v[90:91], v9 offset:9216
    s_waitcnt vmcnt(9) lgkmcnt(8)
    v_mfma_f32_32x32x16_bf16 v[112:127], v[96:99], v[160:163], v[112:127]
    ds_read_b64_tr_b16 v[92:93], v10 offset:8192
    ds_read_b64_tr_b16 v[94:95], v10 offset:9216
    s_waitcnt lgkmcnt(8)
    v_mfma_f32_32x32x16_bf16 v[128:143], v[100:103], v[160:163], v[128:143]
    s_lshl_b32 s73, s80, 12
    s_add_u32 s73, s73, 10485760
    s_lshl_b32 s80, s80, 7
    s_add_u32 s47, s80, 17059840
    ds_read_b64_tr_b16 v[96:97], v9 offset:10240
    ds_read_b64_tr_b16 v[98:99], v9 offset:11264
    s_waitcnt vmcnt(8) lgkmcnt(8)
    v_mfma_f32_32x32x16_bf16 v[112:127], v[104:107], v[164:167], v[112:127]
    ds_read_b64_tr_b16 v[100:101], v10 offset:10240
    ds_read_b64_tr_b16 v[102:103], v10 offset:11264
    s_waitcnt lgkmcnt(8)
    v_mfma_f32_32x32x16_bf16 v[128:143], v[108:111], v[164:167], v[128:143]
    s_waitcnt vmcnt(0)
    s_lshl_b32 s80, s7, 3
    s_add_u32 s80, s80, s78
    s_add_u32 s78, s78, 32768
    s_add_u32 s80, s80, 32768
    v_mov_b32 v22, s44
    v_mov_b32_e64 v23, s45
    s_mov_b64 exec, 1
    buffer_store_dwordx2 v[22:23], off, s[36:39], s80 sc1
    s_mov_b64 exec, -1
    ds_read_b64_tr_b16 v[104:105], v9 offset:16384
    ds_read_b64_tr_b16 v[106:107], v9 offset:17408
    s_waitcnt lgkmcnt(8)
    v_mfma_f32_32x32x16_bf16 v[112:127], v[88:91], v[168:171], v[112:127]
    ds_read_b64_tr_b16 v[108:109], v10 offset:16384
    ds_read_b64_tr_b16 v[110:111], v10 offset:17408
    s_waitcnt lgkmcnt(8)
    v_mfma_f32_32x32x16_bf16 v[128:143], v[92:95], v[168:171], v[128:143]
    ds_read_b64_tr_b16 v[88:89], v9 offset:18432
    ds_read_b64_tr_b16 v[90:91], v9 offset:19456
    s_waitcnt lgkmcnt(8)
    v_mfma_f32_32x32x16_bf16 v[112:127], v[96:99], v[172:175], v[112:127]
    ds_read_b64_tr_b16 v[92:93], v10 offset:18432
    ds_read_b64_tr_b16 v[94:95], v10 offset:19456
    s_waitcnt lgkmcnt(8)
    v_mfma_f32_32x32x16_bf16 v[128:143], v[100:103], v[172:175], v[128:143]
    ds_read_b64_tr_b16 v[96:97], v5 offset:0
    ds_read_b64_tr_b16 v[98:99], v5 offset:1024
    s_waitcnt lgkmcnt(8)
    v_mfma_f32_32x32x16_bf16 v[112:127], v[104:107], v[176:179], v[112:127]
    ds_read_b64_tr_b16 v[100:101], v6 offset:0
    ds_read_b64_tr_b16 v[102:103], v6 offset:1024
    s_waitcnt lgkmcnt(8)
    v_mfma_f32_32x32x16_bf16 v[128:143], v[108:111], v[176:179], v[128:143]
    ds_read_b64_tr_b16 v[104:105], v5 offset:2048
    ds_read_b64_tr_b16 v[106:107], v5 offset:3072
    s_waitcnt lgkmcnt(8)
    v_mfma_f32_32x32x16_bf16 v[112:127], v[88:91], v[180:183], v[112:127]
    ds_read_b64_tr_b16 v[108:109], v6 offset:2048
    ds_read_b64_tr_b16 v[110:111], v6 offset:3072
    s_waitcnt lgkmcnt(8)
    v_mfma_f32_32x32x16_bf16 v[128:143], v[92:95], v[180:183], v[128:143]
    ds_read_b64_tr_b16 v[88:89], v5 offset:8192
    ds_read_b64_tr_b16 v[90:91], v5 offset:9216
    s_waitcnt lgkmcnt(8)
    v_mfma_f32_32x32x16_bf16 v[112:127], v[96:99], v[184:187], v[112:127]
    ds_read_b64_tr_b16 v[92:93], v6 offset:8192
    ds_read_b64_tr_b16 v[94:95], v6 offset:9216
    s_waitcnt lgkmcnt(8)
    v_mfma_f32_32x32x16_bf16 v[128:143], v[100:103], v[184:187], v[128:143]
    ds_read_b64_tr_b16 v[96:97], v5 offset:10240
    ds_read_b64_tr_b16 v[98:99], v5 offset:11264
    s_waitcnt lgkmcnt(8)
    v_mfma_f32_32x32x16_bf16 v[112:127], v[104:107], v[188:191], v[112:127]
    ds_read_b64_tr_b16 v[100:101], v6 offset:10240
    ds_read_b64_tr_b16 v[102:103], v6 offset:11264
    s_waitcnt lgkmcnt(8)
    v_mfma_f32_32x32x16_bf16 v[128:143], v[108:111], v[188:191], v[128:143]
    s_waitcnt lgkmcnt(6)
    v_mfma_f32_32x32x16_bf16 v[112:127], v[88:91], v[40:43], v[112:127]
    s_waitcnt lgkmcnt(4)
    v_mfma_f32_32x32x16_bf16 v[128:143], v[92:95], v[40:43], v[128:143]
    s_waitcnt lgkmcnt(2)
    v_mfma_f32_32x32x16_bf16 v[112:127], v[96:99], v[44:47], v[112:127]
    s_waitcnt lgkmcnt(0)
    v_mfma_f32_32x32x16_bf16 v[128:143], v[100:103], v[44:47], v[128:143]
    s_setprio 0
    s_add_u32 m0, s100, 57344
    s_add_u32 s80, s61, 57344
    buffer_load_dwordx4 v4, s[28:31], s80 offen  lds
    s_add_u32 m0, s100, 61440
    s_add_u32 s80, s61, 86016
    buffer_load_dwordx4 v4, s[28:31], s80 offen  lds
    s_lshl_b32 s81, s54, 13
    s_add_u32 s81, s81, s100
    s_mul_i32 s82, s54, 57344
    s_add_u32 s82, s82, s67
    s_add_u32 s54, s54, 1
    s_cmp_eq_u32 s54, 6
    s_cselect_b32 s54, 0, s54
    s_add_u32 m0, s81, 65536
    s_add_u32 s80, s82, 0
    buffer_load_dwordx4 v4, s[20:23], s80 offen lds
    s_add_u32 m0, s81, 69632
    s_add_u32 s80, s82, 28672
    buffer_load_dwordx4 v4, s[20:23], s80 offen lds
    s_lshl_b32 s81, s54, 13
    s_add_u32 s81, s81, s100
    s_mul_i32 s82, s54, 57344
    s_add_u32 s82, s82, s67
    s_add_u32 s54, s54, 1
    s_cmp_eq_u32 s54, 6
    s_cselect_b32 s54, 0, s54
    s_add_u32 m0, s81, 65536
    s_add_u32 s80, s82, 0
    buffer_load_dwordx4 v4, s[20:23], s80 offen lds
    s_add_u32 m0, s81, 69632
    s_add_u32 s80, s82, 28672
    buffer_load_dwordx4 v4, s[20:23], s80 offen lds
    s_buffer_load_dwordx16 s[84:99], s[36:39], s78 offset:0 glc
    s_lshl_b32 s81, s54, 13
    s_add_u32 s81, s81, s100
    s_mul_i32 s82, s54, 57344
    s_add_u32 s82, s82, s67
    s_add_u32 s54, s54, 1
    s_cmp_eq_u32 s54, 6
    s_cselect_b32 s54, 0, s54
    s_add_u32 m0, s81, 65536
    s_add_u32 s80, s82, 0
    buffer_load_dwordx4 v4, s[20:23], s80 offen lds
    s_add_u32 m0, s81, 69632
    s_add_u32 s80, s82, 28672
    buffer_load_dwordx4 v4, s[20:23], s80 offen lds
    s_lshl_b32 s81, s54, 13
    s_add_u32 s81, s81, s100
    s_mul_i32 s82, s54, 57344
    s_add_u32 s82, s82, s67
    s_add_u32 s54, s54, 1
    s_cmp_eq_u32 s54, 6
    s_cselect_b32 s54, 0, s54
    s_add_u32 m0, s81, 65536
    s_add_u32 s80, s82, 0
    buffer_load_dwordx4 v4, s[20:23], s80 offen lds
    s_add_u32 m0, s81, 69632
    s_add_u32 s80, s82, 28672
    buffer_load_dwordx4 v4, s[20:23], s80 offen lds
    s_lshl_b32 s81, s54, 13
    s_add_u32 s81, s81, s100
    s_mul_i32 s82, s54, 57344
    s_add_u32 s82, s82, s67
    s_add_u32 s54, s54, 1
    s_cmp_eq_u32 s54, 6
    s_cselect_b32 s54, 0, s54
    s_add_u32 m0, s81, 65536
    s_add_u32 s80, s82, 0
    buffer_load_dwordx4 v4, s[20:23], s80 offen lds
    s_add_u32 m0, s81, 69632
    s_add_u32 s80, s82, 28672
    buffer_load_dwordx4 v4, s[20:23], s80 offen lds
    s_lshl_b32 s81, s54, 13
    s_add_u32 s81, s81, s100
    s_mul_i32 s82, s54, 57344
    s_add_u32 s82, s82, s67
    s_add_u32 s54, s54, 1
    s_cmp_eq_u32 s54, 6
    s_cselect_b32 s54, 0, s54
    s_add_u32 m0, s81, 65536
    s_add_u32 s80, s82, 0
    buffer_load_dwordx4 v4, s[20:23], s80 offen lds
    s_add_u32 m0, s81, 69632
    s_add_u32 s80, s82, 28672
    buffer_load_dwordx4 v4, s[20:23], s80 offen lds
    s_barrier
    s_nop 0
    s_add_u32 m0, s100, 114688
    s_add_u32 s80, s67, 344064
    buffer_load_dwordx4 v4, s[20:23], s80 offen  lds
    s_add_u32 m0, s100, 118784
    s_add_u32 s80, s67, 372736
    buffer_load_dwordx4 v4, s[20:23], s80 offen  lds
    s_waitcnt lgkmcnt(0)
    s_cmp_eq_u64 s[84:85], s[44:45]
    s_cbranch_scc0 L_spr30
    s_cmp_eq_u64 s[86:87], s[44:45]
    s_cbranch_scc0 L_spr30
    s_cmp_eq_u64 s[88:89], s[44:45]
    s_cbranch_scc0 L_spr30
    s_cmp_eq_u64 s[90:91], s[44:45]
    s_cbranch_scc0 L_spr30
    s_cmp_eq_u64 s[92:93], s[44:45]
    s_cbranch_scc0 L_spr30
    s_cmp_eq_u64 s[94:95], s[44:45]
    s_cbranch_scc0 L_spr30
    s_cmp_eq_u64 s[96:97], s[44:45]
    s_cbranch_scc0 L_spr30
L_spb31:
    s_setprio 3
    s_add_u32 s80, s48, 4096
    buffer_load_dwordx4 v[200:203], v14, s[36:39], s80 offen offset:0 sc1
    buffer_load_dwordx4 v[204:207], v14, s[36:39], s80 offen offset:1024 sc1
    s_add_u32 s80, s49, 4096
    buffer_load_dwordx4 v[208:211], v14, s[36:39], s80 offen offset:0 sc1
    buffer_load_dwordx4 v[212:215], v14, s[36:39], s80 offen offset:1024 sc1
    s_add_u32 s80, s50, 4096
    buffer_load_dwordx4 v[216:219], v14, s[36:39], s80 offen offset:0 sc1
    buffer_load_dwordx4 v[220:223], v14, s[36:39], s80 offen offset:1024 sc1
    s_add_u32 s80, s51, 4096
    buffer_load_dwordx4 v[224:227], v14, s[36:39], s80 offen offset:0 sc1
    buffer_load_dwordx4 v[228:231], v14, s[36:39], s80 offen offset:1024 sc1
    s_add_u32 s80, s52, 4096
    buffer_load_dwordx4 v[232:235], v14, s[36:39], s80 offen offset:0 sc1
    buffer_load_dwordx4 v[236:239], v14, s[36:39], s80 offen offset:1024 sc1
    s_add_u32 s80, s53, 4096
    buffer_load_dwordx4 v[240:243], v14, s[36:39], s80 offen offset:0 sc1
    buffer_load_dwordx4 v[244:247], v14, s[36:39], s80 offen offset:1024 sc1
    s_waitcnt vmcnt(12)
    s_barrier
    s_lshl_b32 s83, s77, 14
    s_add_u32 s83, s83, 8388608
    s_lshl_b32 s77, s77, 7
    s_add_u32 s77, s77, 17039360
    s_setprio 2
    s_nop 0
    ds_read_b64_tr_b16 v[88:89], v5 offset:16384
    ds_read_b64_tr_b16 v[90:91], v5 offset:17408
    ds_read_b64_tr_b16 v[92:93], v6 offset:16384
    ds_read_b64_tr_b16 v[94:95], v6 offset:17408
    ds_read_b64_tr_b16 v[96:97], v5 offset:18432
    ds_read_b64_tr_b16 v[98:99], v5 offset:19456
    ds_read_b64_tr_b16 v[100:101], v6 offset:18432
    ds_read_b64_tr_b16 v[102:103], v6 offset:19456
    ds_read_b64_tr_b16 v[104:105], v5 offset:24576
    ds_read_b64_tr_b16 v[106:107], v5 offset:25600
    s_waitcnt vmcnt(11) lgkmcnt(8)
    v_mfma_f32_32x32x16_bf16 v[112:127], v[88:91], v[200:203], v[112:127]
    ds_read_b64_tr_b16 v[108:109], v6 offset:24576
    ds_read_b64_tr_b16 v[110:111], v6 offset:25600
    s_waitcnt lgkmcnt(8)
    v_mfma_f32_32x32x16_bf16 v[128:143], v[92:95], v[200:203], v[128:143]
    ds_read_b64_tr_b16 v[88:89], v5 offset:26624
    ds_read_b64_tr_b16 v[90:91], v5 offset:27648
    s_waitcnt vmcnt(10) lgkmcnt(8)
    v_mfma_f32_32x32x16_bf16 v[112:127], v[96:99], v[204:207], v[112:127]
    ds_read_b64_tr_b16 v[92:93], v6 offset:26624
    ds_read_b64_tr_b16 v[94:95], v6 offset:27648
    s_waitcnt lgkmcnt(8)
    v_mfma_f32_32x32x16_bf16 v[128:143], v[100:103], v[204:207], v[128:143]
    ds_read_b64_tr_b16 v[96:97], v5 offset:32768
    ds_read_b64_tr_b16 v[98:99], v5 offset:33792
    s_waitcnt vmcnt(9) lgkmcnt(8)
    v_mfma_f32_32x32x16_bf16 v[112:127], v[104:107], v[208:211], v[112:127]
    ds_read_b64_tr_b16 v[100:101], v6 offset:32768
    ds_read_b64_tr_b16 v[102:103], v6 offset:33792
    s_waitcnt lgkmcnt(8)
    v_mfma_f32_32x32x16_bf16 v[128:143], v[108:111], v[208:211], v[128:143]
    ds_read_b64_tr_b16 v[104:105], v5 offset:34816
    ds_read_b64_tr_b16 v[106:107], v5 offset:35840
    s_waitcnt vmcnt(8) lgkmcnt(8)
    v_mfma_f32_32x32x16_bf16 v[112:127], v[88:91], v[212:215], v[112:127]
    ds_read_b64_tr_b16 v[108:109], v6 offset:34816
    ds_read_b64_tr_b16 v[110:111], v6 offset:35840
    s_waitcnt lgkmcnt(8)
    v_mfma_f32_32x32x16_bf16 v[128:143], v[92:95], v[212:215], v[128:143]
    ds_read_b64_tr_b16 v[88:89], v5 offset:40960
    ds_read_b64_tr_b16 v[90:91], v5 offset:41984
    s_waitcnt vmcnt(7) lgkmcnt(8)
    v_mfma_f32_32x32x16_bf16 v[112:127], v[96:99], v[216:219], v[112:127]
    ds_read_b64_tr_b16 v[92:93], v6 offset:40960
    ds_read_b64_tr_b16 v[94:95], v6 offset:41984
    s_waitcnt lgkmcnt(8)
    v_mfma_f32_32x32x16_bf16 v[128:143], v[100:103], v[216:219], v[128:143]
    ds_read_b64_tr_b16 v[96:97], v5 offset:43008
    ds_read_b64_tr_b16 v[98:99], v5 offset:44032
    s_waitcnt vmcnt(6) lgkmcnt(8)
    v_mfma_f32_32x32x16_bf16 v[112:127], v[104:107], v[220:223], v[112:127]
    ds_read_b64_tr_b16 v[100:101], v6 offset:43008
    ds_read_b64_tr_b16 v[102:103], v6 offset:44032
    s_waitcnt lgkmcnt(8)
    v_mfma_f32_32x32x16_bf16 v[128:143], v[108:111], v[220:223], v[128:143]
    ds_read_b64_tr_b16 v[104:105], v5 offset:49152
    ds_read_b64_tr_b16 v[106:107], v5 offset:50176
    s_waitcnt vmcnt(5) lgkmcnt(8)
    v_mfma_f32_32x32x16_bf16 v[112:127], v[88:91], v[224:227], v[112:127]
    ds_read_b64_tr_b16 v[108:109], v6 offset:49152
    ds_read_b64_tr_b16 v[110:111], v6 offset:50176
    s_waitcnt lgkmcnt(8)
    v_mfma_f32_32x32x16_bf16 v[128:143], v[92:95], v[224:227], v[128:143]
    ds_read_b64_tr_b16 v[88:89], v5 offset:51200
    ds_read_b64_tr_b16 v[90:91], v5 offset:52224
    s_waitcnt vmcnt(4) lgkmcnt(8)
    v_mfma_f32_32x32x16_bf16 v[112:127], v[96:99], v[228:231], v[112:127]
    ds_read_b64_tr_b16 v[92:93], v6 offset:51200
    ds_read_b64_tr_b16 v[94:95], v6 offset:52224
    s_waitcnt lgkmcnt(8)
    v_mfma_f32_32x32x16_bf16 v[128:143], v[100:103], v[228:231], v[128:143]
    ds_read_b64_tr_b16 v[96:97], v9 offset:24576
    ds_read_b64_tr_b16 v[98:99], v9 offset:25600
    s_waitcnt vmcnt(3) lgkmcnt(8)
    v_mfma_f32_32x32x16_bf16 v[112:127], v[104:107], v[232:235], v[112:127]
    ds_read_b64_tr_b16 v[100:101], v10 offset:24576
    ds_read_b64_tr_b16 v[102:103], v10 offset:25600
    s_waitcnt lgkmcnt(8)
    v_mfma_f32_32x32x16_bf16 v[128:143], v[108:111], v[232:235], v[128:143]
    ds_read_b64_tr_b16 v[104:105], v9 offset:26624
    ds_read_b64_tr_b16 v[106:107], v9 offset:27648
    s_waitcnt vmcnt(2) lgkmcnt(8)
    v_mfma_f32_32x32x16_bf16 v[112:127], v[88:91], v[236:239], v[112:127]
    ds_read_b64_tr_b16 v[108:109], v10 offset:26624
    ds_read_b64_tr_b16 v[110:111], v10 offset:27648
    s_waitcnt lgkmcnt(8)
    v_mfma_f32_32x32x16_bf16 v[128:143], v[92:95], v[236:239], v[128:143]
    ds_read_b64_tr_b16 v[88:89], v5 offset:57344
    ds_read_b64_tr_b16 v[90:91], v5 offset:58368
    s_waitcnt vmcnt(1) lgkmcnt(8)
    v_mfma_f32_32x32x16_bf16 v[112:127], v[96:99], v[240:243], v[112:127]
    ds_read_b64_tr_b16 v[92:93], v6 offset:57344
    ds_read_b64_tr_b16 v[94:95], v6 offset:58368
    s_waitcnt lgkmcnt(8)
    v_mfma_f32_32x32x16_bf16 v[128:143], v[100:103], v[240:243], v[128:143]
    ds_read_b64_tr_b16 v[96:97], v5 offset:59392
    ds_read_b64_tr_b16 v[98:99], v5 offset:60416
    s_waitcnt vmcnt(0) lgkmcnt(8)
    v_mfma_f32_32x32x16_bf16 v[112:127], v[104:107], v[244:247], v[112:127]
    ds_read_b64_tr_b16 v[100:101], v6 offset:59392
    ds_read_b64_tr_b16 v[102:103], v6 offset:60416
    s_waitcnt lgkmcnt(8)
    v_mfma_f32_32x32x16_bf16 v[128:143], v[108:111], v[244:247], v[128:143]
    s_waitcnt lgkmcnt(6)
    v_mfma_f32_32x32x16_bf16 v[112:127], v[88:91], v[48:51], v[112:127]
    s_waitcnt lgkmcnt(4)
    v_mfma_f32_32x32x16_bf16 v[128:143], v[92:95], v[48:51], v[128:143]
    s_waitcnt lgkmcnt(2)
    v_mfma_f32_32x32x16_bf16 v[112:127], v[96:99], v[52:55], v[112:127]
    s_waitcnt lgkmcnt(0)
    v_mfma_f32_32x32x16_bf16 v[128:143], v[100:103], v[52:55], v[128:143]
    s_setprio 0
    s_setprio 3
    s_nop 9
    ds_write_b128 v72, v[128:131] offset:0
    ds_write_b128 v72, v[132:135] offset:1024
    ds_write_b128 v72, v[136:139] offset:8192
    ds_write_b128 v72, v[140:143] offset:9216
    s_waitcnt lgkmcnt(0)
    s_barrier
    ds_read_b128 v[128:131], v73 offset:0
    ds_read_b128 v[132:135], v73 offset:1024
    ds_read_b128 v[136:139], v73 offset:8192
    ds_read_b128 v[140:143], v73 offset:9216
    s_waitcnt lgkmcnt(2)
    v_add_f32 v112, v112, v128
    v_add_f32 v113, v113, v129
    v_add_f32 v114, v114, v130
    v_add_f32 v115, v115, v131
    v_add_f32 v116, v116, v132
    v_add_f32 v117, v117, v133
    v_add_f32 v118, v118, v134
    v_add_f32 v119, v119, v135
    v_cvt_pk_bf16_f32 v24, v112, v113
    v_cvt_pk_bf16_f32 v25, v114, v115
    v_cvt_pk_bf16_f32 v26, v116, v117
    v_cvt_pk_bf16_f32 v27, v118, v119
    buffer_store_dwordx4 v[24:27], v14, s[36:39], s73 offen offset:0 sc1
    s_waitcnt lgkmcnt(0)
    v_add_f32 v120, v120, v136
    v_add_f32 v121, v121, v137
    v_add_f32 v122, v122, v138
    v_add_f32 v123, v123, v139
    v_add_f32 v124, v124, v140
    v_add_f32 v125, v125, v141
    v_add_f32 v126, v126, v142
    v_add_f32_e64 v127, v127, v143
    v_cvt_pk_bf16_f32 v28, v120, v121
    v_cvt_pk_bf16_f32 v29, v122, v123
    v_cvt_pk_bf16_f32 v30, v124, v125
    v_cvt_pk_bf16_f32 v31, v126, v127
    buffer_store_dwordx4 v[28:31], v14, s[36:39], s73 offen offset:1024 sc1
    s_buffer_load_dwordx8 s[84:91], s[36:39], s77 offset:0 glc
    s_setprio 0
    s_mul_i32 s80, s4, 24576
    s_add_u32 s80, s80, 65536
    v_add_u32 v5, s80, v5
    v_add_u32 v6, s80, v6
    v_lshrrev_b32 v64, 5, v0
    v_bfe_u32 v65, v0, 3, 1
    v_xor_b32 v66, v64, v65
    v_lshlrev_b32 v66, 6, v66
    v_add_u32 v64, v64, v65
    v_lshlrev_b32 v64, 8, v64
    v_xor_b32 v7, v5, v66
    v_sub_u32 v7, v7, v64
    v_xor_b32 v8, 64, v7
    s_waitcnt lgkmcnt(0)
    s_cmp_eq_u64 s[84:85], s[44:45]
    s_cbranch_scc0 L_oslow
    s_cmp_eq_u64 s[86:87], s[44:45]
    s_cbranch_scc0 L_oslow
    s_cmp_eq_u64 s[88:89], s[44:45]
    s_cbranch_scc0 L_oslow
    s_cmp_eq_u64 s[90:91], s[44:45]
    s_cbranch_scc0 L_oslow
    buffer_load_dwordx4 v[144:147], v14, s[36:39], s83 offen offset:0 sc1
    buffer_load_dwordx4 v[148:151], v14, s[36:39], s83 offen offset:1024 sc1
    buffer_load_dwordx4 v[152:155], v14, s[36:39], s83 offen offset:2048 sc1
    buffer_load_dwordx4 v[156:159], v14, s[36:39], s83 offen offset:3072 sc1
    s_add_u32 s83, s83, 4096
    buffer_load_dwordx4 v[160:163], v14, s[36:39], s83 offen offset:0 sc1
    buffer_load_dwordx4 v[164:167], v14, s[36:39], s83 offen offset:1024 sc1
    buffer_load_dwordx4 v[168:171], v14, s[36:39], s83 offen offset:2048 sc1
    buffer_load_dwordx4 v[172:175], v14, s[36:39], s83 offen offset:3072 sc1
    s_add_u32 s83, s83, 4096
    buffer_load_dwordx4 v[176:179], v14, s[36:39], s83 offen offset:0 sc1
    buffer_load_dwordx4 v[180:183], v14, s[36:39], s83 offen offset:1024 sc1
    buffer_load_dwordx4 v[184:187], v14, s[36:39], s83 offen offset:2048 sc1
    s_waitcnt vmcnt(11)
    v_mov_b32 v22, s44
    v_mov_b32 v23, s45
    s_mov_b64 exec, 1
    buffer_store_dwordx2 v[22:23], off, s[36:39], s47 sc1
    s_mov_b64 exec, -1
    s_barrier
L_ojoin:
    s_setprio 2
    s_nop 0
    ds_read_b64_tr_b16 v[88:89], v5 offset:0
    ds_read_b64_tr_b16 v[90:91], v5 offset:1024
    ds_read_b64_tr_b16 v[92:93], v6 offset:0
    ds_read_b64_tr_b16 v[94:95], v6 offset:1024
    ds_read_b64_tr_b16 v[96:97], v5 offset:2048
    ds_read_b64_tr_b16 v[98:99], v7 offset:3072
    ds_read_b64_tr_b16 v[100:101], v6 offset:2048
    ds_read_b64_tr_b16 v[102:103], v8 offset:3072
    ds_read_b64_tr_b16 v[104:105], v5 offset:3584
    ds_read_b64_tr_b16 v[106:107], v5 offset:4608
    s_waitcnt vmcnt(10) lgkmcnt(8)
    v_mfma_f32_32x32x16_bf16 v[112:127], v[88:91], v[144:147], 0
    ds_read_b64_tr_b16 v[108:109], v6 offset:3584
    ds_read_b64_tr_b16 v[110:111], v6 offset:4608
    s_waitcnt lgkmcnt(8)
    v_mfma_f32_32x32x16_bf16 v[128:143], v[92:95], v[144:147], 0
    buffer_load_dwordx4 v[188:191], v14, s[36:39], s83 offen offset:3072 sc1
    ds_read_b64_tr_b16 v[88:89], v5 offset:5632
    ds_read_b64_tr_b16 v[90:91], v7 offset:6656
    s_waitcnt vmcnt(10) lgkmcnt(8)
    v_mfma_f32_32x32x16_bf16 v[112:127], v[96:99], v[148:151], v[112:127]
    ds_read_b64_tr_b16 v[92:93], v6 offset:5632
    ds_read_b64_tr_b16 v[94:95], v8 offset:6656
    s_waitcnt lgkmcnt(8)
    v_mfma_f32_32x32x16_bf16 v[128:143], v[100:103], v[148:151], v[128:143]
    s_add_u32 s83, s83, 4096
    buffer_load_dwordx4 v[192:195], v14, s[36:39], s83 offen offset:0 sc1
    ds_read_b64_tr_b16 v[96:97], v5 offset:7168
    ds_read_b64_tr_b16 v[98:99], v5 offset:8192
    s_waitcnt vmcnt(10) lgkmcnt(8)
    v_mfma_f32_32x32x16_bf16 v[112:127], v[104:107], v[152:155], v[112:127]
    ds_read_b64_tr_b16 v[100:101], v6 offset:7168
    ds_read_b64_tr_b16 v[102:103], v6 offset:8192
    s_waitcnt lgkmcnt(8)
    v_mfma_f32_32x32x16_bf16 v[128:143], v[108:111], v[152:155], v[128:143]
    buffer_load_dwordx4 v[196:199], v14, s[36:39], s83 offen offset:1024 sc1
    ds_read_b64_tr_b16 v[104:105], v5 offset:9216
    ds_read_b64_tr_b16 v[106:107], v7 offset:10240
    s_waitcnt vmcnt(10) lgkmcnt(8)
    v_mfma_f32_32x32x16_bf16 v[112:127], v[88:91], v[156:159], v[112:127]
    ds_read_b64_tr_b16 v[108:109], v6 offset:9216
    ds_read_b64_tr_b16 v[110:111], v8 offset:10240
    s_waitcnt lgkmcnt(8)
    v_mfma_f32_32x32x16_bf16 v[128:143], v[92:95], v[156:159], v[128:143]
    buffer_load_dwordx4 v[200:203], v14, s[36:39], s83 offen offset:2048 sc1
    ds_read_b64_tr_b16 v[88:89], v5 offset:10752
    ds_read_b64_tr_b16 v[90:91], v5 offset:11776
    s_waitcnt vmcnt(10) lgkmcnt(8)
    v_mfma_f32_32x32x16_bf16 v[112:127], v[96:99], v[160:163], v[112:127]
    ds_read_b64_tr_b16 v[92:93], v6 offset:10752
    ds_read_b64_tr_b16 v[94:95], v6 offset:11776
    s_waitcnt lgkmcnt(8)
    v_mfma_f32_32x32x16_bf16 v[128:143], v[100:103], v[160:163], v[128:143]
    buffer_load_dwordx4 v[204:207], v14, s[36:39], s83 offen offset:3072 sc1
    ds_read_b64_tr_b16 v[96:97], v5 offset:12800
    ds_read_b64_tr_b16 v[98:99], v7 offset:13824
    s_waitcnt vmcnt(10) lgkmcnt(8)
    v_mfma_f32_32x32x16_bf16 v[112:127], v[104:107], v[164:167], v[112:127]
    ds_read_b64_tr_b16 v[100:101], v6 offset:12800
    ds_read_b64_tr_b16 v[102:103], v8 offset:13824
    s_waitcnt lgkmcnt(8)
    v_mfma_f32_32x32x16_bf16 v[128:143], v[108:111], v[164:167], v[128:143]
    ds_read_b64_tr_b16 v[104:105], v5 offset:14336
    ds_read_b64_tr_b16 v[106:107], v5 offset:15360
    s_waitcnt vmcnt(9) lgkmcnt(8)
    v_mfma_f32_32x32x16_bf16 v[112:127], v[88:91], v[168:171], v[112:127]
    ds_read_b64_tr_b16 v[108:109], v6 offset:14336
    ds_read_b64_tr_b16 v[110:111], v6 offset:15360
    s_waitcnt lgkmcnt(8)
    v_mfma_f32_32x32x16_bf16 v[128:143], v[92:95], v[168:171], v[128:143]
    ds_read_b64_tr_b16 v[88:89], v5 offset:16384
    ds_read_b64_tr_b16 v[90:91], v7 offset:17408
    s_waitcnt vmcnt(8) lgkmcnt(8)
    v_mfma_f32_32x32x16_bf16 v[112:127], v[96:99], v[172:175], v[112:127]
    ds_read_b64_tr_b16 v[92:93], v6 offset:16384
    ds_read_b64_tr_b16 v[94:95], v8 offset:17408
    s_waitcnt lgkmcnt(8)
    v_mfma_f32_32x32x16_bf16 v[128:143], v[100:103], v[172:175], v[128:143]
    ds_read_b64_tr_b16 v[96:97], v5 offset:17920
    ds_read_b64_tr_b16 v[98:99], v5 offset:18944
    s_waitcnt vmcnt(7) lgkmcnt(8)
    v_mfma_f32_32x32x16_bf16 v[112:127], v[104:107], v[176:179], v[112:127]
    ds_read_b64_tr_b16 v[100:101], v6 offset:17920
    ds_read_b64_tr_b16 v[102:103], v6 offset:18944
    s_waitcnt lgkmcnt(8)
    v_mfma_f32_32x32x16_bf16 v[128:143], v[108:111], v[176:179], v[128:143]
    ds_read_b64_tr_b16 v[104:105], v5 offset:19968
    ds_read_b64_tr_b16 v[106:107], v7 offset:20992
    s_waitcnt vmcnt(6) lgkmcnt(8)
    v_mfma_f32_32x32x16_bf16 v[112:127], v[88:91], v[180:183], v[112:127]
    ds_read_b64_tr_b16 v[108:109], v6 offset:19968
    ds_read_b64_tr_b16 v[110:111], v8 offset:20992
    s_waitcnt lgkmcnt(8)
    v_mfma_f32_32x32x16_bf16 v[128:143], v[92:95], v[180:183], v[128:143]
    ds_read_b64_tr_b16 v[88:89], v5 offset:21504
    ds_read_b64_tr_b16 v[90:91], v5 offset:22528
    s_waitcnt vmcnt(5) lgkmcnt(8)
    v_mfma_f32_32x32x16_bf16 v[112:127], v[96:99], v[184:187], v[112:127]
    ds_read_b64_tr_b16 v[92:93], v6 offset:21504
    ds_read_b64_tr_b16 v[94:95], v6 offset:22528
    s_waitcnt lgkmcnt(8)
    v_mfma_f32_32x32x16_bf16 v[128:143], v[100:103], v[184:187], v[128:143]
    ds_read_b64_tr_b16 v[96:97], v5 offset:23552
    ds_read_b64_tr_b16 v[98:99], v7 offset:24576
    s_waitcnt vmcnt(4) lgkmcnt(8)
    v_mfma_f32_32x32x16_bf16 v[112:127], v[104:107], v[188:191], v[112:127]
    ds_read_b64_tr_b16 v[100:101], v6 offset:23552
    ds_read_b64_tr_b16 v[102:103], v8 offset:24576
    s_waitcnt lgkmcnt(8)
    v_mfma_f32_32x32x16_bf16 v[128:143], v[108:111], v[188:191], v[128:143]
    ds_read_b64_tr_b16 v[104:105], v5 offset:25088
    ds_read_b64_tr_b16 v[106:107], v5 offset:26112
    s_waitcnt vmcnt(3) lgkmcnt(8)
    v_mfma_f32_32x32x16_bf16 v[112:127], v[88:91], v[192:195], v[112:127]
    ds_read_b64_tr_b16 v[108:109], v6 offset:25088
    ds_read_b64_tr_b16 v[110:111], v6 offset:26112
    s_waitcnt lgkmcnt(8)
    v_mfma_f32_32x32x16_bf16 v[128:143], v[92:95], v[192:195], v[128:143]
    ds_read_b64_tr_b16 v[88:89], v5 offset:27136
    ds_read_b64_tr_b16 v[90:91], v7 offset:28160
    s_waitcnt vmcnt(2) lgkmcnt(8)
    v_mfma_f32_32x32x16_bf16 v[112:127], v[96:99], v[196:199], v[112:127]
    ds_read_b64_tr_b16 v[92:93], v6 offset:27136
    ds_read_b64_tr_b16 v[94:95], v8 offset:28160
    s_waitcnt lgkmcnt(8)
    v_mfma_f32_32x32x16_bf16 v[128:143], v[100:103], v[196:199], v[128:143]
    s_waitcnt vmcnt(1) lgkmcnt(6)
    v_mfma_f32_32x32x16_bf16 v[112:127], v[104:107], v[200:203], v[112:127]
    s_waitcnt lgkmcnt(4)
    v_mfma_f32_32x32x16_bf16 v[128:143], v[108:111], v[200:203], v[128:143]
    s_waitcnt vmcnt(0) lgkmcnt(2)
    v_mfma_f32_32x32x16_bf16 v[112:127], v[88:91], v[204:207], v[112:127]
    s_waitcnt lgkmcnt(0)
    v_mfma_f32_32x32x16_bf16 v[128:143], v[92:95], v[204:207], v[128:143]
    s_setprio 0
    s_nop 10
    ds_write_b128 v73, v[128:131] offset:0
    ds_write_b128 v73, v[132:135] offset:1024
    ds_write_b128 v73, v[136:139] offset:8192
    ds_write_b128 v73, v[140:143] offset:9216
    ds_write_b128 v74, v[112:115] offset:16384
    ds_write_b128 v74, v[116:119] offset:17408
    ds_write_b128 v74, v[120:123] offset:24576
    ds_write_b128 v74, v[124:127] offset:25600
    s_waitcnt lgkmcnt(0)
    s_barrier
    s_endpgm
L_rare3:
    s_nop 1
    s_or_b32 s81, s45, 0x80000000
    v_mov_b32 v60, s44
    v_mov_b32 v61, s81
    v_mov_b32 v62, 0
    s_mov_b64 exec, 1
    global_store_dwordx2 v62, v[60:61], s[40:41] sc1
    s_mov_b64 exec, -1
    s_nop 1
    s_branch L_back4
L_rare5:
    s_nop 1
    s_mov_b32 s24, s50
    s_mov_b32 s25, s51
    s_mov_b32 s26, 1204224
    s_mov_b32 s71, 86016
    s_mul_i32 s95, s42, 3
    s_add_u32 s95, s95, s81
    s_lshl_b32 s95, s95, 7
    s_lshl_b32 s81, s81, 2
    v_add_u32 v83, s81, v80
    v_min_u32 v83, 13, v83
    v_mul_u32_u24 v2, 2688, v81
    s_mul_i32 s101, s42, 448
    s_add_u32 s72, s101, 224
    s_mov_b32 s94, 7
    v_lshl_add_u32 v82, v77, 2, v78
    v_min_u32 v82, 6, v82
    s_mul_i32 s80, s4, 112
    v_lshl_add_u32 v82, v82, 3, s80
    v_lshrrev_b32_e64 v85, 7, v82
    v_mul_u32_u24 v85, 1920, v85
    v_xor_b32_e64 v84, v82, v79
    v_add3_u32 v5, v85, v84, v76
    v_add_u32 v82, 56, v82
    v_lshrrev_b32 v85, 7, v82
    v_mul_u32_u24 v85, 1920, v85
    v_xor_b32_e64 v84, v82, v79
    v_add3_u32 v6, v85, v84, v76
    s_nop 1
    s_branch L_back6
L_rare7:
    s_nop 1
    s_mov_b32 s79, 65536
L_non9:
    global_load_dwordx2 v[44:45], v40, s[40:41] sc1
    s_sub_u32 s79, s79, 1
    s_waitcnt vmcnt(0)
    s_cbranch_scc1 L_nond10
    v_readfirstlane_b32 s44, v44
    v_readfirstlane_b32 s45, v45
    s_cmp_eq_u32 s45, 0
    s_cbranch_scc1 L_non9
L_nond10:
    s_nop 1
    s_branch L_back8
L_rare11:
    s_nop 1
    s_add_u32 m0, s46, 156672
    s_nop 0
    buffer_load_dwordx4 v14, s[16:19], s93 offen lds
    s_nop 1
    s_branch L_back12
L_rare13:
    s_nop 1
    s_lshl_b32 s80, s6, 3
    s_add_u32 s80, s80, s7
    s_lshl_b32 s81, s42, 7
    s_add_u32 s80, s80, s81
    s_mul_i32 s80, s80, 6272
    v_min_u32 v21, 48, v0
    v_lshlrev_b32_e64 v21, 7, v21
    buffer_load_dword v20, v21, s[28:31], s80 offen
    s_mul_i32 s80, s2, 1664
    v_min_u32 v21, 12, v0
    v_lshlrev_b32 v21, 7, v21
    buffer_load_dword v20, v21, s[20:23], s80 offen
    s_nop 1
    s_branch L_back14
L_rare17:
    s_nop 1
    buffer_load_dwordx4 v[56:59], v11, s[8:11], 0 offen
    buffer_load_dwordx4 v[84:87], v11, s[8:11], 0 offen offset:32
    s_nop 1
    s_branch L_back18
L_rare22:
    s_nop 1
    s_waitcnt vmcnt(8)
    v_mov_b32 v22, s44
    v_mov_b32 v23, s45
    s_mov_b64 exec, 1
    buffer_store_dwordx2 v[22:23], off, s[36:39], s47 sc1
    s_mov_b64 exec, -1
    s_nop 1
    s_branch L_back23
L_spr26:
    s_mov_b32 s79, 65536
L_spl28:
    s_sleep 1
    s_buffer_load_dwordx16 s[84:99], s[36:39], s78 offset:0 glc
    s_sub_u32 s79, s79, 1
    s_waitcnt lgkmcnt(0)
    s_cbranch_scc1 L_spb27
    s_cmp_eq_u64 s[84:85], s[44:45]
    s_cbranch_scc0 L_spl28
    s_cmp_eq_u64 s[86:87], s[44:45]
    s_cbranch_scc0 L_spl28
    s_cmp_eq_u64 s[88:89], s[44:45]
    s_cbranch_scc0 L_spl28
    s_cmp_eq_u64 s[90:91], s[44:45]
    s_cbranch_scc0 L_spl28
    s_cmp_eq_u64 s[92:93], s[44:45]
    s_cbranch_scc0 L_spl28
    s_cmp_eq_u64 s[94:95], s[44:45]
    s_cbranch_scc0 L_spl28
    s_cmp_eq_u64 s[96:97], s[44:45]
    s_cbranch_scc0 L_spl28
    s_branch L_spb27
L_spr30:
    s_mov_b32 s79, 65536
L_spl32:
    s_sleep 1
    s_buffer_load_dwordx16 s[84:99], s[36:39], s78 offset:0 glc
    s_sub_u32 s79, s79, 1
    s_waitcnt lgkmcnt(0)
    s_cbranch_scc1 L_spb31
    s_cmp_eq_u64 s[84:85], s[44:45]
    s_cbranch_scc0 L_spl32
    s_cmp_eq_u64 s[86:87], s[44:45]
    s_cbranch_scc0 L_spl32
    s_cmp_eq_u64 s[88:89], s[44:45]
    s_cbranch_scc0 L_spl32
    s_cmp_eq_u64 s[90:91], s[44:45]
    s_cbranch_scc0 L_spl32
    s_cmp_eq_u64 s[92:93], s[44:45]
    s_cbranch_scc0 L_spl32
    s_cmp_eq_u64 s[94:95], s[44:45]
    s_cbranch_scc0 L_spl32
    s_cmp_eq_u64 s[96:97], s[44:45]
    s_cbranch_scc0 L_spl32
    s_branch L_spb31
L_spr34:
    s_mov_b32 s79, 65536
L_spl36:
    s_sleep 1
    s_buffer_load_dwordx8 s[84:91], s[36:39], s77 offset:0 glc
    s_sub_u32 s79, s79, 1
    s_waitcnt lgkmcnt(0)
    s_cbranch_scc1 L_spb35
    s_cmp_eq_u64 s[84:85], s[44:45]
    s_cbranch_scc0 L_spl36
    s_cmp_eq_u64 s[86:87], s[44:45]
    s_cbranch_scc0 L_spl36
    s_branch L_spb35
L_spr39:
    s_mov_b32 s79, 65536
L_spl41:
    s_sleep 1
    s_buffer_load_dwordx8 s[84:91], s[36:39], s77 offset:0 glc
    s_sub_u32 s79, s79, 1
    s_waitcnt lgkmcnt(0)
    s_cbranch_scc1 L_spb40
    s_cmp_eq_u64 s[88:89], s[44:45]
    s_cbranch_scc0 L_spl41
    s_cmp_eq_u64 s[90:91], s[44:45]
    s_cbranch_scc0 L_spl41
    s_branch L_spb40
L_oslow:
    s_buffer_load_dwordx8 s[84:91], s[36:39], s77 offset:0 glc
    s_waitcnt vmcnt(0)
    v_mov_b32 v22, s44
    v_mov_b32_e64 v23, s45
    s_mov_b64 exec, 1
    buffer_store_dwordx2 v[22:23], off, s[36:39], s47 sc1
    s_mov_b64 exec, -1
    s_barrier
    s_waitcnt lgkmcnt(0)
    s_cmp_eq_u64 s[84:85], s[44:45]
    s_cbranch_scc0 L_spr34
    s_cmp_eq_u64 s[86:87], s[44:45]
    s_cbranch_scc0 L_spr34
L_spb35:
    s_cmp_eq_u64 s[88:89], s[44:45]
    s_cbranch_scc0 L_o237
    s_cmp_eq_u64 s[90:91], s[44:45]
    s_cbranch_scc0 L_o237
    s_branch L_o338
L_o237:
    s_buffer_load_dwordx8 s[84:91], s[36:39], s77 offset:0 glc
L_o338:
    buffer_load_dwordx4 v[144:147], v14, s[36:39], s83 offen offset:0 sc1
    buffer_load_dwordx4 v[148:151], v14, s[36:39], s83 offen offset:1024 sc1
    buffer_load_dwordx4 v[152:155], v14, s[36:39], s83 offen offset:2048 sc1
    buffer_load_dwordx4 v[156:159], v14, s[36:39], s83 offen offset:3072 sc1
    s_add_u32 s83, s83, 4096
    buffer_load_dwordx4 v[160:163], v14, s[36:39], s83 offen offset:0 sc1
    buffer_load_dwordx4 v[164:167], v14, s[36:39], s83 offen offset:1024 sc1
    buffer_load_dwordx4 v[168:171], v14, s[36:39], s83 offen offset:2048 sc1
    buffer_load_dwordx4 v[172:175], v14, s[36:39], s83 offen offset:3072 sc1
    s_waitcnt lgkmcnt(0)
    s_cmp_eq_u64 s[88:89], s[44:45]
    s_cbranch_scc0 L_spr39
    s_cmp_eq_u64 s[90:91], s[44:45]
    s_cbranch_scc0 L_spr39
L_spb40:
    s_add_u32 s83, s83, 4096
    buffer_load_dwordx4 v[176:179], v14, s[36:39], s83 offen offset:0 sc1
    buffer_load_dwordx4 v[180:183], v14, s[36:39], s83 offen offset:1024 sc1
    buffer_load_dwordx4 v[184:187], v14, s[36:39], s83 offen offset:2048 sc1
    s_branch L_ojoin
L_proB:
    s_setprio 2
    s_mov_b32 s76, 0x3f803f80
    v_mov_b32 v4, 0
    v_mov_b32_e64 v73, 0
    v_bfe_u32 v21, v0, 2, 2
    v_lshrrev_b32 v22, 4, v0
    v_cmp_eq_u32 vcc, v21, v22
    v_mov_b32 v21, s76
    v_mov_b32 v24, 0
    v_cndmask_b32 v30, 0, v21, vcc
    v_and_b32 v22, 1, v0
    v_lshlrev_b32_e64 v22, 4, v22
    v_mov_b32 v21, 0xffff
    v_lshlrev_b32 v21, v22, v21
    v_and_b32 v21, v21, v30
    v_and_b32 v22, 2, v0
    v_cmp_eq_u32 vcc, 0, v22
    v_mov_b32 v25, 0
    v_mov_b32_e64 v28, 0
    v_cndmask_b32 v26, 0, v21, vcc
    v_cndmask_b32 v27, v21, 0, vcc
    v_mov_b32 v29, 0
    v_mov_b32 v31, v30
    v_mov_b32 v32, v30
    v_mov_b32 v33, v30
    v_lshrrev_b32 v21, 3, v0
    v_add_u32 v21, s96, v21
    v_bfe_u32 v22, v21, 1, 3
    v_and_b32 v23, 7, v0
    v_xor_b32 v22, v22, v23
    v_lshlrev_b32_e64 v22, 4, v22
    v_lshl_add_u32 v88, v21, 7, v22
    v_xor_b32 v89, 0x440, v88
    v_add_u32 v90, 0x10000, v88
    v_add_u32 v91, 0x10000, v89
    s_mov_b32 s80, 155648
    v_lshl_add_u32 v92, v21, 2, s80
    s_mov_b32 s80, 156160
    v_lshl_add_u32 v93, v21, 1, s80
    v_xor_b32 v94, 32, v92
    v_xor_b32 v95, 16, v93
    s_mov_b32 s16, s52
    s_mov_b32 s17, s53
    s_mov_b32 s18, 25088
    s_mov_b32 s19, 0x20000
    s_mov_b32 s36, s68
    s_mov_b32 s37, s69
    s_mov_b32 s38, 18874368
    s_mov_b32 s39, 0x20000
    s_lshr_b32 s82, s3, 2
    s_lshr_b32 s4, s3, 1
    s_xor_b32 s4, s4, s82
    s_and_b32 s4, s4, 1
    s_xor_b32 s5, s82, s42
    s_xor_b32 s5, s5, 1
    s_lshl_b32 s5, s5, 1
    s_and_b32 s80, s3, 1
    s_add_u32 s5, s5, s80
    s_lshl_b32 s46, s3, 10
    s_and_b32 s100, s46, 0xfff
    v_lshlrev_b32 v14, 4, v0
    v_and_b32 v21, 31, v0
    s_lshl_b32 s80, s5, 5
    v_add_u32 v21, s80, v21
    v_bfe_u32 v22, v0, 1, 3
    v_lshrrev_b32 v23, 5, v0
    v_xor_b32 v22, v22, v23
    v_lshlrev_b32_e64 v22, 4, v22
    v_lshl_add_u32 v60, v21, 7, v22
    v_xor_b32 v61, 32, v60
    v_xor_b32 v62, 64, v60
    v_xor_b32 v63, 0x60, v60
    v_xor_b32 v64, 0x10000, v60
    v_xor_b32 v65, 0x10020, v60
    v_xor_b32 v66, 0x10040, v60
    v_xor_b32 v67, 0x10060, v60
    s_mov_b32 s80, 155648
    v_lshl_add_u32 v68, v21, 2, s80
    v_mov_b32 v74, 156416
    s_mov_b32 s27, 0x20000
    v_bfe_u32 v77, v0, 2, 2
    v_lshl_add_u32 v76, v23, 3, v77
    v_lshlrev_b32_e64 v76, 7, v76
    v_bfe_u32 v77, v0, 4, 1
    v_and_b32 v78, 3, v0
    v_and_b32 v79, 8, v0
    v_lshlrev_b32 v79, 3, v79
    v_lshlrev_b32 v80, 2, v77
    v_and_b32 v81, 7, v0
    v_xor_b32 v80, v80, v81
    v_lshrrev_b32 v81, 3, v0
    s_and_b32 s81, s3, 1
    s_lshl_b32 s81, s81, 3
    v_add_u32 v81, s81, v81
    s_and_b32 s81, s3, 2
    s_cmp_eq_u32 s81, 0
    s_cselect_b32 s24, s58, s60
    s_cselect_b32 s25, s59, s61
    s_mov_b32 s26, 1605632
    s_mov_b32 s71, 114688
    v_xor_b32_e64 v83, s81, v80
    v_mul_u32_u24 v2, 3584, v81
    s_mul_i32 s101, s42, 1792
    s_lshl_b32 s80, s7, 8
    s_add_u32 s101, s101, s80
    s_add_u32 s72, s101, 128
    s_mov_b32 s95, s101
    s_mov_b32 s93, s43
    s_mov_b32 s94, 2
    v_mul_u32_u24 v82, 0x820, v77
    v_lshl_add_u32 v82, v78, 3, v82
    s_lshl_b32 s80, s4, 6
    v_xor_b32_e64 v84, s80, v79
    v_add3_u32 v5, v82, v84, v76
    v_xor_b32_e64 v6, 32, v5
    s_cmp_eq_u32 s7, 7
    s_cbranch_scc1 L_rare43
L_back44:
    v_lshl_add_u32 v2, v83, 4, v2
    v_add_u32 v7, 0x10000, v5
    v_add_u32 v8, 0x10000, v6
    v_add_u32 v9, 0x20000, v5
    v_add_u32 v10, 0x20000, v6
    s_lshr_b32 s70, s71, 1
    s_mul_i32 s70, s70, s82
    s_add_u32 s70, s70, s101
    s_sub_u32 s70, s70, s71
    s_mul_i32 s93, s93, 1568
    s_add_u32 s93, s93, s46
    s_mul_i32 s73, s43, 57344
    s_add_u32 s73, s73, 7340032
    s_mov_b32 s20, s54
    s_mov_b32 s21, s55
    s_mov_b32 s22, 401408
    s_mov_b32 s23, 0x20000
    s_mov_b32 s28, s62
    s_mov_b32 s29, s63
    s_mov_b32 s30, 1605632
    s_mov_b32 s31, 0x20000
    s_add_u32 s73, s73, s100
    s_mov_b32 s68, 0
    s_mov_b32 s69, -1
    s_lshl_b32 s75, s6, 1
    s_add_u32 s75, s75, s42
    s_lshl_b32 s75, s75, 3
    s_add_u32 s75, s75, s7
    v_lshrrev_b32_e64 v76, 5, v0
    v_bfe_u32 v77, v0, 2, 2
    v_bfe_u32 v78, v0, 4, 1
    v_and_b32_e64 v79, 3, v0
    v_lshl_add_u32 v78, v78, 2, v79
    v_min_u32 v78, 6, v78
    v_lshlrev_b32 v78, 3, v78
    v_lshl_add_u32 v79, v76, 3, v77
    v_lshl_add_u32 v12, v79, 6, v78
    s_lshl_b32 s80, s4, 12
    s_add_u32 s80, s80, s47
    v_add_u32_e64 v12, s80, v12
    v_lshl_add_u32 v79, v76, 2, v77
    v_mul_u32_u24 v79, 56, v79
    v_add_u32 v3, v79, v78
    v_and_b32_e64 v76, 31, v0
    v_bfe_u32 v77, v0, 1, 1
    v_bfe_u32 v78, v0, 2, 2
    v_lshl_or_b32 v77, v77, 2, v78
    v_lshlrev_b32_e64 v77, 4, v77
    v_lshl_add_u32 v76, v76, 7, v77
    v_lshrrev_b32_e64 v77, 5, v0
    v_lshl_add_u32 v76, v77, 3, v76
    s_lshl_b32 s81, s5, 12
    s_add_u32 s81, s81, 0
    v_add_u32_e64 v76, s81, v76
    v_add_u32 v75, 156672, v3
    v_xor_b32 v77, 16, v76
    v_xor_b32 v78, 32, v76
    v_xor_b32 v79, 48, v76
    v_xor_b32 v80, 64, v76
    v_xor_b32 v81, 80, v76
    v_xor_b32 v82, 96, v76
    v_xor_b32 v83, 112, v76
    s_lshl_b32 s80, s6, 2
    s_add_u32 s80, s80, s5
    s_mul_i32 s80, s80, 112
    s_mul_i32 s81, s42, 56
    s_add_u32 s80, s80, s81
    s_lshl_b32 s81, s4, 1
    s_add_u32 s80, s80, s81
    s_lshl_b32 s77, s80, 10
    s_lshl_b32 s81, s7, 13
    s_add_u32 s74, s77, s81
    s_and_b32 s78, s75, 0xf8
    s_add_u32 s78, s78, s3
    s_lshl_b32 s78, s78, 7
    s_add_u32 s78, s78, 16973824
    v_and_b32 v21, 16, v0
    v_lshlrev_b32 v21, 2, v21
    v_xor_b32 v4, v21, v1
    s_mul_i32 s81, s100, 7
    v_add_u32 v4, s81, v4
    s_mul_i32 s81, s42, 802816
    s_lshl_b32 s67, s7, 7
    s_add_u32 s81, s81, s67
    s_and_b32 s82, s6, 3
    s_mul_i32 s82, s82, 3
    s_lshr_b32 s54, s82, 1
    s_add_u32 s82, s54, s7
    s_cmp_ge_u32 s82, 7
    s_cselect_b32 s83, 7, 0
    s_sub_u32 s82, s82, s83
    s_mul_i32 s83, s7, 114688
    s_add_u32 s61, s81, s83
    s_add_u32 s80, s7, 1
    s_cmp_eq_u32 s80, 7
    s_cselect_b32 s80, 0, s80
    s_add_u32 s82, s82, 1
    s_cmp_eq_u32 s82, 7
    s_cselect_b32 s82, 0, s82
    s_cmp_eq_u32 s82, s7
    s_cselect_b32 s82, s80, s82
    s_lshl_b32 s83, s82, 13
    s_add_u32 s48, s77, s83
    s_mul_i32 s83, s82, 114688
    s_add_u32 s55, s81, s83
    s_add_u32 s82, s82, 1
    s_cmp_eq_u32 s82, 7
    s_cselect_b32 s82, 0, s82
    s_cmp_eq_u32 s82, s7
    s_cselect_b32 s82, s80, s82
    s_lshl_b32 s83, s82, 13
    s_add_u32 s49, s77, s83
    s_mul_i32 s83, s82, 114688
    s_add_u32 s56, s81, s83
    s_add_u32 s82, s82, 1
    s_cmp_eq_u32 s82, 7
    s_cselect_b32 s82, 0, s82
    s_cmp_eq_u32 s82, s7
    s_cselect_b32 s82, s80, s82
    s_lshl_b32 s83, s82, 13
    s_add_u32 s50, s77, s83
    s_mul_i32 s83, s82, 114688
    s_add_u32 s57, s81, s83
    s_add_u32 s82, s82, 1
    s_cmp_eq_u32 s82, 7
    s_cselect_b32 s82, 0, s82
    s_cmp_eq_u32 s82, s7
    s_cselect_b32 s82, s80, s82
    s_lshl_b32 s83, s82, 13
    s_add_u32 s51, s77, s83
    s_mul_i32 s83, s82, 114688
    s_add_u32 s58, s81, s83
    s_add_u32 s82, s82, 1
    s_cmp_eq_u32 s82, 7
    s_cselect_b32 s82, 0, s82
    s_cmp_eq_u32 s82, s7
    s_cselect_b32 s82, s80, s82
    s_lshl_b32 s83, s82, 13
    s_add_u32 s52, s77, s83
    s_mul_i32 s83, s82, 114688
    s_add_u32 s59, s81, s83
    s_add_u32 s82, s82, 1
    s_cmp_eq_u32 s82, 7
    s_cselect_b32 s82, 0, s82
    s_cmp_eq_u32 s82, s7
    s_cselect_b32 s82, s80, s82
    s_lshl_b32 s83, s82, 13
    s_add_u32 s53, s77, s83
    s_mul_i32 s83, s82, 114688
    s_add_u32 s60, s81, s83
    s_and_b32 s81, s3, 1
    s_lshr_b32 s80, s75, 3
    s_lshl_b32 s80, s80, 1
    s_add_u32 s80, s80, s81
    s_mul_i32 s80, s80, 28672
    s_lshl_b32 s82, s7, 7
    s_add_u32 s80, s80, s82
    s_lshl_b32 s82, s4, 6
    s_add_u32 s80, s80, s82
    v_and_b32 v11, 31, v0
    v_mul_u32_u24 v11, 896, v11
    v_lshrrev_b32 v21, 5, v0
    v_lshlrev_b32 v21, 4, v21
    v_add3_u32 v11, v11, v21, s80
    buffer_load_dwordx4 v[144:147], v1, s[8:11], s90 offen offset:0
    buffer_load_dwordx4 v[148:151], v1, s[8:11], s90 offen offset:128
    buffer_load_dwordx4 v[152:155], v1, s[8:11], s90 offen offset:256
    buffer_load_dwordx4 v[156:159], v1, s[8:11], s90 offen offset:384
    buffer_load_dwordx4 v[160:163], v1, s[8:11], s90 offen offset:512
    buffer_load_dwordx4 v[164:167], v1, s[8:11], s90 offen offset:640
    buffer_load_dwordx4 v[168:171], v1, s[8:11], s90 offen offset:768
    buffer_load_dwordx4 v[172:175], v1, s[8:11], s91 offen offset:0
    buffer_load_dwordx4 v[176:179], v1, s[8:11], s91 offen offset:128
    buffer_load_dwordx4 v[180:183], v1, s[8:11], s91 offen offset:256
    buffer_load_dwordx4 v[184:187], v1, s[8:11], s91 offen offset:384
    buffer_load_dwordx4 v[188:191], v1, s[8:11], s91 offen offset:512
    buffer_load_dwordx4 v[192:195], v1, s[8:11], s91 offen offset:640
    buffer_load_dwordx4 v[196:199], v1, s[8:11], s91 offen offset:768
    s_setprio 0
    s_waitcnt vmcnt(13)
    v_mfma_f32_16x16x32_bf16 v[112:115], v[30:33], v[144:147], 0
    v_dot2_f32_bf16 v96, v144, v144, 0
    v_dot2_f32_bf16 v97, v145, v145, 0
    v_dot2_f32_bf16 v96, v146, v146, v96
    v_dot2_f32_bf16 v97, v147, v147, v97
    s_waitcnt vmcnt(12)
    v_mfma_f32_16x16x32_bf16 v[112:115], v[30:33], v[148:151], v[112:115]
    v_dot2_f32_bf16 v96, v148, v148, v96
    v_dot2_f32_bf16 v97, v149, v149, v97
    v_dot2_f32_bf16 v96, v150, v150, v96
    v_dot2_f32_bf16 v97, v151, v151, v97
    s_waitcnt vmcnt(11)
    v_mfma_f32_16x16x32_bf16 v[112:115], v[30:33], v[152:155], v[112:115]
    v_dot2_f32_bf16 v96, v152, v152, v96
    v_dot2_f32_bf16 v97, v153, v153, v97
    v_dot2_f32_bf16 v96, v154, v154, v96
    v_dot2_f32_bf16 v97, v155, v155, v97
    s_waitcnt vmcnt(10)
    v_mfma_f32_16x16x32_bf16 v[112:115], v[30:33], v[156:159], v[112:115]
    v_dot2_f32_bf16 v96, v156, v156, v96
    v_dot2_f32_bf16 v97, v157, v157, v97
    v_dot2_f32_bf16 v96, v158, v158, v96
    v_dot2_f32_bf16 v97, v159, v159, v97
    s_waitcnt vmcnt(9)
    v_mfma_f32_16x16x32_bf16 v[112:115], v[30:33], v[160:163], v[112:115]
    v_dot2_f32_bf16 v96, v160, v160, v96
    v_dot2_f32_bf16 v97, v161, v161, v97
    v_dot2_f32_bf16 v96, v162, v162, v96
    v_dot2_f32_bf16 v97, v163, v163, v97
    s_waitcnt vmcnt(8)
    v_mfma_f32_16x16x32_bf16 v[112:115], v[30:33], v[164:167], v[112:115]
    v_dot2_f32_bf16 v96, v164, v164, v96
    v_dot2_f32_bf16 v97, v165, v165, v97
    v_dot2_f32_bf16 v96, v166, v166, v96
    v_dot2_f32_bf16 v97, v167, v167, v97
    s_waitcnt vmcnt(7)
    v_mfma_f32_16x16x32_bf16 v[112:115], v[30:33], v[168:171], v[112:115]
    v_dot2_f32_bf16 v96, v168, v168, v96
    v_dot2_f32_bf16 v97, v169, v169, v97
    v_dot2_f32_bf16 v96, v170, v170, v96
    v_dot2_f32_bf16 v97, v171, v171, v97
    s_nop 2
    v_add_f32 v96, v96, v97
    v_add_f32_dpp v112, v112, v112 quad_perm:[1,0,3,2] row_mask:0xf bank_mask:0xf
    s_nop 0
    v_add_f32_dpp v96, v96, v96 quad_perm:[1,0,3,2] row_mask:0xf bank_mask:0xf
    v_add_f32_dpp v112, v112, v112 quad_perm:[2,3,0,1] row_mask:0xf bank_mask:0xf
    s_nop 0
    v_add_f32_dpp v96, v96, v96 quad_perm:[2,3,0,1] row_mask:0xf bank_mask:0xf
    v_add_f32_dpp v112, v112, v112 row_half_mirror row_mask:0xf bank_mask:0xf
    s_nop 0
    s_nop 0
    v_add_f32_dpp v96, v96, v96 row_half_mirror row_mask:0xf bank_mask:0xf
    v_mul_f32 v112, 0xbb124925, v112
    v_cvt_pk_bf16_f32 v116, 0, v112
    v_cvt_pk_bf16_f32 v117, 0, v112
    v_cvt_pk_bf16_f32 v118, 0, v112
    v_cvt_pk_bf16_f32 v119, 0, v112
    v_mul_f32 v96, 0x3b124925, v96
    s_nop 0
    s_nop 0
    v_mfma_f32_16x16x32_bf16 v[120:123], v[26:29], v[144:147], v[116:119]
    v_mfma_f32_16x16x32_bf16 v[124:127], v[24:27], v[144:147], v[116:119]
    v_mfma_f32_16x16x32_bf16 v[128:131], v[26:29], v[148:151], v[116:119]
    v_mfma_f32_16x16x32_bf16 v[132:135], v[24:27], v[148:151], v[116:119]
    v_mfma_f32_16x16x32_bf16 v[136:139], v[26:29], v[152:155], v[116:119]
    v_mfma_f32_16x16x32_bf16 v[140:143], v[24:27], v[152:155], v[116:119]
    v_fma_f32 v96, -v112, v112, v96
    s_nop 1
    s_nop 0
    v_cvt_pk_bf16_f32 v144, v120, v121
    v_cvt_pk_bf16_f32 v145, v122, v123
    v_cvt_pk_bf16_f32 v146, v124, v125
    v_cvt_pk_bf16_f32 v147, v126, v127
    ds_write_b128 v88, v[144:147] offset:0
    v_mfma_f32_16x16x32_bf16 v[120:123], v[26:29], v[156:159], v[116:119]
    v_mfma_f32_16x16x32_bf16 v[124:127], v[24:27], v[156:159], v[116:119]
    v_max_f32_e64 v96, 0, v96
    v_cvt_pk_bf16_f32 v148, v128, v129
    v_cvt_pk_bf16_f32 v149, v130, v131
    v_cvt_pk_bf16_f32 v150, v132, v133
    v_cvt_pk_bf16_f32 v151, v134, v135
    ds_write_b128 v88, v[148:151] offset:16384
    v_mfma_f32_16x16x32_bf16 v[128:131], v[26:29], v[160:163], v[116:119]
    v_mfma_f32_16x16x32_bf16 v[132:135], v[24:27], v[160:163], v[116:119]
    v_cvt_pk_bf16_f32 v96, 0, v96
    v_cvt_pk_bf16_f32 v152, v136, v137
    v_cvt_pk_bf16_f32 v153, v138, v139
    v_cvt_pk_bf16_f32 v154, v140, v141
    v_cvt_pk_bf16_f32 v155, v142, v143
    ds_write_b128 v88, v[152:155] offset:32768
    v_mfma_f32_16x16x32_bf16 v[136:139], v[26:29], v[164:167], v[116:119]
    v_mfma_f32_16x16x32_bf16 v[140:143], v[24:27], v[164:167], v[116:119]
    v_add_f32 v96, 0x3727c5ac, v96
    v_cvt_pk_bf16_f32 v156, v120, v121
    v_cvt_pk_bf16_f32 v157, v122, v123
    v_cvt_pk_bf16_f32 v158, v124, v125
    v_cvt_pk_bf16_f32 v159, v126, v127
    ds_write_b128 v88, v[156:159] offset:49152
    v_mfma_f32_16x16x32_bf16 v[120:123], v[26:29], v[168:171], v[116:119]
    v_mfma_f32_16x16x32_bf16 v[124:127], v[24:27], v[168:171], v[116:119]
    v_cvt_pk_bf16_f32 v96, 0, v96
    v_cvt_pk_bf16_f32 v160, v128, v129
    v_cvt_pk_bf16_f32 v161, v130, v131
    v_cvt_pk_bf16_f32 v162, v132, v133
    v_cvt_pk_bf16_f32 v163, v134, v135
    ds_write_b128 v90, v[160:163] offset:0
    v_sqrt_f32_e64 v96, v96
    v_cvt_pk_bf16_f32 v164, v136, v137
    v_cvt_pk_bf16_f32 v165, v138, v139
    v_cvt_pk_bf16_f32 v166, v140, v141
    v_cvt_pk_bf16_f32 v167, v142, v143
    ds_write_b128 v90, v[164:167] offset:16384
    v_cvt_pk_bf16_f32 v96, 0, v96
    v_cvt_pk_bf16_f32 v168, v120, v121
    v_cvt_pk_bf16_f32 v169, v122, v123
    v_cvt_pk_bf16_f32 v170, v124, v125
    v_cvt_pk_bf16_f32 v171, v126, v127
    ds_write_b128 v90, v[168:171] offset:32768
    ds_write_b32 v92, v96
    ds_write_b16_d16_hi v93, v96
    s_add_u32 m0, s46, 114688
    s_add_u32 s70, s70, s71
    buffer_load_dwordx4 v2, s[24:27], s70 offen lds
    s_add_u32 m0, s46, 122880
    s_add_u32 s70, s70, s71
    buffer_load_dwordx4 v2, s[24:27], s70 offen lds
    s_add_u32 m0, s46, 131072
    s_add_u32 s70, s70, s71
    buffer_load_dwordx4 v2, s[24:27], s70 offen lds
    s_add_u32 m0, s46, 139264
    s_add_u32 s70, s70, s71
    buffer_load_dwordx4 v2, s[24:27], s70 offen lds
    s_add_u32 m0, s46, 147456
    s_add_u32 s70, s70, s71
    buffer_load_dwordx4 v2, s[24:27], s70 offen lds
    s_waitcnt vmcnt(11)
    v_mfma_f32_16x16x32_bf16 v[112:115], v[30:33], v[172:175], 0
    v_dot2_f32_bf16 v96, v172, v172, 0
    v_dot2_f32_bf16 v97, v173, v173, 0
    v_dot2_f32_bf16 v96, v174, v174, v96
    v_dot2_f32_bf16 v97, v175, v175, v97
    s_waitcnt vmcnt(10)
    v_mfma_f32_16x16x32_bf16 v[112:115], v[30:33], v[176:179], v[112:115]
    v_dot2_f32_bf16 v96, v176, v176, v96
    v_dot2_f32_bf16 v97, v177, v177, v97
    v_dot2_f32_bf16 v96, v178, v178, v96
    v_dot2_f32_bf16 v97, v179, v179, v97
    s_waitcnt vmcnt(9)
    v_mfma_f32_16x16x32_bf16 v[112:115], v[30:33], v[180:183], v[112:115]
    v_dot2_f32_bf16 v96, v180, v180, v96
    v_dot2_f32_bf16 v97, v181, v181, v97
    v_dot2_f32_bf16 v96, v182, v182, v96
    v_dot2_f32_bf16 v97, v183, v183, v97
    s_waitcnt vmcnt(8)
    v_mfma_f32_16x16x32_bf16 v[112:115], v[30:33], v[184:187], v[112:115]
    v_dot2_f32_bf16 v96, v184, v184, v96
    v_dot2_f32_bf16 v97, v185, v185, v97
    v_dot2_f32_bf16 v96, v186, v186, v96
    v_dot2_f32_bf16 v97, v187, v187, v97
    s_waitcnt vmcnt(7)
    v_mfma_f32_16x16x32_bf16 v[112:115], v[30:33], v[188:191], v[112:115]
    v_dot2_f32_bf16 v96, v188, v188, v96
    v_dot2_f32_bf16 v97, v189, v189, v97
    v_dot2_f32_bf16 v96, v190, v190, v96
    v_dot2_f32_bf16 v97, v191, v191, v97
    s_waitcnt vmcnt(6)
    v_mfma_f32_16x16x32_bf16 v[112:115], v[30:33], v[192:195], v[112:115]
    v_dot2_f32_bf16 v96, v192, v192, v96
    v_dot2_f32_bf16 v97, v193, v193, v97
    v_dot2_f32_bf16 v96, v194, v194, v96
    v_dot2_f32_bf16 v97, v195, v195, v97
    s_waitcnt vmcnt(5)
    v_mfma_f32_16x16x32_bf16 v[112:115], v[30:33], v[196:199], v[112:115]
    v_dot2_f32_bf16 v96, v196, v196, v96
    v_dot2_f32_bf16 v97, v197, v197, v97
    v_dot2_f32_bf16 v96, v198, v198, v96
    v_dot2_f32_bf16 v97, v199, v199, v97
    s_nop 2
    v_add_f32 v96, v96, v97
    v_add_f32_dpp v112, v112, v112 quad_perm:[1,0,3,2] row_mask:0xf bank_mask:0xf
    s_nop 0
    v_add_f32_dpp v96, v96, v96 quad_perm:[1,0,3,2] row_mask:0xf bank_mask:0xf
    v_add_f32_dpp v112, v112, v112 quad_perm:[2,3,0,1] row_mask:0xf bank_mask:0xf
    s_nop 0
    v_add_f32_dpp v96, v96, v96 quad_perm:[2,3,0,1] row_mask:0xf bank_mask:0xf
    v_add_f32_dpp v112, v112, v112 row_half_mirror row_mask:0xf bank_mask:0xf
    s_nop 0
    s_nop 0
    v_add_f32_dpp v96, v96, v96 row_half_mirror row_mask:0xf bank_mask:0xf
    v_mul_f32 v112, 0xbb124925, v112
    v_cvt_pk_bf16_f32 v116, 0, v112
    v_cvt_pk_bf16_f32 v117, 0, v112
    v_cvt_pk_bf16_f32 v118, 0, v112
    v_cvt_pk_bf16_f32 v119, 0, v112
    v_mul_f32 v96, 0x3b124925, v96
    s_nop 0
    s_nop 0
    v_mfma_f32_16x16x32_bf16 v[120:123], v[26:29], v[172:175], v[116:119]
    v_mfma_f32_16x16x32_bf16 v[124:127], v[24:27], v[172:175], v[116:119]
    v_mfma_f32_16x16x32_bf16 v[128:131], v[26:29], v[176:179], v[116:119]
    v_mfma_f32_16x16x32_bf16 v[132:135], v[24:27], v[176:179], v[116:119]
    v_mfma_f32_16x16x32_bf16 v[136:139], v[26:29], v[180:183], v[116:119]
    v_mfma_f32_16x16x32_bf16 v[140:143], v[24:27], v[180:183], v[116:119]
    v_fma_f32 v96, -v112, v112, v96
    s_nop 1
    s_nop 0
    v_cvt_pk_bf16_f32 v172, v120, v121
    v_cvt_pk_bf16_f32 v173, v122, v123
    v_cvt_pk_bf16_f32 v174, v124, v125
    v_cvt_pk_bf16_f32 v175, v126, v127
    ds_write_b128 v89, v[172:175] offset:0
    v_mfma_f32_16x16x32_bf16 v[120:123], v[26:29], v[184:187], v[116:119]
    v_mfma_f32_16x16x32_bf16 v[124:127], v[24:27], v[184:187], v[116:119]
    v_max_f32_e64 v96, 0, v96
    v_cvt_pk_bf16_f32 v176, v128, v129
    v_cvt_pk_bf16_f32 v177, v130, v131
    v_cvt_pk_bf16_f32 v178, v132, v133
    v_cvt_pk_bf16_f32 v179, v134, v135
    ds_write_b128 v89, v[176:179] offset:16384
    v_mfma_f32_16x16x32_bf16 v[128:131], v[26:29], v[188:191], v[116:119]
    v_mfma_f32_16x16x32_bf16 v[132:135], v[24:27], v[188:191], v[116:119]
    v_cvt_pk_bf16_f32 v96, 0, v96
    v_cvt_pk_bf16_f32 v180, v136, v137
    v_cvt_pk_bf16_f32 v181, v138, v139
    v_cvt_pk_bf16_f32 v182, v140, v141
    v_cvt_pk_bf16_f32 v183, v142, v143
    ds_write_b128 v89, v[180:183] offset:32768
    v_mfma_f32_16x16x32_bf16 v[136:139], v[26:29], v[192:195], v[116:119]
    v_mfma_f32_16x16x32_bf16 v[140:143], v[24:27], v[192:195], v[116:119]
    v_add_f32 v96, 0x3727c5ac, v96
    v_cvt_pk_bf16_f32 v184, v120, v121
    v_cvt_pk_bf16_f32 v185, v122, v123
    v_cvt_pk_bf16_f32 v186, v124, v125
    v_cvt_pk_bf16_f32 v187, v126, v127
    ds_write_b128 v89, v[184:187] offset:49152
    v_mfma_f32_16x16x32_bf16 v[120:123], v[26:29], v[196:199], v[116:119]
    v_mfma_f32_16x16x32_bf16 v[124:127], v[24:27], v[196:199], v[116:119]
    v_cvt_pk_bf16_f32 v96, 0, v96
    v_cvt_pk_bf16_f32 v188, v128, v129
    v_cvt_pk_bf16_f32 v189, v130, v131
    v_cvt_pk_bf16_f32 v190, v132, v133
    v_cvt_pk_bf16_f32 v191, v134, v135
    ds_write_b128 v91, v[188:191] offset:0
    v_sqrt_f32_e64 v96, v96
    v_cvt_pk_bf16_f32 v192, v136, v137
    v_cvt_pk_bf16_f32 v193, v138, v139
    v_cvt_pk_bf16_f32 v194, v140, v141
    v_cvt_pk_bf16_f32 v195, v142, v143
    ds_write_b128 v91, v[192:195] offset:16384
    v_cvt_pk_bf16_f32 v96, 0, v96
    v_cvt_pk_bf16_f32 v196, v120, v121
    v_cvt_pk_bf16_f32 v197, v122, v123
    v_cvt_pk_bf16_f32 v198, v124, v125
    v_cvt_pk_bf16_f32 v199, v126, v127
    s_waitcnt lgkmcnt(14)
    ds_write_b128 v91, v[196:199] offset:32768
    s_waitcnt lgkmcnt(14)
    ds_write_b32 v94, v96
    s_waitcnt lgkmcnt(14)
    ds_write_b16_d16_hi v95, v96
    s_lshl_b32 s96, s43, 11
    s_add_u32 s96, s96, 16908288
    v_bfe_u32 v56, v0, 1, 4
    v_and_b32 v21, 1, v0
    v_lshlrev_b32 v21, 4, v21
    v_lshl_add_u32 v56, v56, 7, v21
    buffer_load_dwordx4 v[84:87], v56, s[36:39], s96 offen sc1
    s_waitcnt vmcnt(1)
    s_cmp_lt_u32 s3, s94
    s_cbranch_scc1 L_rare46
L_back47:
    s_waitcnt lgkmcnt(0)
    s_barrier
    s_cmp_eq_u32 s7, 7
    s_cbranch_scc1 L_QB
    s_nop 0
    ds_read_b64 v[72:73], v74
    ds_read_b128 v[144:147], v60 offset:0
    ds_read_b128 v[148:151], v61 offset:0
    ds_read_b128 v[152:155], v62 offset:0
    ds_read_b128 v[156:159], v63 offset:0
    ds_read_b128 v[160:163], v60 offset:16384
    ds_read_b128 v[164:167], v61 offset:16384
    ds_read_b128 v[168:171], v62 offset:16384
    ds_read_b128 v[172:175], v63 offset:16384
    ds_read_b128 v[176:179], v60 offset:32768
    ds_read_b128 v[180:183], v61 offset:32768
    ds_read_b128 v[184:187], v62 offset:32768
    ds_read_b128 v[188:191], v63 offset:32768
    ds_read_b128 v[192:195], v60 offset:49152
    ds_read_b128 v[196:199], v61 offset:49152
    s_waitcnt lgkmcnt(14)
    ds_read_b128 v[200:203], v62 offset:49152
    s_waitcnt lgkmcnt(14)
    ds_read_b128 v[204:207], v63 offset:49152
    v_readfirstlane_b32 s44, v72
    v_readfirstlane_b32 s45, v73
    s_waitcnt vmcnt(0)
    s_nop 0
    v_cmp_ne_u64 vcc, s[44:45], v[84:85]
    v_cmp_ne_u64 s[84:85], s[44:45], v[86:87]
    s_nop 0
    s_or_b64 vcc, vcc, s[84:85]
    s_cbranch_vccnz L_rare48
L_back49:
    s_waitcnt lgkmcnt(0)
    s_barrier
    ds_read_b128 v[208:211], v64 offset:0
    s_add_u32 m0, s100, 0
    s_add_u32 s80, s73, 0
    buffer_load_dwordx4 v14, s[36:39], s80 offen sc1 lds
    ds_read_b128 v[212:215], v65 offset:0
    s_add_u32 m0, s100, 4096
    s_add_u32 s80, s73, 4096
    buffer_load_dwordx4 v14, s[36:39], s80 offen sc1 lds
    ds_read_b128 v[216:219], v66 offset:0
    s_add_u32 m0, s100, 8192
    s_add_u32 s80, s73, 8192
    buffer_load_dwordx4 v14, s[36:39], s80 offen sc1 lds
    ds_read_b128 v[220:223], v67 offset:0
    s_add_u32 m0, s100, 12288
    s_add_u32 s80, s73, 12288
    buffer_load_dwordx4 v14, s[36:39], s80 offen sc1 lds
    ds_read_b128 v[224:227], v64 offset:16384
    s_add_u32 m0, s100, 16384
    s_add_u32 s80, s73, 16384
    buffer_load_dwordx4 v14, s[36:39], s80 offen sc1 lds
    ds_read_b128 v[228:231], v65 offset:16384
    s_add_u32 m0, s100, 20480
    s_add_u32 s80, s73, 20480
    buffer_load_dwordx4 v14, s[36:39], s80 offen sc1 lds
    ds_read_b128 v[232:235], v66 offset:16384
    s_add_u32 m0, s100, 24576
    s_add_u32 s80, s73, 24576
    buffer_load_dwordx4 v14, s[36:39], s80 offen sc1 lds
    ds_read_b128 v[236:239], v67 offset:16384
    s_add_u32 m0, s100, 28672
    s_add_u32 s80, s73, 28672
    buffer_load_dwordx4 v14, s[36:39], s80 offen sc1 lds
    ds_read_b128 v[240:243], v64 offset:32768
    s_add_u32 m0, s100, 32768
    s_add_u32 s80, s73, 32768
    buffer_load_dwordx4 v14, s[36:39], s80 offen sc1 lds
    ds_read_b128 v[244:247], v65 offset:32768
    s_add_u32 m0, s100, 36864
    s_add_u32 s80, s73, 36864
    buffer_load_dwordx4 v14, s[36:39], s80 offen sc1 lds
    ds_read_b128 v[248:251], v66 offset:32768
    ds_read_b128 v[252:255], v67 offset:32768
    ds_read_b32 v69, v68
    s_waitcnt lgkmcnt(0)
    s_barrier
    s_setprio 1
    s_nop 0
    ds_read_b64_tr_b16 v[88:89], v7 offset:49152
    ds_read_b64_tr_b16 v[90:91], v7 offset:49664
    ds_read_b64_tr_b16 v[92:93], v8 offset:49152
    ds_read_b64_tr_b16 v[94:95], v8 offset:49664
    ds_read_b64_tr_b16 v[96:97], v7 offset:53248
    ds_read_b64_tr_b16 v[98:99], v7 offset:53760
    ds_read_b64_tr_b16 v[100:101], v8 offset:53248
    ds_read_b64_tr_b16 v[102:103], v8 offset:53760
    ds_read_b64_tr_b16 v[104:105], v7 offset:57344
    ds_read_b64_tr_b16 v[106:107], v7 offset:57856
    s_waitcnt lgkmcnt(8)
    v_mfma_f32_32x32x16_bf16 v[112:127], v[88:91], v[144:147], 0
    ds_read_b64_tr_b16 v[108:109], v8 offset:57344
    ds_read_b64_tr_b16 v[110:111], v8 offset:57856
    s_waitcnt lgkmcnt(8)
    v_mfma_f32_32x32x16_bf16 v[128:143], v[92:95], v[144:147], 0
    v_rcp_f32 v19, v69
    v_mul_f32 v17, v69, v69
    v_mul_f32 v18, 0x3fb8aa3b, v19
    v_mul_f32 v15, 0xc0135761, v19
    ds_read_b64_tr_b16 v[88:89], v7 offset:61440
    ds_read_b64_tr_b16 v[90:91], v7 offset:61952
    s_waitcnt lgkmcnt(8)
    v_mfma_f32_32x32x16_bf16 v[112:127], v[96:99], v[148:151], v[112:127]
    ds_read_b64_tr_b16 v[92:93], v8 offset:61440
    ds_read_b64_tr_b16 v[94:95], v8 offset:61952
    s_waitcnt lgkmcnt(8)
    v_mfma_f32_32x32x16_bf16 v[128:143], v[100:103], v[148:151], v[128:143]
    v_mul_f32 v16, v19, v19
    v_mul_f32 v16, v16, v19
    v_mul_f32 v16, 0xbdd2d3e8, v16
    ds_read_b64_tr_b16 v[96:97], v9 offset:0
    ds_read_b64_tr_b16 v[98:99], v9 offset:512
    s_waitcnt lgkmcnt(8)
    v_mfma_f32_32x32x16_bf16 v[112:127], v[104:107], v[152:155], v[112:127]
    ds_read_b64_tr_b16 v[100:101], v10 offset:0
    ds_read_b64_tr_b16 v[102:103], v10 offset:512
    s_waitcnt lgkmcnt(8)
    v_mfma_f32_32x32x16_bf16 v[128:143], v[108:111], v[152:155], v[128:143]
    ds_read_b64_tr_b16 v[104:105], v9 offset:4096
    ds_read_b64_tr_b16 v[106:107], v9 offset:4608
    s_waitcnt lgkmcnt(8)
    v_mfma_f32_32x32x16_bf16 v[112:127], v[88:91], v[156:159], v[112:127]
    ds_read_b64_tr_b16 v[108:109], v10 offset:4096
    ds_read_b64_tr_b16 v[110:111], v10 offset:4608
    s_waitcnt lgkmcnt(8)
    v_mfma_f32_32x32x16_bf16 v[128:143], v[92:95], v[156:159], v[128:143]
    ds_read_b64_tr_b16 v[88:89], v9 offset:8192
    ds_read_b64_tr_b16 v[90:91], v9 offset:8704
    s_waitcnt lgkmcnt(8)
    v_mfma_f32_32x32x16_bf16 v[112:127], v[96:99], v[160:163], v[112:127]
    ds_read_b64_tr_b16 v[92:93], v10 offset:8192
    ds_read_b64_tr_b16 v[94:95], v10 offset:8704
    s_waitcnt lgkmcnt(8)
    v_mfma_f32_32x32x16_bf16 v[128:143], v[100:103], v[160:163], v[128:143]
    ds_read_b64_tr_b16 v[96:97], v9 offset:12288
    ds_read_b64_tr_b16 v[98:99], v9 offset:12800
    s_waitcnt lgkmcnt(8)
    v_mfma_f32_32x32x16_bf16 v[112:127], v[104:107], v[164:167], v[112:127]
    ds_read_b64_tr_b16 v[100:101], v10 offset:12288
    ds_read_b64_tr_b16 v[102:103], v10 offset:12800
    s_waitcnt lgkmcnt(8)
    v_mfma_f32_32x32x16_bf16 v[128:143], v[108:111], v[164:167], v[128:143]
    ds_read_b64_tr_b16 v[104:105], v9 offset:16384
    ds_read_b64_tr_b16 v[106:107], v9 offset:16896
    s_waitcnt lgkmcnt(8)
    v_mfma_f32_32x32x16_bf16 v[112:127], v[88:91], v[168:171], v[112:127]
    ds_read_b64_tr_b16 v[108:109], v10 offset:16384
    ds_read_b64_tr_b16 v[110:111], v10 offset:16896
    s_waitcnt lgkmcnt(8)
    v_mfma_f32_32x32x16_bf16 v[128:143], v[92:95], v[168:171], v[128:143]
    ds_read_b64_tr_b16 v[88:89], v9 offset:20480
    ds_read_b64_tr_b16 v[90:91], v9 offset:20992
    s_waitcnt lgkmcnt(8)
    v_mfma_f32_32x32x16_bf16 v[112:127], v[96:99], v[172:175], v[112:127]
    ds_read_b64_tr_b16 v[92:93], v10 offset:20480
    ds_read_b64_tr_b16 v[94:95], v10 offset:20992
    s_waitcnt lgkmcnt(8)
    v_mfma_f32_32x32x16_bf16 v[128:143], v[100:103], v[172:175], v[128:143]
    s_waitcnt vmcnt(0) lgkmcnt(0)
    s_barrier
    v_mfma_f32_32x32x16_bf16 v[112:127], v[104:107], v[176:179], v[112:127]
    v_mfma_f32_32x32x16_bf16 v[128:143], v[108:111], v[176:179], v[128:143]
    v_mfma_f32_32x32x16_bf16 v[112:127], v[88:91], v[180:183], v[112:127]
    v_mfma_f32_32x32x16_bf16 v[128:143], v[92:95], v[180:183], v[128:143]
    s_setprio 0
    s_cmp_eq_u32 s4, 0
    s_cbranch_scc1 L_FK
L_FV:
    s_nop 0
    s_add_u32 m0, s100, 90112
    s_add_u32 s80, s101, 1032192
    buffer_load_dwordx4 v2, s[24:27], s80 offen  lds
    s_add_u32 m0, s100, 94208
    s_add_u32 s80, s101, 1089536
    buffer_load_dwordx4 v2, s[24:27], s80 offen  lds
    s_add_u32 m0, s100, 98304
    s_add_u32 s80, s101, 1146880
    buffer_load_dwordx4 v2, s[24:27], s80 offen  lds
    s_add_u32 m0, s100, 102400
    s_add_u32 s80, s101, 1204224
    buffer_load_dwordx4 v2, s[24:27], s80 offen  lds
    s_add_u32 m0, s100, 106496
    s_add_u32 s80, s101, 1261568
    buffer_load_dwordx4 v2, s[24:27], s80 offen  lds
    s_add_u32 m0, s100, 110592
    s_add_u32 s80, s101, 1318912
    buffer_load_dwordx4 v2, s[24:27], s80 offen  lds
    s_add_u32 m0, s100, 114688
    s_add_u32 s80, s101, 1376256
    buffer_load_dwordx4 v2, s[24:27], s80 offen  lds
    s_add_u32 m0, s100, 118784
    s_add_u32 s80, s101, 1433600
    buffer_load_dwordx4 v2, s[24:27], s80 offen  lds
    v_lshrrev_b32 v21, 5, v0
    v_lshlrev_b32_e64 v21, 3, v21
    s_lshl_b32 s80, s5, 6
    s_add_u32 s80, s80, 156160
    v_add_u32 v21, s80, v21
    s_lshl_b32 s80, s5, 11
    s_add_u32 s80, s80, 16384
    v_add_u32_e64 v76, s80, v14
    ds_read_b64 v[68:69], v21 offset:0
    ds_read_b64 v[70:71], v21 offset:16
    ds_read_b64 v[72:73], v21 offset:32
    ds_read_b64 v[74:75], v21 offset:48
    s_setprio 1
    s_nop 0
    ds_read_b64_tr_b16 v[88:89], v12 offset:0
    ds_read_b64_tr_b16 v[90:91], v12 offset:256
    ds_read_b64_tr_b16 v[92:93], v12 offset:1024
    ds_read_b64_tr_b16 v[94:95], v12 offset:1280
    ds_read_b64_tr_b16 v[96:97], v12 offset:2048
    ds_read_b64_tr_b16 v[98:99], v12 offset:2304
    ds_read_b64_tr_b16 v[100:101], v12 offset:3072
    ds_read_b64_tr_b16 v[102:103], v12 offset:3328
    ds_read_b64_tr_b16 v[104:105], v12 offset:8192
    ds_read_b64_tr_b16 v[106:107], v12 offset:8448
    ds_read_b64_tr_b16 v[108:109], v12 offset:9216
    s_waitcnt lgkmcnt(14)
    ds_read_b64_tr_b16 v[110:111], v12 offset:9472
    s_waitcnt lgkmcnt(10)
    v_mfma_f32_32x32x16_bf16 v[24:39], v[144:147], v[88:91], 0
    ds_read_b64_tr_b16 v[88:89], v12 offset:10240
    ds_read_b64_tr_b16 v[90:91], v12 offset:10496
    s_waitcnt lgkmcnt(10)
    v_mfma_f32_32x32x16_bf16 v[24:39], v[148:151], v[92:95], v[24:39]
    ds_read_b64_tr_b16 v[92:93], v12 offset:11264
    ds_read_b64_tr_b16 v[94:95], v12 offset:11520
    s_waitcnt lgkmcnt(10)
    v_mfma_f32_32x32x16_bf16 v[24:39], v[152:155], v[96:99], v[24:39]
    ds_read_b64_tr_b16 v[96:97], v12 offset:16384
    ds_read_b64_tr_b16 v[98:99], v12 offset:16640
    s_waitcnt lgkmcnt(10)
    v_mfma_f32_32x32x16_bf16 v[24:39], v[156:159], v[100:103], v[24:39]
    ds_read_b64_tr_b16 v[100:101], v12 offset:17408
    ds_read_b64_tr_b16 v[102:103], v12 offset:17664
    s_waitcnt lgkmcnt(10)
    v_mfma_f32_32x32x16_bf16 v[24:39], v[160:163], v[104:107], v[24:39]
    s_add_u32 m0, s100, 131072
    s_add_u32 s80, s72, 0
    buffer_load_dwordx4 v2, s[24:27], s80 offen  lds
    ds_read_b64_tr_b16 v[104:105], v12 offset:18432
    ds_read_b64_tr_b16 v[106:107], v12 offset:18688
    s_waitcnt lgkmcnt(10)
    v_mfma_f32_32x32x16_bf16 v[24:39], v[164:167], v[108:111], v[24:39]
    ds_read_b64_tr_b16 v[108:109], v12 offset:19456
    ds_read_b64_tr_b16 v[110:111], v12 offset:19712
    s_waitcnt lgkmcnt(10)
    s_nop 0
    v_mfma_f32_32x32x16_bf16 v[24:39], v[168:171], v[88:91], v[24:39]
    s_add_u32 m0, s100, 135168
    s_add_u32 s80, s72, 57344
    buffer_load_dwordx4 v2, s[24:27], s80 offen  lds
    ds_read_b64_tr_b16 v[88:89], v12 offset:24576
    ds_read_b64_tr_b16 v[90:91], v12 offset:24832
    s_waitcnt lgkmcnt(10)
    v_mfma_f32_32x32x16_bf16 v[24:39], v[172:175], v[92:95], v[24:39]
    ds_read_b64_tr_b16 v[92:93], v12 offset:25600
    ds_read_b64_tr_b16 v[94:95], v12 offset:25856
    s_waitcnt lgkmcnt(10)
    v_mfma_f32_32x32x16_bf16 v[24:39], v[176:179], v[96:99], v[24:39]
    s_add_u32 m0, s100, 139264
    s_add_u32 s80, s72, 114688
    buffer_load_dwordx4 v2, s[24:27], s80 offen  lds
    ds_read_b64_tr_b16 v[96:97], v12 offset:26624
    ds_read_b64_tr_b16 v[98:99], v12 offset:26880
    s_waitcnt lgkmcnt(10)
    v_mfma_f32_32x32x16_bf16 v[24:39], v[180:183], v[100:103], v[24:39]
    ds_read_b64_tr_b16 v[100:101], v12 offset:27648
    ds_read_b64_tr_b16 v[102:103], v12 offset:27904
    s_waitcnt lgkmcnt(10)
    v_mfma_f32_32x32x16_bf16 v[24:39], v[184:187], v[104:107], v[24:39]
    s_add_u32 m0, s100, 143360
    s_add_u32 s80, s72, 172032
    buffer_load_dwordx4 v2, s[24:27], s80 offen  lds
    ds_read_b64_tr_b16 v[104:105], v12 offset:32768
    ds_read_b64_tr_b16 v[106:107], v12 offset:33024
    s_waitcnt lgkmcnt(10)
    v_mfma_f32_32x32x16_bf16 v[24:39], v[188:191], v[108:111], v[24:39]
    ds_read_b64_tr_b16 v[108:109], v12 offset:33792
    ds_read_b64_tr_b16 v[110:111], v12 offset:34048
    s_waitcnt lgkmcnt(10)
    v_mfma_f32_32x32x16_bf16 v[24:39], v[192:195], v[88:91], v[24:39]
    s_add_u32 m0, s100, 147456
    s_add_u32 s80, s72, 229376
    buffer_load_dwordx4 v2, s[24:27], s80 offen  lds
    ds_read_b64_tr_b16 v[88:89], v12 offset:34816
    ds_read_b64_tr_b16 v[90:91], v12 offset:35072
    s_waitcnt lgkmcnt(10)
    v_mfma_f32_32x32x16_bf16 v[24:39], v[196:199], v[92:95], v[24:39]
    ds_read_b64_tr_b16 v[92:93], v12 offset:35840
    ds_read_b64_tr_b16 v[94:95], v12 offset:36096
    s_waitcnt lgkmcnt(10)
    v_mfma_f32_32x32x16_bf16 v[24:39], v[200:203], v[96:99], v[24:39]
    s_add_u32 m0, s100, 151552
    s_add_u32 s80, s72, 286720
    buffer_load_dwordx4 v2, s[24:27], s80 offen  lds
    ds_read_b64_tr_b16 v[96:97], v12 offset:40960
    ds_read_b64_tr_b16 v[98:99], v12 offset:41216
    s_waitcnt lgkmcnt(10)
    v_mfma_f32_32x32x16_bf16 v[24:39], v[204:207], v[100:103], v[24:39]
    ds_read_b64_tr_b16 v[100:101], v12 offset:41984
    ds_read_b64_tr_b16 v[102:103], v12 offset:42240
    s_waitcnt lgkmcnt(10)
    v_mfma_f32_32x32x16_bf16 v[24:39], v[208:211], v[104:107], v[24:39]
    s_cmp_ge_u32 s3, 4
    s_cbranch_scc1 L_rare54
L_back55:
    ds_read_b64_tr_b16 v[104:105], v12 offset:43008
    ds_read_b64_tr_b16 v[106:107], v12 offset:43264
    s_waitcnt lgkmcnt(10)
    v_mfma_f32_32x32x16_bf16 v[24:39], v[212:215], v[108:111], v[24:39]
    ds_read_b64_tr_b16 v[108:109], v12 offset:44032
    ds_read_b64_tr_b16 v[110:111], v12 offset:44288
    s_waitcnt lgkmcnt(10)
    v_mfma_f32_32x32x16_bf16 v[24:39], v[216:219], v[88:91], v[24:39]
    ds_read_b64_tr_b16 v[88:89], v12 offset:49152
    ds_read_b64_tr_b16 v[90:91], v12 offset:49408
    s_waitcnt lgkmcnt(10)
    v_mfma_f32_32x32x16_bf16 v[24:39], v[220:223], v[92:95], v[24:39]
    ds_read_b64_tr_b16 v[92:93], v12 offset:50176
    ds_read_b64_tr_b16 v[94:95], v12 offset:50432
    s_waitcnt lgkmcnt(10)
    v_mfma_f32_32x32x16_bf16 v[24:39], v[224:227], v[96:99], v[24:39]
    ds_read_b64_tr_b16 v[96:97], v12 offset:51200
    ds_read_b64_tr_b16 v[98:99], v12 offset:51456
    s_waitcnt lgkmcnt(10)
    v_mfma_f32_32x32x16_bf16 v[24:39], v[228:231], v[100:103], v[24:39]
    ds_read_b64_tr_b16 v[100:101], v12 offset:52224
    ds_read_b64_tr_b16 v[102:103], v12 offset:52480
    s_waitcnt lgkmcnt(10)
    v_mfma_f32_32x32x16_bf16 v[24:39], v[232:235], v[104:107], v[24:39]
    s_waitcnt lgkmcnt(8)
    v_mfma_f32_32x32x16_bf16 v[24:39], v[236:239], v[108:111], v[24:39]
    s_waitcnt lgkmcnt(6)
    v_mfma_f32_32x32x16_bf16 v[24:39], v[240:243], v[88:91], v[24:39]
    s_waitcnt vmcnt(6) lgkmcnt(0)
    s_barrier
    v_mfma_f32_32x32x16_bf16 v[24:39], v[244:247], v[92:95], v[24:39]
    ds_read_b64_tr_b16 v[104:105], v5 offset:57344
    ds_read_b64_tr_b16 v[106:107], v5 offset:57856
    ds_read_b64_tr_b16 v[108:109], v6 offset:57344
    ds_read_b64_tr_b16 v[110:111], v6 offset:57856
    v_mfma_f32_32x32x16_bf16 v[24:39], v[248:251], v[96:99], v[24:39]
    ds_read_b64_tr_b16 v[88:89], v5 offset:61440
    ds_read_b64_tr_b16 v[90:91], v5 offset:61952
    ds_read_b64_tr_b16 v[92:93], v6 offset:61440
    ds_read_b64_tr_b16 v[94:95], v6 offset:61952
    v_mfma_f32_32x32x16_bf16 v[24:39], v[252:255], v[100:103], v[24:39]
    s_setprio 0
    s_setprio 2
    ds_read_b64_tr_b16 v[96:97], v7 offset:0
    ds_read_b64_tr_b16 v[98:99], v7 offset:512
    s_waitcnt lgkmcnt(8)
    v_mfma_f32_32x32x16_bf16 v[112:127], v[104:107], v[184:187], v[112:127]
    ds_read_b64_tr_b16 v[100:101], v8 offset:0
    ds_read_b64_tr_b16 v[102:103], v8 offset:512
    s_waitcnt lgkmcnt(8)
    v_mfma_f32_32x32x16_bf16 v[128:143], v[108:111], v[184:187], v[128:143]
    s_mov_b32 exec_lo, 0xefffffff
    s_mov_b32 exec_hi, 0xefffffff
    v_cvt_pk_bf16_f32 v68, v24, v25
    v_cvt_pk_bf16_f32 v69, v26, v27
    v_cvt_pk_bf16_f32 v70, v28, v29
    v_cvt_pk_bf16_f32 v71, v30, v31
    v_cvt_pk_bf16_f32 v72, v32, v33
    v_cvt_pk_bf16_f32 v73, v34, v35
    v_cvt_pk_bf16_f32 v74, v36, v37
    v_cvt_pk_bf16_f32 v75, v38, v39
    s_mov_b64 exec, -1
    ds_write_b128 v76, v[68:71] offset:0
    ds_write_b128 v76, v[72:75] offset:1024
    ds_read_b64_tr_b16 v[104:105], v7 offset:4096
    ds_read_b64_tr_b16 v[106:107], v7 offset:4608
    s_waitcnt lgkmcnt(10)
    v_mfma_f32_32x32x16_bf16 v[112:127], v[88:91], v[188:191], v[112:127]
    ds_read_b64_tr_b16 v[108:109], v8 offset:4096
    ds_read_b64_tr_b16 v[110:111], v8 offset:4608
    s_waitcnt lgkmcnt(10)
    s_nop 0
    v_mfma_f32_32x32x16_bf16 v[128:143], v[92:95], v[188:191], v[128:143]
    s_add_u32 m0, s100, 155648
    s_add_u32 s80, s60, 57344
    buffer_load_dwordx4 v4, s[28:31], s80 offen  lds
    ds_read_b64_tr_b16 v[88:89], v7 offset:8192
    ds_read_b64_tr_b16 v[90:91], v7 offset:8704
    s_waitcnt lgkmcnt(10)
    v_mfma_f32_32x32x16_bf16 v[112:127], v[96:99], v[192:195], v[112:127]
    ds_read_b64_tr_b16 v[92:93], v8 offset:8192
    ds_read_b64_tr_b16 v[94:95], v8 offset:8704
    s_waitcnt lgkmcnt(10)
    v_mfma_f32_32x32x16_bf16 v[128:143], v[100:103], v[192:195], v[128:143]
    s_add_u32 m0, s100, 159744
    s_add_u32 s80, s60, 86016
    buffer_load_dwordx4 v4, s[28:31], s80 offen  lds
    ds_read_b64_tr_b16 v[96:97], v7 offset:12288
    ds_read_b64_tr_b16 v[98:99], v7 offset:12800
    s_waitcnt lgkmcnt(8)
    v_mfma_f32_32x32x16_bf16 v[112:127], v[104:107], v[196:199], v[112:127]
    ds_read_b64_tr_b16 v[100:101], v8 offset:12288
    ds_read_b64_tr_b16 v[102:103], v8 offset:12800
    s_waitcnt lgkmcnt(8)
    v_mfma_f32_32x32x16_bf16 v[128:143], v[108:111], v[196:199], v[128:143]
    ds_read_b64_tr_b16 v[104:105], v7 offset:16384
    ds_read_b64_tr_b16 v[106:107], v7 offset:16896
    s_waitcnt lgkmcnt(8)
    v_mfma_f32_32x32x16_bf16 v[112:127], v[88:91], v[200:203], v[112:127]
    ds_read_b64_tr_b16 v[108:109], v8 offset:16384
    ds_read_b64_tr_b16 v[110:111], v8 offset:16896
    s_waitcnt lgkmcnt(8)
    v_mfma_f32_32x32x16_bf16 v[128:143], v[92:95], v[200:203], v[128:143]
    ds_read_b64_tr_b16 v[88:89], v7 offset:20480
    ds_read_b64_tr_b16 v[90:91], v7 offset:20992
    s_waitcnt lgkmcnt(8)
    v_mfma_f32_32x32x16_bf16 v[112:127], v[96:99], v[204:207], v[112:127]
    ds_read_b64_tr_b16 v[92:93], v8 offset:20480
    ds_read_b64_tr_b16 v[94:95], v8 offset:20992
    s_waitcnt lgkmcnt(8)
    v_mfma_f32_32x32x16_bf16 v[128:143], v[100:103], v[204:207], v[128:143]
    ds_read_b64_tr_b16 v[96:97], v7 offset:24576
    ds_read_b64_tr_b16 v[98:99], v7 offset:25088
    s_waitcnt lgkmcnt(8)
    v_mfma_f32_32x32x16_bf16 v[112:127], v[104:107], v[208:211], v[112:127]
    ds_read_b64_tr_b16 v[100:101], v8 offset:24576
    ds_read_b64_tr_b16 v[102:103], v8 offset:25088
    s_waitcnt lgkmcnt(8)
    v_mfma_f32_32x32x16_bf16 v[128:143], v[108:111], v[208:211], v[128:143]
    ds_read_b64_tr_b16 v[104:105], v7 offset:28672
    ds_read_b64_tr_b16 v[106:107], v7 offset:29184
    s_waitcnt lgkmcnt(8)
    v_mfma_f32_32x32x16_bf16 v[112:127], v[88:91], v[212:215], v[112:127]
    ds_read_b64_tr_b16 v[108:109], v8 offset:28672
    ds_read_b64_tr_b16 v[110:111], v8 offset:29184
    s_waitcnt lgkmcnt(8)
    v_mfma_f32_32x32x16_bf16 v[128:143], v[92:95], v[212:215], v[128:143]
    s_barrier
    ds_read_b64_tr_b16 v[88:89], v7 offset:32768
    ds_read_b64_tr_b16 v[90:91], v7 offset:33280
    s_waitcnt lgkmcnt(8)
    v_mfma_f32_32x32x16_bf16 v[112:127], v[96:99], v[216:219], v[112:127]
    ds_read_b64_tr_b16 v[92:93], v8 offset:32768
    ds_read_b64_tr_b16 v[94:95], v8 offset:33280
    s_waitcnt lgkmcnt(8)
    v_mfma_f32_32x32x16_bf16 v[128:143], v[100:103], v[216:219], v[128:143]
    ds_read_b64_tr_b16 v[96:97], v7 offset:36864
    ds_read_b64_tr_b16 v[98:99], v7 offset:37376
    s_waitcnt lgkmcnt(8)
    v_mfma_f32_32x32x16_bf16 v[112:127], v[104:107], v[220:223], v[112:127]
    ds_read_b64_tr_b16 v[100:101], v8 offset:36864
    ds_read_b64_tr_b16 v[102:103], v8 offset:37376
    s_waitcnt lgkmcnt(8)
    v_mfma_f32_32x32x16_bf16 v[128:143], v[108:111], v[220:223], v[128:143]
    ds_read_b64_tr_b16 v[104:105], v7 offset:40960
    ds_read_b64_tr_b16 v[106:107], v7 offset:41472
    s_waitcnt lgkmcnt(8)
    v_mfma_f32_32x32x16_bf16 v[112:127], v[88:91], v[224:227], v[112:127]
    ds_read_b64_tr_b16 v[108:109], v8 offset:40960
    ds_read_b64_tr_b16 v[110:111], v8 offset:41472
    s_waitcnt lgkmcnt(8)
    v_mfma_f32_32x32x16_bf16 v[128:143], v[92:95], v[224:227], v[128:143]
    ds_read_b64_tr_b16 v[88:89], v7 offset:45056
    ds_read_b64_tr_b16 v[90:91], v7 offset:45568
    s_waitcnt lgkmcnt(8)
    v_mfma_f32_32x32x16_bf16 v[112:127], v[96:99], v[228:231], v[112:127]
    ds_read_b64_tr_b16 v[92:93], v8 offset:45056
    ds_read_b64_tr_b16 v[94:95], v8 offset:45568
    s_waitcnt lgkmcnt(8)
    v_mfma_f32_32x32x16_bf16 v[128:143], v[100:103], v[228:231], v[128:143]
    ds_read_b64_tr_b16 v[96:97], v7 offset:49152
    ds_read_b64_tr_b16 v[98:99], v7 offset:49664
    s_waitcnt lgkmcnt(8)
    v_mfma_f32_32x32x16_bf16 v[112:127], v[104:107], v[232:235], v[112:127]
    ds_read_b64_tr_b16 v[100:101], v8 offset:49152
    ds_read_b64_tr_b16 v[102:103], v8 offset:49664
    s_waitcnt lgkmcnt(8)
    v_mfma_f32_32x32x16_bf16 v[128:143], v[108:111], v[232:235], v[128:143]
    ds_read_b64_tr_b16 v[104:105], v7 offset:53248
    ds_read_b64_tr_b16 v[106:107], v7 offset:53760
    s_waitcnt lgkmcnt(8)
    v_mfma_f32_32x32x16_bf16 v[112:127], v[88:91], v[236:239], v[112:127]
    ds_read_b64_tr_b16 v[108:109], v8 offset:53248
    ds_read_b64_tr_b16 v[110:111], v8 offset:53760
    s_waitcnt lgkmcnt(8)
    v_mfma_f32_32x32x16_bf16 v[128:143], v[92:95], v[236:239], v[128:143]
    ds_read_b64_tr_b16 v[88:89], v7 offset:57344
    ds_read_b64_tr_b16 v[90:91], v7 offset:57856
    s_waitcnt lgkmcnt(8)
    v_mfma_f32_32x32x16_bf16 v[112:127], v[96:99], v[240:243], v[112:127]
    ds_read_b64_tr_b16 v[92:93], v8 offset:57344
    ds_read_b64_tr_b16 v[94:95], v8 offset:57856
    s_waitcnt lgkmcnt(8)
    v_mfma_f32_32x32x16_bf16 v[128:143], v[100:103], v[240:243], v[128:143]
    ds_read_b64_tr_b16 v[96:97], v7 offset:61440
    ds_read_b64_tr_b16 v[98:99], v7 offset:61952
    s_waitcnt lgkmcnt(8)
    v_mfma_f32_32x32x16_bf16 v[112:127], v[104:107], v[244:247], v[112:127]
    ds_read_b64_tr_b16 v[100:101], v8 offset:61440
    ds_read_b64_tr_b16 v[102:103], v8 offset:61952
    s_waitcnt lgkmcnt(8)
    v_mfma_f32_32x32x16_bf16 v[128:143], v[108:111], v[244:247], v[128:143]
    s_waitcnt lgkmcnt(6)
    v_mfma_f32_32x32x16_bf16 v[112:127], v[88:91], v[248:251], v[112:127]
    s_waitcnt lgkmcnt(4)
    v_mfma_f32_32x32x16_bf16 v[128:143], v[92:95], v[248:251], v[128:143]
    s_waitcnt lgkmcnt(2)
    v_mfma_f32_32x32x16_bf16 v[112:127], v[96:99], v[252:255], v[112:127]
    s_waitcnt lgkmcnt(0)
    v_mfma_f32_32x32x16_bf16 v[128:143], v[100:103], v[252:255], v[128:143]
    s_setprio 0
    s_nop 8
    v_mul_f32 v88, v112, v112
    v_mul_f32 v89, v113, v113
    v_mul_f32 v90, v114, v114
    v_mul_f32 v91, v115, v115
    v_mul_f32 v92, v116, v116
    v_mul_f32 v93, v117, v117
    v_mul_f32 v94, v118, v118
    v_mul_f32_e64 v95, v119, v119
    v_fma_f32 v88, v88, v16, v15
    v_fma_f32 v89, v89, v16, v15
    v_fma_f32 v90, v90, v16, v15
    v_fma_f32 v91, v91, v16, v15
    v_fma_f32 v92, v92, v16, v15
    v_fma_f32 v93, v93, v16, v15
    v_fma_f32 v94, v94, v16, v15
    v_fma_f32 v95, v95, v16, v15
    v_mul_f32 v88, v88, v112
    v_mul_f32 v89, v89, v113
    v_mul_f32 v90, v90, v114
    v_mul_f32 v91, v91, v115
    v_mul_f32 v92, v92, v116
    v_mul_f32 v93, v93, v117
    v_mul_f32 v94, v94, v118
    v_mul_f32 v95, v95, v119
    v_exp_f32 v88, v88
    v_mul_f32 v112, v112, v120
    v_exp_f32 v89, v89
    v_mul_f32 v113, v113, v121
    v_exp_f32 v90, v90
    v_mul_f32 v114, v114, v122
    v_exp_f32 v91, v91
    v_mul_f32 v115, v115, v123
    v_exp_f32 v92, v92
    v_mul_f32 v116, v116, v124
    v_exp_f32 v93, v93
    v_mul_f32 v117, v117, v125
    v_exp_f32 v94, v94
    v_mul_f32 v118, v118, v126
    v_exp_f32 v95, v95
    v_mul_f32 v119, v119, v127
    v_fma_f32 v88, v88, v17, v17
    v_fma_f32 v89, v89, v17, v17
    v_fma_f32 v90, v90, v17, v17
    v_fma_f32 v91, v91, v17, v17
    v_fma_f32 v92, v92, v17, v17
    v_fma_f32 v93, v93, v17, v17
    v_fma_f32 v94, v94, v17, v17
    v_fma_f32 v95, v95, v17, v17
    v_rcp_f32 v88, v88
    v_rcp_f32 v89, v89
    v_rcp_f32 v90, v90
    v_rcp_f32 v91, v91
    v_rcp_f32 v92, v92
    v_rcp_f32 v93, v93
    v_rcp_f32 v94, v94
    v_rcp_f32 v95, v95
    v_mul_f32 v88, v88, v112
    v_mul_f32 v89, v89, v113
    v_mul_f32 v90, v90, v114
    v_mul_f32 v91, v91, v115
    v_mul_f32 v92, v92, v116
    v_mul_f32 v93, v93, v117
    v_mul_f32 v94, v94, v118
    v_mul_f32 v95, v95, v119
    v_cvt_pk_bf16_f32 v40, v88, v89
    v_cvt_pk_bf16_f32 v41, v90, v91
    v_cvt_pk_bf16_f32 v42, v92, v93
    v_cvt_pk_bf16_f32 v43, v94, v95
    buffer_store_dwordx4 v[40:43], v14, s[36:39], s74 offen offset:0 sc1
    v_mul_f32 v96, v128, v128
    v_mul_f32 v97, v129, v129
    v_mul_f32 v98, v130, v130
    v_mul_f32 v99, v131, v131
    v_mul_f32 v100, v132, v132
    v_mul_f32 v101, v133, v133
    v_mul_f32 v102, v134, v134
    v_mul_f32 v103, v135, v135
    v_fma_f32 v96, v96, v16, v15
    s_barrier
    s_nop 0
    v_fma_f32 v97, v97, v16, v15
    v_fma_f32 v98, v98, v16, v15
    v_fma_f32 v99, v99, v16, v15
    v_fma_f32 v100, v100, v16, v15
    v_fma_f32 v101, v101, v16, v15
    v_fma_f32 v102, v102, v16, v15
    v_fma_f32 v103, v103, v16, v15
    v_mul_f32 v96, v96, v128
    v_mul_f32 v97, v97, v129
    v_mul_f32 v98, v98, v130
    v_mul_f32 v99, v99, v131
    v_mul_f32 v100, v100, v132
    v_mul_f32 v101, v101, v133
    v_mul_f32 v102, v102, v134
    v_mul_f32 v103, v103, v135
    v_exp_f32 v96, v96
    v_mul_f32 v128, v128, v136
    v_exp_f32 v97, v97
    v_mul_f32 v129, v129, v137
    v_exp_f32 v98, v98
    v_mul_f32 v130, v130, v138
    v_exp_f32 v99, v99
    v_mul_f32 v131, v131, v139
    v_exp_f32 v100, v100
    v_mul_f32 v132, v132, v140
    v_exp_f32 v101, v101
    v_mul_f32 v133, v133, v141
    v_exp_f32 v102, v102
    v_mul_f32 v134, v134, v142
    v_exp_f32 v103, v103
    v_mul_f32 v135, v135, v143
    v_fma_f32 v96, v96, v17, v17
    v_fma_f32 v97, v97, v17, v17
    v_fma_f32 v98, v98, v17, v17
    v_fma_f32 v99, v99, v17, v17
    v_fma_f32 v100, v100, v17, v17
    v_fma_f32 v101, v101, v17, v17
    v_fma_f32 v102, v102, v17, v17
    v_fma_f32 v103, v103, v17, v17
    v_rcp_f32 v96, v96
    v_rcp_f32 v97, v97
    v_rcp_f32 v98, v98
    v_rcp_f32 v99, v99
    v_rcp_f32 v100, v100
    v_rcp_f32 v101, v101
    v_rcp_f32 v102, v102
    v_rcp_f32 v103, v103
    v_mul_f32 v96, v96, v128
    v_mul_f32 v97, v97, v129
    v_mul_f32 v98, v98, v130
    v_mul_f32 v99, v99, v131
    v_mul_f32 v100, v100, v132
    v_mul_f32 v101, v101, v133
    v_mul_f32 v102, v102, v134
    v_mul_f32 v103, v103, v135
    v_cvt_pk_bf16_f32 v44, v96, v97
    v_cvt_pk_bf16_f32 v45, v98, v99
    v_cvt_pk_bf16_f32 v46, v100, v101
    v_cvt_pk_bf16_f32 v47, v102, v103
    buffer_store_dwordx4 v[44:47], v14, s[36:39], s74 offen offset:1024 sc1
    s_waitcnt vmcnt(4) lgkmcnt(0)
    s_barrier
    s_setprio 2
    s_nop 0
    ds_read_b64_tr_b16 v[88:89], v9 offset:0
    ds_read_b64_tr_b16 v[90:91], v9 offset:512
    ds_read_b64_tr_b16 v[92:93], v10 offset:0
    ds_read_b64_tr_b16 v[94:95], v10 offset:512
    ds_read_b64_tr_b16 v[96:97], v9 offset:4096
    ds_read_b64_tr_b16 v[98:99], v9 offset:4608
    ds_read_b64_tr_b16 v[100:101], v10 offset:4096
    ds_read_b64_tr_b16 v[102:103], v10 offset:4608
    ds_read_b64_tr_b16 v[104:105], v9 offset:8192
    ds_read_b64_tr_b16 v[106:107], v9 offset:8704
    s_waitcnt lgkmcnt(8)
    v_mfma_f32_32x32x16_bf16 v[112:127], v[88:91], v[144:147], 0
    ds_read_b64_tr_b16 v[108:109], v10 offset:8192
    ds_read_b64_tr_b16 v[110:111], v10 offset:8704
    s_waitcnt lgkmcnt(8)
    v_mfma_f32_32x32x16_bf16 v[128:143], v[92:95], v[144:147], 0
    s_add_u32 m0, s100, 90112
    s_add_u32 s80, s72, 1261568
    buffer_load_dwordx4 v2, s[24:27], s80 offen  lds
    ds_read_b64_tr_b16 v[88:89], v9 offset:12288
    ds_read_b64_tr_b16 v[90:91], v9 offset:12800
    s_waitcnt lgkmcnt(8)
    v_mfma_f32_32x32x16_bf16 v[112:127], v[96:99], v[148:151], v[112:127]
    ds_read_b64_tr_b16 v[92:93], v10 offset:12288
    ds_read_b64_tr_b16 v[94:95], v10 offset:12800
    s_waitcnt lgkmcnt(8)
    v_mfma_f32_32x32x16_bf16 v[128:143], v[100:103], v[148:151], v[128:143]
    s_add_u32 m0, s100, 94208
    s_add_u32 s80, s72, 1318912
    buffer_load_dwordx4 v2, s[24:27], s80 offen  lds
    ds_read_b64_tr_b16 v[96:97], v9 offset:16384
    ds_read_b64_tr_b16 v[98:99], v9 offset:16896
    s_waitcnt lgkmcnt(8)
    v_mfma_f32_32x32x16_bf16 v[112:127], v[104:107], v[152:155], v[112:127]
    ds_read_b64_tr_b16 v[100:101], v10 offset:16384
    ds_read_b64_tr_b16 v[102:103], v10 offset:16896
    s_waitcnt lgkmcnt(8)
    v_mfma_f32_32x32x16_bf16 v[128:143], v[108:111], v[152:155], v[128:143]
    s_add_u32 m0, s100, 98304
    s_add_u32 s80, s72, 1376256
    buffer_load_dwordx4 v2, s[24:27], s80 offen  lds
    ds_read_b64_tr_b16 v[104:105], v9 offset:20480
    ds_read_b64_tr_b16 v[106:107], v9 offset:20992
    s_waitcnt lgkmcnt(8)
    v_mfma_f32_32x32x16_bf16 v[112:127], v[88:91], v[156:159], v[112:127]
    ds_read_b64_tr_b16 v[108:109], v10 offset:20480
    ds_read_b64_tr_b16 v[110:111], v10 offset:20992
    s_waitcnt lgkmcnt(8)
    v_mfma_f32_32x32x16_bf16 v[128:143], v[92:95], v[156:159], v[128:143]
    s_add_u32 m0, s100, 102400
    s_add_u32 s80, s72, 1433600
    buffer_load_dwordx4 v2, s[24:27], s80 offen  lds
    ds_read_b64_tr_b16 v[88:89], v5 offset:24576
    ds_read_b64_tr_b16 v[90:91], v5 offset:25088
    s_waitcnt lgkmcnt(8)
    v_mfma_f32_32x32x16_bf16 v[112:127], v[96:99], v[160:163], v[112:127]
    ds_read_b64_tr_b16 v[92:93], v6 offset:24576
    ds_read_b64_tr_b16 v[94:95], v6 offset:25088
    s_waitcnt lgkmcnt(8)
    v_mfma_f32_32x32x16_bf16 v[128:143], v[100:103], v[160:163], v[128:143]
    s_add_u32 m0, s100, 106496
    s_add_u32 s80, s72, 1490944
    buffer_load_dwordx4 v2, s[24:27], s80 offen  lds
    ds_read_b64_tr_b16 v[96:97], v5 offset:28672
    ds_read_b64_tr_b16 v[98:99], v5 offset:29184
    s_waitcnt lgkmcnt(8)
    v_mfma_f32_32x32x16_bf16 v[112:127], v[104:107], v[164:167], v[112:127]
    ds_read_b64_tr_b16 v[100:101], v6 offset:28672
    ds_read_b64_tr_b16 v[102:103], v6 offset:29184
    s_waitcnt lgkmcnt(8)
    v_mfma_f32_32x32x16_bf16 v[128:143], v[108:111], v[164:167], v[128:143]
    s_add_u32 m0, s100, 110592
    s_add_u32 s80, s72, 1548288
    buffer_load_dwordx4 v2, s[24:27], s80 offen  lds
    ds_read_b64_tr_b16 v[104:105], v5 offset:32768
    ds_read_b64_tr_b16 v[106:107], v5 offset:33280
    s_waitcnt lgkmcnt(8)
    v_mfma_f32_32x32x16_bf16 v[112:127], v[88:91], v[168:171], v[112:127]
    ds_read_b64_tr_b16 v[108:109], v6 offset:32768
    ds_read_b64_tr_b16 v[110:111], v6 offset:33280
    s_waitcnt lgkmcnt(8)
    v_mfma_f32_32x32x16_bf16 v[128:143], v[92:95], v[168:171], v[128:143]
    s_add_u32 m0, s100, 0
    s_add_u32 s80, s60, 0
    buffer_load_dwordx4 v4, s[28:31], s80 offen  lds
    ds_read_b64_tr_b16 v[88:89], v5 offset:36864
    ds_read_b64_tr_b16 v[90:91], v5 offset:37376
    s_waitcnt lgkmcnt(8)
    v_mfma_f32_32x32x16_bf16 v[112:127], v[96:99], v[172:175], v[112:127]
    ds_read_b64_tr_b16 v[92:93], v6 offset:36864
    ds_read_b64_tr_b16 v[94:95], v6 offset:37376
    s_waitcnt lgkmcnt(8)
    v_mfma_f32_32x32x16_bf16 v[128:143], v[100:103], v[172:175], v[128:143]
    s_add_u32 m0, s100, 4096
    s_add_u32 s80, s60, 28672
    buffer_load_dwordx4 v4, s[28:31], s80 offen  lds
    ds_read_b64_tr_b16 v[96:97], v5 offset:40960
    ds_read_b64_tr_b16 v[98:99], v5 offset:41472
    s_waitcnt lgkmcnt(8)
    v_mfma_f32_32x32x16_bf16 v[112:127], v[104:107], v[176:179], v[112:127]
    ds_read_b64_tr_b16 v[100:101], v6 offset:40960
    ds_read_b64_tr_b16 v[102:103], v6 offset:41472
    s_waitcnt lgkmcnt(8)
    v_mfma_f32_32x32x16_bf16 v[128:143], v[108:111], v[176:179], v[128:143]
    s_waitcnt vmcnt(8)
    s_lshl_b32 s80, s7, 3
    s_add_u32 s80, s80, s78
    v_mov_b32 v22, s44
    v_mov_b32 v23, s45
    s_mov_b64 exec, 1
    buffer_store_dwordx2 v[22:23], off, s[36:39], s80 sc1
    s_mov_b64 exec, -1
    ds_read_b64_tr_b16 v[104:105], v5 offset:45056
    ds_read_b64_tr_b16 v[106:107], v5 offset:45568
    s_waitcnt lgkmcnt(8)
    v_mfma_f32_32x32x16_bf16 v[112:127], v[88:91], v[180:183], v[112:127]
    ds_read_b64_tr_b16 v[108:109], v6 offset:45056
    ds_read_b64_tr_b16 v[110:111], v6 offset:45568
    s_waitcnt lgkmcnt(8)
    v_mfma_f32_32x32x16_bf16 v[128:143], v[92:95], v[180:183], v[128:143]
    ds_read_b64_tr_b16 v[88:89], v5 offset:49152
    ds_read_b64_tr_b16 v[90:91], v5 offset:49664
    s_waitcnt lgkmcnt(8)
    v_mfma_f32_32x32x16_bf16 v[112:127], v[96:99], v[184:187], v[112:127]
    ds_read_b64_tr_b16 v[92:93], v6 offset:49152
    ds_read_b64_tr_b16 v[94:95], v6 offset:49664
    s_waitcnt lgkmcnt(8)
    v_mfma_f32_32x32x16_bf16 v[128:143], v[100:103], v[184:187], v[128:143]
    ds_read_b64_tr_b16 v[96:97], v5 offset:53248
    ds_read_b64_tr_b16 v[98:99], v5 offset:53760
    s_waitcnt lgkmcnt(8)
    v_mfma_f32_32x32x16_bf16 v[112:127], v[104:107], v[188:191], v[112:127]
    ds_read_b64_tr_b16 v[100:101], v6 offset:53248
    ds_read_b64_tr_b16 v[102:103], v6 offset:53760
    s_waitcnt lgkmcnt(8)
    v_mfma_f32_32x32x16_bf16 v[128:143], v[108:111], v[188:191], v[128:143]
    s_waitcnt lgkmcnt(6)
    v_mfma_f32_32x32x16_bf16 v[112:127], v[88:91], v[192:195], v[112:127]
    s_waitcnt lgkmcnt(4)
    v_mfma_f32_32x32x16_bf16 v[128:143], v[92:95], v[192:195], v[128:143]
    s_waitcnt lgkmcnt(2)
    v_mfma_f32_32x32x16_bf16 v[112:127], v[96:99], v[196:199], v[112:127]
    s_waitcnt lgkmcnt(0)
    v_mfma_f32_32x32x16_bf16 v[128:143], v[100:103], v[196:199], v[128:143]
    s_setprio 0
    s_add_u32 m0, s100, 8192
    s_add_u32 s80, s61, 0
    s_nop 0
    buffer_load_dwordx4 v4, s[28:31], s80 offen  lds
    s_add_u32 m0, s100, 12288
    s_add_u32 s80, s61, 28672
    buffer_load_dwordx4 v4, s[28:31], s80 offen  lds
    s_add_u32 m0, s100, 16384
    s_add_u32 s80, s55, 57344
    buffer_load_dwordx4 v4, s[28:31], s80 offen  lds
    s_add_u32 m0, s100, 20480
    s_add_u32 s80, s55, 86016
    buffer_load_dwordx4 v4, s[28:31], s80 offen  lds
    s_add_u32 m0, s100, 114688
    s_add_u32 s80, s55, 0
    buffer_load_dwordx4 v4, s[28:31], s80 offen  lds
    s_add_u32 m0, s100, 118784
    s_add_u32 s80, s55, 28672
    buffer_load_dwordx4 v4, s[28:31], s80 offen  lds
    s_add_u32 m0, s100, 122880
    s_add_u32 s80, s56, 0
    buffer_load_dwordx4 v4, s[28:31], s80 offen  lds
    s_add_u32 m0, s100, 126976
    s_add_u32 s80, s56, 28672
    buffer_load_dwordx4 v4, s[28:31], s80 offen  lds
    s_barrier
    s_add_u32 m0, s100, 131072
    s_add_u32 s80, s57, 0
    buffer_load_dwordx4 v4, s[28:31], s80 offen  lds
    s_add_u32 m0, s100, 135168
    s_add_u32 s80, s57, 28672
    buffer_load_dwordx4 v4, s[28:31], s80 offen  lds
    s_add_u32 m0, s100, 139264
    s_add_u32 s80, s58, 0
    buffer_load_dwordx4 v4, s[28:31], s80 offen  lds
    s_add_u32 m0, s100, 143360
    s_add_u32 s80, s58, 28672
    buffer_load_dwordx4 v4, s[28:31], s80 offen  lds
    s_waitcnt vmcnt(15)
    s_barrier
    s_cmp_lt_u32 s3, 4
    s_cbranch_scc1 L_FA4
L_FB4:
    s_add_u32 m0, s100, 147456
    s_add_u32 s80, s59, 0
    buffer_load_dwordx4 v4, s[28:31], s80 offen  lds
    s_add_u32 m0, s100, 151552
    s_add_u32 s80, s59, 28672
    buffer_load_dwordx4 v4, s[28:31], s80 offen  lds
    s_add_u32 m0, s100, 24576
    s_add_u32 s80, s56, 57344
    buffer_load_dwordx4 v4, s[28:31], s80 offen  lds
    s_add_u32 m0, s100, 28672
    s_add_u32 s80, s56, 86016
    buffer_load_dwordx4 v4, s[28:31], s80 offen  lds
    s_add_u32 m0, s100, 32768
    s_add_u32 s80, s57, 57344
    buffer_load_dwordx4 v4, s[28:31], s80 offen  lds
    s_add_u32 m0, s100, 36864
    s_add_u32 s80, s57, 86016
    buffer_load_dwordx4 v4, s[28:31], s80 offen  lds
    s_add_u32 m0, s100, 40960
    s_add_u32 s80, s58, 57344
    buffer_load_dwordx4 v4, s[28:31], s80 offen  lds
    s_add_u32 m0, s100, 45056
    s_add_u32 s80, s58, 86016
    buffer_load_dwordx4 v4, s[28:31], s80 offen  lds
    s_add_u32 m0, s100, 49152
    s_add_u32 s80, s59, 57344
    buffer_load_dwordx4 v4, s[28:31], s80 offen  lds
    s_add_u32 m0, s100, 53248
    s_add_u32 s80, s59, 86016
    buffer_load_dwordx4 v4, s[28:31], s80 offen  lds
    s_barrier
    s_setprio 1
    ds_read_b64_tr_b16 v[88:89], v5 offset:57344
    ds_read_b64_tr_b16 v[90:91], v5 offset:57856
    ds_read_b64_tr_b16 v[92:93], v6 offset:57344
    ds_read_b64_tr_b16 v[94:95], v6 offset:57856
    ds_read_b64_tr_b16 v[96:97], v5 offset:61440
    ds_read_b64_tr_b16 v[98:99], v5 offset:61952
    ds_read_b64_tr_b16 v[100:101], v6 offset:61440
    ds_read_b64_tr_b16 v[102:103], v6 offset:61952
    ds_read_b64_tr_b16 v[104:105], v7 offset:0
    ds_read_b64_tr_b16 v[106:107], v7 offset:512
    s_waitcnt lgkmcnt(8)
    v_mfma_f32_32x32x16_bf16 v[112:127], v[88:91], v[200:203], v[112:127]
    ds_read_b64_tr_b16 v[108:109], v8 offset:0
    ds_read_b64_tr_b16 v[110:111], v8 offset:512
    s_waitcnt lgkmcnt(8)
    v_mfma_f32_32x32x16_bf16 v[128:143], v[92:95], v[200:203], v[128:143]
    ds_read_b64_tr_b16 v[88:89], v7 offset:4096
    ds_read_b64_tr_b16 v[90:91], v7 offset:4608
    s_waitcnt lgkmcnt(8)
    v_mfma_f32_32x32x16_bf16 v[112:127], v[96:99], v[204:207], v[112:127]
    ds_read_b64_tr_b16 v[92:93], v8 offset:4096
    ds_read_b64_tr_b16 v[94:95], v8 offset:4608
    s_waitcnt lgkmcnt(8)
    v_mfma_f32_32x32x16_bf16 v[128:143], v[100:103], v[204:207], v[128:143]
    ds_read_b64_tr_b16 v[96:97], v7 offset:8192
    ds_read_b64_tr_b16 v[98:99], v7 offset:8704
    s_waitcnt lgkmcnt(8)
    v_mfma_f32_32x32x16_bf16 v[112:127], v[104:107], v[208:211], v[112:127]
    ds_read_b64_tr_b16 v[100:101], v8 offset:8192
    ds_read_b64_tr_b16 v[102:103], v8 offset:8704
    s_waitcnt lgkmcnt(8)
    v_mfma_f32_32x32x16_bf16 v[128:143], v[108:111], v[208:211], v[128:143]
    ds_read_b64_tr_b16 v[104:105], v7 offset:12288
    ds_read_b64_tr_b16 v[106:107], v7 offset:12800
    s_waitcnt lgkmcnt(8)
    v_mfma_f32_32x32x16_bf16 v[112:127], v[88:91], v[212:215], v[112:127]
    ds_read_b64_tr_b16 v[108:109], v8 offset:12288
    ds_read_b64_tr_b16 v[110:111], v8 offset:12800
    s_waitcnt lgkmcnt(8)
    v_mfma_f32_32x32x16_bf16 v[128:143], v[92:95], v[212:215], v[128:143]
    s_buffer_load_dwordx16 s[84:99], s[36:39], s78 offset:0 glc
    ds_read_b64_tr_b16 v[88:89], v7 offset:16384
    ds_read_b64_tr_b16 v[90:91], v7 offset:16896
    s_waitcnt lgkmcnt(8)
    v_mfma_f32_32x32x16_bf16 v[112:127], v[96:99], v[216:219], v[112:127]
    ds_read_b64_tr_b16 v[92:93], v8 offset:16384
    ds_read_b64_tr_b16 v[94:95], v8 offset:16896
    s_waitcnt lgkmcnt(8)
    v_mfma_f32_32x32x16_bf16 v[128:143], v[100:103], v[216:219], v[128:143]
    ds_read_b64_tr_b16 v[96:97], v7 offset:20480
    ds_read_b64_tr_b16 v[98:99], v7 offset:20992
    s_waitcnt lgkmcnt(8)
    v_mfma_f32_32x32x16_bf16 v[112:127], v[104:107], v[220:223], v[112:127]
    ds_read_b64_tr_b16 v[100:101], v8 offset:20480
    ds_read_b64_tr_b16 v[102:103], v8 offset:20992
    s_waitcnt lgkmcnt(8)
    v_mfma_f32_32x32x16_bf16 v[128:143], v[108:111], v[220:223], v[128:143]
    ds_read_b64_tr_b16 v[104:105], v7 offset:24576
    ds_read_b64_tr_b16 v[106:107], v7 offset:25088
    s_waitcnt lgkmcnt(8)
    v_mfma_f32_32x32x16_bf16 v[112:127], v[88:91], v[224:227], v[112:127]
    ds_read_b64_tr_b16 v[108:109], v8 offset:24576
    ds_read_b64_tr_b16 v[110:111], v8 offset:25088
    s_waitcnt lgkmcnt(8)
    v_mfma_f32_32x32x16_bf16 v[128:143], v[92:95], v[224:227], v[128:143]
    ds_read_b64_tr_b16 v[88:89], v7 offset:28672
    ds_read_b64_tr_b16 v[90:91], v7 offset:29184
    s_waitcnt lgkmcnt(8)
    v_mfma_f32_32x32x16_bf16 v[112:127], v[96:99], v[228:231], v[112:127]
    ds_read_b64_tr_b16 v[92:93], v8 offset:28672
    ds_read_b64_tr_b16 v[94:95], v8 offset:29184
    s_waitcnt lgkmcnt(8)
    v_mfma_f32_32x32x16_bf16 v[128:143], v[100:103], v[228:231], v[128:143]
    ds_read_b64_tr_b16 v[96:97], v7 offset:32768
    ds_read_b64_tr_b16 v[98:99], v7 offset:33280
    s_waitcnt lgkmcnt(8)
    v_mfma_f32_32x32x16_bf16 v[112:127], v[104:107], v[232:235], v[112:127]
    ds_read_b64_tr_b16 v[100:101], v8 offset:32768
    ds_read_b64_tr_b16 v[102:103], v8 offset:33280
    s_waitcnt lgkmcnt(8)
    v_mfma_f32_32x32x16_bf16 v[128:143], v[108:111], v[232:235], v[128:143]
    ds_read_b64_tr_b16 v[104:105], v7 offset:36864
    ds_read_b64_tr_b16 v[106:107], v7 offset:37376
    s_waitcnt lgkmcnt(8)
    v_mfma_f32_32x32x16_bf16 v[112:127], v[88:91], v[236:239], v[112:127]
    ds_read_b64_tr_b16 v[108:109], v8 offset:36864
    ds_read_b64_tr_b16 v[110:111], v8 offset:37376
    s_waitcnt lgkmcnt(8)
    v_mfma_f32_32x32x16_bf16 v[128:143], v[92:95], v[236:239], v[128:143]
    ds_read_b64_tr_b16 v[88:89], v7 offset:40960
    ds_read_b64_tr_b16 v[90:91], v7 offset:41472
    s_waitcnt lgkmcnt(8)
    v_mfma_f32_32x32x16_bf16 v[112:127], v[96:99], v[240:243], v[112:127]
    ds_read_b64_tr_b16 v[92:93], v8 offset:40960
    ds_read_b64_tr_b16 v[94:95], v8 offset:41472
    s_waitcnt lgkmcnt(8)
    v_mfma_f32_32x32x16_bf16 v[128:143], v[100:103], v[240:243], v[128:143]
    ds_read_b64_tr_b16 v[96:97], v7 offset:45056
    ds_read_b64_tr_b16 v[98:99], v7 offset:45568
    s_waitcnt lgkmcnt(8)
    v_mfma_f32_32x32x16_bf16 v[112:127], v[104:107], v[244:247], v[112:127]
    ds_read_b64_tr_b16 v[100:101], v8 offset:45056
    ds_read_b64_tr_b16 v[102:103], v8 offset:45568
    s_waitcnt lgkmcnt(8)
    v_mfma_f32_32x32x16_bf16 v[128:143], v[108:111], v[244:247], v[128:143]
    s_waitcnt vmcnt(0) lgkmcnt(0)
    s_barrier
    v_mfma_f32_32x32x16_bf16 v[112:127], v[88:91], v[248:251], v[112:127]
    v_mfma_f32_32x32x16_bf16 v[128:143], v[92:95], v[248:251], v[128:143]
    v_mfma_f32_32x32x16_bf16 v[112:127], v[96:99], v[252:255], v[112:127]
    v_mfma_f32_32x32x16_bf16 v[128:143], v[100:103], v[252:255], v[128:143]
    s_setprio 0
    s_waitcnt lgkmcnt(0)
    s_cmp_eq_u64 s[84:85], s[44:45]
    s_cbranch_scc0 L_spr59
    s_cmp_eq_u64 s[86:87], s[44:45]
    s_cbranch_scc0 L_spr59
    s_cmp_eq_u64 s[88:89], s[44:45]
    s_cbranch_scc0 L_spr59
    s_cmp_eq_u64 s[90:91], s[44:45]
    s_cbranch_scc0 L_spr59
    s_cmp_eq_u64 s[92:93], s[44:45]
    s_cbranch_scc0 L_spr59
    s_cmp_eq_u64 s[94:95], s[44:45]
    s_cbranch_scc0 L_spr59
    s_cmp_eq_u64 s[96:97], s[44:45]
    s_cbranch_scc0 L_spr59
L_spb60:
    v_mul_f32 v88, v112, v112
    v_mul_f32 v89, v113, v113
    v_mul_f32 v90, v114, v114
    v_mul_f32 v91, v115, v115
    v_mul_f32 v92, v116, v116
    v_mul_f32 v93, v117, v117
    v_mul_f32 v94, v118, v118
    v_mul_f32 v95, v119, v119
    v_fma_f32 v88, v88, v16, v15
    v_fma_f32 v89, v89, v16, v15
    v_fma_f32 v90, v90, v16, v15
    v_fma_f32 v91, v91, v16, v15
    v_fma_f32 v92, v92, v16, v15
    buffer_load_dwordx4 v[144:147], v14, s[36:39], s48 offen offset:0 sc1
    v_fma_f32 v93, v93, v16, v15
    v_fma_f32 v94, v94, v16, v15
    v_fma_f32 v95, v95, v16, v15
    v_mul_f32 v88, v88, v112
    v_mul_f32 v89, v89, v113
    v_mul_f32 v90, v90, v114
    v_mul_f32 v91, v91, v115
    v_mul_f32 v92, v92, v116
    v_mul_f32 v93, v93, v117
    v_mul_f32 v94, v94, v118
    v_mul_f32 v95, v95, v119
    v_exp_f32 v88, v88
    v_mul_f32 v112, v112, v120
    buffer_load_dwordx4 v[148:151], v14, s[36:39], s48 offen offset:1024 sc1
    v_exp_f32 v89, v89
    v_mul_f32 v113, v113, v121
    v_exp_f32 v90, v90
    v_mul_f32 v114, v114, v122
    v_exp_f32 v91, v91
    v_mul_f32 v115, v115, v123
    v_exp_f32 v92, v92
    v_mul_f32 v116, v116, v124
    v_exp_f32 v93, v93
    v_mul_f32 v117, v117, v125
    v_exp_f32 v94, v94
    v_mul_f32 v118, v118, v126
    v_exp_f32_e64 v95, v95
    buffer_load_dwordx4 v[152:155], v14, s[36:39], s49 offen offset:0 sc1
    v_mul_f32_e64 v119, v119, v127
    v_fma_f32 v88, v88, v17, v17
    v_fma_f32 v89, v89, v17, v17
    v_fma_f32 v90, v90, v17, v17
    v_fma_f32 v91, v91, v17, v17
    v_fma_f32 v92, v92, v17, v17
    v_fma_f32 v93, v93, v17, v17
    v_fma_f32 v94, v94, v17, v17
    v_fma_f32 v95, v95, v17, v17
    v_rcp_f32 v88, v88
    v_rcp_f32 v89, v89
    v_rcp_f32 v90, v90
    v_rcp_f32 v91, v91
    buffer_load_dwordx4 v[156:159], v14, s[36:39], s49 offen offset:1024 sc1
    v_rcp_f32 v92, v92
    v_rcp_f32 v93, v93
    v_rcp_f32 v94, v94
    v_rcp_f32 v95, v95
    v_mul_f32 v88, v88, v112
    v_mul_f32 v89, v89, v113
    v_mul_f32 v90, v90, v114
    v_mul_f32 v91, v91, v115
    v_mul_f32 v92, v92, v116
    v_mul_f32 v93, v93, v117
    v_mul_f32 v94, v94, v118
    v_mul_f32 v95, v95, v119
    v_cvt_pk_bf16_f32 v48, v88, v89
    buffer_load_dwordx4 v[160:163], v14, s[36:39], s50 offen offset:0 sc1
    v_cvt_pk_bf16_f32 v49, v90, v91
    v_cvt_pk_bf16_f32 v50, v92, v93
    v_cvt_pk_bf16_f32 v51, v94, v95
    s_add_u32 s74, s74, 4096
    buffer_store_dwordx4 v[48:51], v14, s[36:39], s74 offen offset:0 sc1
    v_mul_f32 v96, v128, v128
    v_mul_f32 v97, v129, v129
    v_mul_f32 v98, v130, v130
    v_mul_f32 v99, v131, v131
    v_mul_f32 v100, v132, v132
    v_mul_f32 v101, v133, v133
    v_mul_f32 v102, v134, v134
    v_mul_f32 v103, v135, v135
    buffer_load_dwordx4 v[164:167], v14, s[36:39], s50 offen offset:1024 sc1
    v_fma_f32 v96, v96, v16, v15
    v_fma_f32 v97, v97, v16, v15
    v_fma_f32 v98, v98, v16, v15
    v_fma_f32 v99, v99, v16, v15
    v_fma_f32 v100, v100, v16, v15
    v_fma_f32 v101, v101, v16, v15
    v_fma_f32 v102, v102, v16, v15
    v_fma_f32 v103, v103, v16, v15
    v_mul_f32 v96, v96, v128
    v_mul_f32 v97, v97, v129
    v_mul_f32 v98, v98, v130
    v_mul_f32 v99, v99, v131
    v_mul_f32_e64 v100, v100, v132
    buffer_load_dwordx4 v[168:171], v14, s[36:39], s51 offen offset:0 sc1
    v_mul_f32 v101, v101, v133
    v_mul_f32 v102, v102, v134
    v_mul_f32 v103, v103, v135
    v_exp_f32 v96, v96
    v_mul_f32 v128, v128, v136
    v_exp_f32 v97, v97
    v_mul_f32 v129, v129, v137
    v_exp_f32 v98, v98
    v_mul_f32 v130, v130, v138
    v_exp_f32 v99, v99
    v_mul_f32 v131, v131, v139
    v_exp_f32 v100, v100
    v_mul_f32_e64 v132, v132, v140
    buffer_load_dwordx4 v[172:175], v14, s[36:39], s51 offen offset:1024 sc1
    v_exp_f32 v101, v101
    v_mul_f32 v133, v133, v141
    v_exp_f32 v102, v102
    v_mul_f32 v134, v134, v142
    v_exp_f32 v103, v103
    v_mul_f32 v135, v135, v143
    v_fma_f32 v96, v96, v17, v17
    v_fma_f32 v97, v97, v17, v17
    v_fma_f32 v98, v98, v17, v17
    v_fma_f32 v99, v99, v17, v17
    v_fma_f32 v100, v100, v17, v17
    v_fma_f32 v101, v101, v17, v17
    v_fma_f32 v102, v102, v17, v17
    v_fma_f32 v103, v103, v17, v17
    v_rcp_f32 v96, v96
    v_rcp_f32 v97, v97
    v_rcp_f32 v98, v98
    v_rcp_f32 v99, v99
    v_rcp_f32 v100, v100
    v_rcp_f32 v101, v101
    v_rcp_f32 v102, v102
    v_rcp_f32 v103, v103
    v_mul_f32 v96, v96, v128
    v_mul_f32 v97, v97, v129
    v_mul_f32 v98, v98, v130
    v_mul_f32 v99, v99, v131
    v_mul_f32 v100, v100, v132
    v_mul_f32 v101, v101, v133
    v_mul_f32 v102, v102, v134
    v_mul_f32 v103, v103, v135
    v_cvt_pk_bf16_f32 v52, v96, v97
    v_cvt_pk_bf16_f32 v53, v98, v99
    v_cvt_pk_bf16_f32 v54, v100, v101
    v_cvt_pk_bf16_f32 v55, v102, v103
    buffer_store_dwordx4 v[52:55], v14, s[36:39], s74 offen offset:1024 sc1
    buffer_load_dwordx4 v[176:179], v14, s[36:39], s52 offen offset:0 sc1
    buffer_load_dwordx4 v[180:183], v14, s[36:39], s52 offen offset:1024 sc1
    buffer_load_dwordx4 v[184:187], v14, s[36:39], s53 offen offset:0 sc1
    buffer_load_dwordx4 v[188:191], v14, s[36:39], s53 offen offset:1024 sc1
    v_lshrrev_b32_e64 v68, 5, v0
    v_bfe_u32 v69, v0, 2, 2
    v_lshl_add_u32 v68, v68, 2, v69
    v_lshlrev_b32_e64 v68, 7, v68
    v_bfe_u32 v69, v0, 3, 1
    v_lshl_add_u32 v68, v69, 6, v68
    v_bfe_u32 v69, v0, 4, 1
    v_lshlrev_b32 v69, 5, v69
    v_and_b32 v70, 3, v0
    v_lshl_add_u32 v70, v70, 3, v69
    s_mul_i32 s80, s4, 0x1040
    v_add_u32 v68, v68, v70
    v_xor_b32 v5, s80, v68
    v_xor_b32_e64 v6, 64, v5
    v_add_u32 v7, 0x10000, v5
    v_add_u32 v8, 0x10000, v6
    v_add_u32 v9, 0x20000, v5
    v_add_u32 v10, 0x20000, v6
    s_setprio 1
    s_nop 0
    ds_read_b64_tr_b16 v[88:89], v7 offset:49152
    ds_read_b64_tr_b16 v[90:91], v7 offset:50176
    ds_read_b64_tr_b16 v[92:93], v8 offset:49152
    ds_read_b64_tr_b16 v[94:95], v8 offset:50176
    ds_read_b64_tr_b16 v[96:97], v7 offset:51200
    ds_read_b64_tr_b16 v[98:99], v7 offset:52224
    ds_read_b64_tr_b16 v[100:101], v8 offset:51200
    ds_read_b64_tr_b16 v[102:103], v8 offset:52224
    ds_read_b64_tr_b16 v[104:105], v7 offset:57344
    ds_read_b64_tr_b16 v[106:107], v7 offset:58368
    s_waitcnt vmcnt(13) lgkmcnt(8)
    v_mfma_f32_32x32x16_bf16 v[112:127], v[88:91], v[144:147], 0
    ds_read_b64_tr_b16 v[108:109], v8 offset:57344
    ds_read_b64_tr_b16 v[110:111], v8 offset:58368
    s_waitcnt lgkmcnt(8)
    v_mfma_f32_32x32x16_bf16 v[128:143], v[92:95], v[144:147], 0
    s_and_b32 s81, s3, 1
    s_lshr_b32 s80, s75, 3
    s_lshl_b32 s80, s80, 1
    s_add_u32 s80, s80, s81
    ds_read_b64_tr_b16 v[88:89], v7 offset:59392
    ds_read_b64_tr_b16 v[90:91], v7 offset:60416
    s_waitcnt vmcnt(12) lgkmcnt(8)
    v_mfma_f32_32x32x16_bf16 v[112:127], v[96:99], v[148:151], v[112:127]
    ds_read_b64_tr_b16 v[92:93], v8 offset:59392
    ds_read_b64_tr_b16 v[94:95], v8 offset:60416
    s_waitcnt lgkmcnt(8)
    v_mfma_f32_32x32x16_bf16 v[128:143], v[100:103], v[148:151], v[128:143]
    s_lshl_b32 s77, s80, 1
    s_add_u32 s77, s77, s4
    s_lshl_b32 s82, s4, 1
    s_add_u32 s81, s81, s82
    ds_read_b64_tr_b16 v[96:97], v9 offset:0
    ds_read_b64_tr_b16 v[98:99], v9 offset:1024
    s_waitcnt vmcnt(11) lgkmcnt(8)
    v_mfma_f32_32x32x16_bf16 v[112:127], v[104:107], v[152:155], v[112:127]
    ds_read_b64_tr_b16 v[100:101], v10 offset:0
    ds_read_b64_tr_b16 v[102:103], v10 offset:1024
    s_waitcnt lgkmcnt(8)
    v_mfma_f32_32x32x16_bf16 v[128:143], v[108:111], v[152:155], v[128:143]
    s_lshl_b32 s82, s81, 11
    v_add_u32 v72, s82, v14
    v_xor_b32 v73, 0x1000, v72
    v_add_u32 v74, 122880, v72
    ds_read_b64_tr_b16 v[104:105], v9 offset:2048
    ds_read_b64_tr_b16 v[106:107], v9 offset:3072
    s_waitcnt vmcnt(10) lgkmcnt(8)
    v_mfma_f32_32x32x16_bf16 v[112:127], v[88:91], v[156:159], v[112:127]
    ds_read_b64_tr_b16 v[108:109], v10 offset:2048
    ds_read_b64_tr_b16 v[110:111], v10 offset:3072
    s_waitcnt lgkmcnt(8)
    v_mfma_f32_32x32x16_bf16 v[128:143], v[92:95], v[156:159], v[128:143]
    v_add_u32 v75, 122880, v73
    s_xor_b32 s80, s75, 8
    s_lshl_b32 s80, s80, 2
    s_add_u32 s80, s80, s81
    ds_read_b64_tr_b16 v[88:89], v9 offset:8192
    ds_read_b64_tr_b16 v[90:91], v9 offset:9216
    s_waitcnt vmcnt(9) lgkmcnt(8)
    v_mfma_f32_32x32x16_bf16 v[112:127], v[96:99], v[160:163], v[112:127]
    ds_read_b64_tr_b16 v[92:93], v10 offset:8192
    ds_read_b64_tr_b16 v[94:95], v10 offset:9216
    s_waitcnt lgkmcnt(8)
    v_mfma_f32_32x32x16_bf16 v[128:143], v[100:103], v[160:163], v[128:143]
    s_lshl_b32 s73, s80, 12
    s_add_u32 s73, s73, 10485760
    s_lshl_b32 s80, s80, 7
    s_add_u32 s47, s80, 17059840
    ds_read_b64_tr_b16 v[96:97], v9 offset:10240
    ds_read_b64_tr_b16 v[98:99], v9 offset:11264
    s_waitcnt vmcnt(7) lgkmcnt(8)
    v_mfma_f32_32x32x16_bf16 v[112:127], v[104:107], v[164:167], v[112:127]
    ds_read_b64_tr_b16 v[100:101], v10 offset:10240
    ds_read_b64_tr_b16 v[102:103], v10 offset:11264
    s_waitcnt lgkmcnt(8)
    v_mfma_f32_32x32x16_bf16 v[128:143], v[108:111], v[164:167], v[128:143]
    ds_read_b64_tr_b16 v[104:105], v9 offset:16384
    ds_read_b64_tr_b16 v[106:107], v9 offset:17408
    s_waitcnt vmcnt(6) lgkmcnt(8)
    v_mfma_f32_32x32x16_bf16 v[112:127], v[88:91], v[168:171], v[112:127]
    ds_read_b64_tr_b16 v[108:109], v10 offset:16384
    ds_read_b64_tr_b16 v[110:111], v10 offset:17408
    s_waitcnt lgkmcnt(8)
    v_mfma_f32_32x32x16_bf16 v[128:143], v[92:95], v[168:171], v[128:143]
    ds_read_b64_tr_b16 v[88:89], v9 offset:18432
    ds_read_b64_tr_b16 v[90:91], v9 offset:19456
    s_waitcnt vmcnt(5) lgkmcnt(8)
    v_mfma_f32_32x32x16_bf16 v[112:127], v[96:99], v[172:175], v[112:127]
    ds_read_b64_tr_b16 v[92:93], v10 offset:18432
    ds_read_b64_tr_b16 v[94:95], v10 offset:19456
    s_waitcnt lgkmcnt(8)
    v_mfma_f32_32x32x16_bf16 v[128:143], v[100:103], v[172:175], v[128:143]
    ds_read_b64_tr_b16 v[96:97], v5 offset:0
    ds_read_b64_tr_b16 v[98:99], v5 offset:1024
    s_waitcnt vmcnt(3) lgkmcnt(8)
    v_mfma_f32_32x32x16_bf16 v[112:127], v[104:107], v[176:179], v[112:127]
    ds_read_b64_tr_b16 v[100:101], v6 offset:0
    ds_read_b64_tr_b16 v[102:103], v6 offset:1024
    s_waitcnt lgkmcnt(8)
    v_mfma_f32_32x32x16_bf16 v[128:143], v[108:111], v[176:179], v[128:143]
    s_barrier
    ds_read_b64_tr_b16 v[104:105], v5 offset:2048
    ds_read_b64_tr_b16 v[106:107], v5 offset:3072
    s_waitcnt vmcnt(2) lgkmcnt(8)
    v_mfma_f32_32x32x16_bf16 v[112:127], v[88:91], v[180:183], v[112:127]
    ds_read_b64_tr_b16 v[108:109], v6 offset:2048
    ds_read_b64_tr_b16 v[110:111], v6 offset:3072
    s_waitcnt lgkmcnt(8)
    v_mfma_f32_32x32x16_bf16 v[128:143], v[92:95], v[180:183], v[128:143]
    ds_read_b64_tr_b16 v[88:89], v5 offset:8192
    ds_read_b64_tr_b16 v[90:91], v5 offset:9216
    s_waitcnt vmcnt(1) lgkmcnt(8)
    v_mfma_f32_32x32x16_bf16 v[112:127], v[96:99], v[184:187], v[112:127]
    ds_read_b64_tr_b16 v[92:93], v6 offset:8192
    ds_read_b64_tr_b16 v[94:95], v6 offset:9216
    s_waitcnt lgkmcnt(8)
    v_mfma_f32_32x32x16_bf16 v[128:143], v[100:103], v[184:187], v[128:143]
    s_lshl_b32 s80, s7, 3
    s_add_u32 s80, s80, s78
    s_add_u32 s78, s78, 32768
    s_add_u32 s80, s80, 32768
    v_mov_b32 v22, s44
    v_mov_b32_e64 v23, s45
    s_mov_b64 exec, 1
    buffer_store_dwordx2 v[22:23], off, s[36:39], s80 sc1
    s_mov_b64 exec, -1
    ds_read_b64_tr_b16 v[96:97], v5 offset:10240
    ds_read_b64_tr_b16 v[98:99], v5 offset:11264
    s_waitcnt vmcnt(1) lgkmcnt(8)
    v_mfma_f32_32x32x16_bf16 v[112:127], v[104:107], v[188:191], v[112:127]
    ds_read_b64_tr_b16 v[100:101], v6 offset:10240
    ds_read_b64_tr_b16 v[102:103], v6 offset:11264
    s_waitcnt lgkmcnt(8)
    v_mfma_f32_32x32x16_bf16 v[128:143], v[108:111], v[188:191], v[128:143]
    s_waitcnt lgkmcnt(6)
    v_mfma_f32_32x32x16_bf16 v[112:127], v[88:91], v[40:43], v[112:127]
    s_waitcnt lgkmcnt(4)
    v_mfma_f32_32x32x16_bf16 v[128:143], v[92:95], v[40:43], v[128:143]
    s_waitcnt lgkmcnt(2)
    v_mfma_f32_32x32x16_bf16 v[112:127], v[96:99], v[44:47], v[112:127]
    s_waitcnt lgkmcnt(0)
    v_mfma_f32_32x32x16_bf16 v[128:143], v[100:103], v[44:47], v[128:143]
    s_setprio 0
    s_buffer_load_dwordx16 s[84:99], s[36:39], s78 offset:0 glc
    s_barrier
    s_mov_b32 s74, 0
    s_waitcnt lgkmcnt(0)
    s_cmp_eq_u64 s[84:85], s[44:45]
    s_cbranch_scc0 L_spr63
    s_cmp_eq_u64 s[86:87], s[44:45]
    s_cbranch_scc0 L_spr63
    s_cmp_eq_u64 s[88:89], s[44:45]
    s_cbranch_scc0 L_spr63
    s_cmp_eq_u64 s[90:91], s[44:45]
    s_cbranch_scc0 L_spr63
    s_cmp_eq_u64 s[92:93], s[44:45]
    s_cbranch_scc0 L_spr63
    s_cmp_eq_u64 s[94:95], s[44:45]
    s_cbranch_scc0 L_spr63
    s_cmp_eq_u64 s[96:97], s[44:45]
    s_cbranch_scc0 L_spr63
L_spb64:
    s_setprio 2
    s_add_u32 s80, s48, 4096
    buffer_load_dwordx4 v[200:203], v14, s[36:39], s80 offen offset:0 sc1
    buffer_load_dwordx4 v[204:207], v14, s[36:39], s80 offen offset:1024 sc1
    s_add_u32 s80, s49, 4096
    buffer_load_dwordx4 v[208:211], v14, s[36:39], s80 offen offset:0 sc1
    buffer_load_dwordx4 v[212:215], v14, s[36:39], s80 offen offset:1024 sc1
    s_add_u32 s80, s50, 4096
    buffer_load_dwordx4 v[216:219], v14, s[36:39], s80 offen offset:0 sc1
    buffer_load_dwordx4 v[220:223], v14, s[36:39], s80 offen offset:1024 sc1
    s_add_u32 s80, s51, 4096
    buffer_load_dwordx4 v[224:227], v14, s[36:39], s80 offen offset:0 sc1
    buffer_load_dwordx4 v[228:231], v14, s[36:39], s80 offen offset:1024 sc1
    s_add_u32 s80, s52, 4096
    buffer_load_dwordx4 v[232:235], v14, s[36:39], s80 offen offset:0 sc1
    buffer_load_dwordx4 v[236:239], v14, s[36:39], s80 offen offset:1024 sc1
    s_add_u32 s80, s53, 4096
    buffer_load_dwordx4 v[240:243], v14, s[36:39], s80 offen offset:0 sc1
    buffer_load_dwordx4 v[244:247], v14, s[36:39], s80 offen offset:1024 sc1
    s_setprio 0
    s_cmp_eq_u32 s74, 1
    s_cbranch_scc1 L_h266
    s_barrier
L_h266:
    s_setprio 1
    s_nop 0
    ds_read_b64_tr_b16 v[88:89], v5 offset:16384
    ds_read_b64_tr_b16 v[90:91], v5 offset:17408
    ds_read_b64_tr_b16 v[92:93], v6 offset:16384
    ds_read_b64_tr_b16 v[94:95], v6 offset:17408
    ds_read_b64_tr_b16 v[96:97], v5 offset:18432
    ds_read_b64_tr_b16 v[98:99], v5 offset:19456
    ds_read_b64_tr_b16 v[100:101], v6 offset:18432
    ds_read_b64_tr_b16 v[102:103], v6 offset:19456
    ds_read_b64_tr_b16 v[104:105], v5 offset:24576
    ds_read_b64_tr_b16 v[106:107], v5 offset:25600
    s_waitcnt vmcnt(11) lgkmcnt(8)
    v_mfma_f32_32x32x16_bf16 v[112:127], v[88:91], v[200:203], v[112:127]
    ds_read_b64_tr_b16 v[108:109], v6 offset:24576
    ds_read_b64_tr_b16 v[110:111], v6 offset:25600
    s_waitcnt lgkmcnt(8)
    v_mfma_f32_32x32x16_bf16 v[128:143], v[92:95], v[200:203], v[128:143]
    ds_read_b64_tr_b16 v[88:89], v5 offset:26624
    ds_read_b64_tr_b16 v[90:91], v5 offset:27648
    s_waitcnt vmcnt(10) lgkmcnt(8)
    v_mfma_f32_32x32x16_bf16 v[112:127], v[96:99], v[204:207], v[112:127]
    ds_read_b64_tr_b16 v[92:93], v6 offset:26624
    ds_read_b64_tr_b16 v[94:95], v6 offset:27648
    s_waitcnt lgkmcnt(8)
    v_mfma_f32_32x32x16_bf16 v[128:143], v[100:103], v[204:207], v[128:143]
    ds_read_b64_tr_b16 v[96:97], v5 offset:32768
    ds_read_b64_tr_b16 v[98:99], v5 offset:33792
    s_waitcnt vmcnt(9) lgkmcnt(8)
    v_mfma_f32_32x32x16_bf16 v[112:127], v[104:107], v[208:211], v[112:127]
    ds_read_b64_tr_b16 v[100:101], v6 offset:32768
    ds_read_b64_tr_b16 v[102:103], v6 offset:33792
    s_waitcnt lgkmcnt(8)
    v_mfma_f32_32x32x16_bf16 v[128:143], v[108:111], v[208:211], v[128:143]
    ds_read_b64_tr_b16 v[104:105], v5 offset:34816
    ds_read_b64_tr_b16 v[106:107], v5 offset:35840
    s_waitcnt vmcnt(8) lgkmcnt(8)
    v_mfma_f32_32x32x16_bf16 v[112:127], v[88:91], v[212:215], v[112:127]
    ds_read_b64_tr_b16 v[108:109], v6 offset:34816
    ds_read_b64_tr_b16 v[110:111], v6 offset:35840
    s_waitcnt lgkmcnt(8)
    v_mfma_f32_32x32x16_bf16 v[128:143], v[92:95], v[212:215], v[128:143]
    ds_read_b64_tr_b16 v[88:89], v5 offset:40960
    ds_read_b64_tr_b16 v[90:91], v5 offset:41984
    s_waitcnt vmcnt(7) lgkmcnt(8)
    v_mfma_f32_32x32x16_bf16 v[112:127], v[96:99], v[216:219], v[112:127]
    ds_read_b64_tr_b16 v[92:93], v6 offset:40960
    ds_read_b64_tr_b16 v[94:95], v6 offset:41984
    s_waitcnt lgkmcnt(8)
    v_mfma_f32_32x32x16_bf16 v[128:143], v[100:103], v[216:219], v[128:143]
    ds_read_b64_tr_b16 v[96:97], v5 offset:43008
    ds_read_b64_tr_b16 v[98:99], v5 offset:44032
    s_waitcnt vmcnt(6) lgkmcnt(8)
    v_mfma_f32_32x32x16_bf16 v[112:127], v[104:107], v[220:223], v[112:127]
    ds_read_b64_tr_b16 v[100:101], v6 offset:43008
    ds_read_b64_tr_b16 v[102:103], v6 offset:44032
    s_waitcnt lgkmcnt(8)
    v_mfma_f32_32x32x16_bf16 v[128:143], v[108:111], v[220:223], v[128:143]
    ds_read_b64_tr_b16 v[104:105], v5 offset:49152
    ds_read_b64_tr_b16 v[106:107], v5 offset:50176
    s_waitcnt vmcnt(5) lgkmcnt(8)
    v_mfma_f32_32x32x16_bf16 v[112:127], v[88:91], v[224:227], v[112:127]
    ds_read_b64_tr_b16 v[108:109], v6 offset:49152
    ds_read_b64_tr_b16 v[110:111], v6 offset:50176
    s_waitcnt lgkmcnt(8)
    v_mfma_f32_32x32x16_bf16 v[128:143], v[92:95], v[224:227], v[128:143]
    ds_read_b64_tr_b16 v[88:89], v5 offset:51200
    ds_read_b64_tr_b16 v[90:91], v5 offset:52224
    s_waitcnt vmcnt(4) lgkmcnt(8)
    v_mfma_f32_32x32x16_bf16 v[112:127], v[96:99], v[228:231], v[112:127]
    ds_read_b64_tr_b16 v[92:93], v6 offset:51200
    ds_read_b64_tr_b16 v[94:95], v6 offset:52224
    s_waitcnt lgkmcnt(8)
    v_mfma_f32_32x32x16_bf16 v[128:143], v[100:103], v[228:231], v[128:143]
    ds_read_b64_tr_b16 v[96:97], v9 offset:24576
    ds_read_b64_tr_b16 v[98:99], v9 offset:25600
    s_waitcnt vmcnt(3) lgkmcnt(8)
    v_mfma_f32_32x32x16_bf16 v[112:127], v[104:107], v[232:235], v[112:127]
    ds_read_b64_tr_b16 v[100:101], v10 offset:24576
    ds_read_b64_tr_b16 v[102:103], v10 offset:25600
    s_waitcnt lgkmcnt(8)
    v_mfma_f32_32x32x16_bf16 v[128:143], v[108:111], v[232:235], v[128:143]
    ds_read_b64_tr_b16 v[104:105], v9 offset:26624
    ds_read_b64_tr_b16 v[106:107], v9 offset:27648
    s_waitcnt vmcnt(2) lgkmcnt(8)
    v_mfma_f32_32x32x16_bf16 v[112:127], v[88:91], v[236:239], v[112:127]
    ds_read_b64_tr_b16 v[108:109], v10 offset:26624
    ds_read_b64_tr_b16 v[110:111], v10 offset:27648
    s_waitcnt lgkmcnt(8)
    v_mfma_f32_32x32x16_bf16 v[128:143], v[92:95], v[236:239], v[128:143]
    ds_read_b64_tr_b16 v[88:89], v5 offset:57344
    ds_read_b64_tr_b16 v[90:91], v5 offset:58368
    s_waitcnt vmcnt(1) lgkmcnt(8)
    v_mfma_f32_32x32x16_bf16 v[112:127], v[96:99], v[240:243], v[112:127]
    ds_read_b64_tr_b16 v[92:93], v6 offset:57344
    ds_read_b64_tr_b16 v[94:95], v6 offset:58368
    s_waitcnt lgkmcnt(8)
    v_mfma_f32_32x32x16_bf16 v[128:143], v[100:103], v[240:243], v[128:143]
    ds_read_b64_tr_b16 v[96:97], v5 offset:59392
    ds_read_b64_tr_b16 v[98:99], v5 offset:60416
    s_waitcnt vmcnt(0) lgkmcnt(8)
    v_mfma_f32_32x32x16_bf16 v[112:127], v[104:107], v[244:247], v[112:127]
    ds_read_b64_tr_b16 v[100:101], v6 offset:59392
    ds_read_b64_tr_b16 v[102:103], v6 offset:60416
    s_waitcnt lgkmcnt(8)
    v_mfma_f32_32x32x16_bf16 v[128:143], v[108:111], v[244:247], v[128:143]
    s_waitcnt lgkmcnt(6)
    v_mfma_f32_32x32x16_bf16 v[112:127], v[88:91], v[48:51], v[112:127]
    s_waitcnt lgkmcnt(4)
    v_mfma_f32_32x32x16_bf16 v[128:143], v[92:95], v[48:51], v[128:143]
    s_waitcnt lgkmcnt(2)
    v_mfma_f32_32x32x16_bf16 v[112:127], v[96:99], v[52:55], v[112:127]
    s_waitcnt lgkmcnt(0)
    v_mfma_f32_32x32x16_bf16 v[128:143], v[100:103], v[52:55], v[128:143]
    s_setprio 0
    s_nop 10
    ds_write_b128 v75, v[128:131] offset:0
    ds_write_b128 v75, v[132:135] offset:1024
    ds_write_b128 v75, v[136:139] offset:8192
    ds_write_b128 v75, v[140:143] offset:9216
    s_waitcnt lgkmcnt(0)
    s_barrier
    s_buffer_load_dwordx2 s[84:85], s[36:39], s47 offset:0 glc
    ds_read_b128 v[128:131], v74 offset:0
    ds_read_b128 v[132:135], v74 offset:1024
    ds_read_b128 v[136:139], v74 offset:8192
    ds_read_b128 v[140:143], v74 offset:9216
    v_permlane32_swap_b32 v56, v58
    v_permlane32_swap_b32 v57, v59
    v_lshlrev_b32_e64 v160, 16, v56
    v_and_b32 v161, 0xffff0000, v56
    v_lshlrev_b32_e64 v162, 16, v57
    v_and_b32 v163, 0xffff0000, v57
    v_lshlrev_b32_e64 v164, 16, v58
    v_and_b32 v165, 0xffff0000, v58
    v_lshlrev_b32_e64 v166, 16, v59
    v_and_b32 v167, 0xffff0000, v59
    v_permlane32_swap_b32 v84, v86
    v_permlane32_swap_b32 v85, v87
    v_lshlrev_b32_e64 v168, 16, v84
    v_and_b32 v169, 0xffff0000, v84
    v_lshlrev_b32_e64 v170, 16, v85
    v_and_b32 v171, 0xffff0000, v85
    v_lshlrev_b32_e64 v172, 16, v86
    v_and_b32 v173, 0xffff0000, v86
    v_lshlrev_b32_e64 v174, 16, v87
    v_and_b32 v175, 0xffff0000, v87
    s_waitcnt lgkmcnt(0)
    s_cmp_eq_u64 s[84:85], s[44:45]
    s_cbranch_scc0 L_spr68
L_spb69:
    s_setprio 3
    buffer_load_dwordx4 v[24:27], v14, s[36:39], s73 offen offset:0 sc1
    buffer_load_dwordx4 v[28:31], v14, s[36:39], s73 offen offset:1024 sc1
    s_setprio 1
    s_waitcnt vmcnt(1)
    v_lshlrev_b32_e64 v144, 16, v24
    v_and_b32 v145, 0xffff0000, v24
    v_lshlrev_b32_e64 v146, 16, v25
    v_and_b32 v147, 0xffff0000, v25
    v_lshlrev_b32_e64 v148, 16, v26
    v_and_b32 v149, 0xffff0000, v26
    v_lshlrev_b32_e64 v150, 16, v27
    v_and_b32 v151, 0xffff0000, v27
    v_add_f32 v112, v112, v144
    v_add_f32 v113, v113, v145
    v_add_f32 v114, v114, v146
    v_add_f32 v115, v115, v147
    v_add_f32 v116, v116, v148
    v_add_f32 v117, v117, v149
    v_add_f32 v118, v118, v150
    v_add_f32 v119, v119, v151
    s_waitcnt vmcnt(0)
    v_lshlrev_b32 v144, 16, v28
    v_and_b32 v145, 0xffff0000, v28
    v_lshlrev_b32_e64 v146, 16, v29
    v_and_b32 v147, 0xffff0000, v29
    v_lshlrev_b32_e64 v148, 16, v30
    v_and_b32 v149, 0xffff0000, v30
    v_lshlrev_b32_e64 v150, 16, v31
    v_and_b32 v151, 0xffff0000, v31
    v_add_f32 v120, v120, v144
    v_add_f32 v121, v121, v145
    v_add_f32 v122, v122, v146
    v_add_f32 v123, v123, v147
    v_add_f32 v124, v124, v148
    v_add_f32 v125, v125, v149
    v_add_f32 v126, v126, v150
    v_add_f32 v127, v127, v151
    v_add_f32 v112, v112, v128
    v_add_f32 v113, v113, v129
    v_add_f32 v114, v114, v130
    v_add_f32 v115, v115, v131
    v_add_f32 v116, v116, v132
    v_add_f32 v117, v117, v133
    v_add_f32 v118, v118, v134
    v_add_f32 v119, v119, v135
    v_add_f32 v120, v120, v136
    v_add_f32 v121, v121, v137
    v_add_f32 v122, v122, v138
    v_add_f32 v123, v123, v139
    v_add_f32 v124, v124, v140
    v_add_f32 v125, v125, v141
    v_add_f32 v126, v126, v142
    v_add_f32 v127, v127, v143
    v_mul_f32 v176, 0xbfb8aa3b, v112
    v_mul_f32 v177, 0xbfb8aa3b, v113
    v_mul_f32 v178, 0xbfb8aa3b, v114
    v_mul_f32 v179, 0xbfb8aa3b, v115
    v_mul_f32 v180, 0xbfb8aa3b, v116
    v_mul_f32 v181, 0xbfb8aa3b, v117
    v_mul_f32 v182, 0xbfb8aa3b, v118
    v_mul_f32 v183, 0xbfb8aa3b, v119
    v_mul_f32 v184, 0xbfb8aa3b, v120
    v_mul_f32 v185, 0xbfb8aa3b, v121
    v_mul_f32 v186, 0xbfb8aa3b, v122
    v_mul_f32 v187, 0xbfb8aa3b, v123
    v_mul_f32 v188, 0xbfb8aa3b, v124
    v_mul_f32 v189, 0xbfb8aa3b, v125
    v_mul_f32 v190, 0xbfb8aa3b, v126
    v_mul_f32 v191, 0xbfb8aa3b, v127
    v_exp_f32 v176, v176
    v_exp_f32 v177, v177
    v_exp_f32 v178, v178
    v_exp_f32 v179, v179
    v_exp_f32 v180, v180
    v_exp_f32 v181, v181
    v_exp_f32 v182, v182
    v_exp_f32 v183, v183
    v_exp_f32 v184, v184
    v_exp_f32 v185, v185
    v_exp_f32 v186, v186
    v_exp_f32 v187, v187
    v_exp_f32 v188, v188
    v_exp_f32 v189, v189
    v_exp_f32 v190, v190
    v_exp_f32 v191, v191
    v_add_f32 v176, 1.0, v176
    v_add_f32 v177, 1.0, v177
    v_add_f32 v178, 1.0, v178
    v_add_f32 v179, 1.0, v179
    v_add_f32 v180, 1.0, v180
    v_add_f32 v181, 1.0, v181
    v_add_f32 v182, 1.0, v182
    v_add_f32 v183, 1.0, v183
    v_add_f32 v184, 1.0, v184
    v_add_f32 v185, 1.0, v185
    v_add_f32 v186, 1.0, v186
    v_add_f32 v187, 1.0, v187
    v_add_f32 v188, 1.0, v188
    v_add_f32 v189, 1.0, v189
    v_add_f32 v190, 1.0, v190
    v_add_f32 v191, 1.0, v191
    v_rcp_f32 v176, v176
    v_rcp_f32 v177, v177
    v_rcp_f32 v178, v178
    v_rcp_f32 v179, v179
    v_rcp_f32 v180, v180
    v_rcp_f32 v181, v181
    v_rcp_f32 v182, v182
    v_rcp_f32 v183, v183
    v_rcp_f32 v184, v184
    v_rcp_f32 v185, v185
    v_rcp_f32 v186, v186
    v_rcp_f32 v187, v187
    v_rcp_f32 v188, v188
    v_rcp_f32 v189, v189
    v_rcp_f32 v190, v190
    v_rcp_f32 v191, v191
    v_mul_f32 v112, v112, v176
    v_mul_f32 v113, v113, v177
    v_mul_f32 v114, v114, v178
    v_mul_f32 v115, v115, v179
    v_mul_f32 v116, v116, v180
    v_mul_f32 v117, v117, v181
    v_mul_f32 v118, v118, v182
    v_mul_f32 v119, v119, v183
    v_mul_f32 v120, v120, v184
    v_mul_f32 v121, v121, v185
    v_mul_f32 v122, v122, v186
    v_mul_f32 v123, v123, v187
    v_mul_f32 v124, v124, v188
    v_mul_f32 v125, v125, v189
    v_mul_f32 v126, v126, v190
    v_mul_f32_e64 v127, v127, v191
    s_barrier
    ds_read_b128 v[192:195], v72 offset:0
    ds_read_b128 v[200:203], v74 offset:16384
    ds_read_b128 v[196:199], v72 offset:1024
    ds_read_b128 v[204:207], v74 offset:17408
    ds_read_b128 v[208:211], v72 offset:8192
    ds_read_b128 v[216:219], v74 offset:24576
    ds_read_b128 v[212:215], v72 offset:9216
    ds_read_b128 v[220:223], v74 offset:25600
    s_waitcnt lgkmcnt(4)
    v_fmac_f32 v160, v112, v192
    v_fmac_f32 v161, v113, v193
    v_fmac_f32 v162, v114, v194
    v_fmac_f32 v163, v115, v195
    v_fmac_f32 v164, v116, v196
    v_fmac_f32 v165, v117, v197
    v_fmac_f32 v166, v118, v198
    v_fmac_f32 v167, v119, v199
    v_fmac_f32 v160, v112, v200
    v_fmac_f32 v161, v113, v201
    v_fmac_f32 v162, v114, v202
    v_fmac_f32 v163, v115, v203
    v_fmac_f32 v164, v116, v204
    v_fmac_f32 v165, v117, v205
    v_fmac_f32 v166, v118, v206
    v_fmac_f32_e64 v167, v119, v207
    v_cvt_pk_bf16_f32 v176, v160, v161
    v_cvt_pk_bf16_f32 v177, v162, v163
    v_cvt_pk_bf16_f32 v178, v164, v165
    v_cvt_pk_bf16_f32 v179, v166, v167
    s_nop 0
    v_permlane32_swap_b32 v176, v178
    v_permlane32_swap_b32 v177, v179
    buffer_store_dwordx4 v[176:179], v11, s[32:35], 0 offen offset:0
    s_waitcnt lgkmcnt(0)
    v_fmac_f32 v168, v120, v208
    v_fmac_f32 v169, v121, v209
    v_fmac_f32 v170, v122, v210
    v_fmac_f32 v171, v123, v211
    v_fmac_f32 v172, v124, v212
    v_fmac_f32 v173, v125, v213
    v_fmac_f32 v174, v126, v214
    v_fmac_f32 v175, v127, v215
    v_fmac_f32 v168, v120, v216
    v_fmac_f32 v169, v121, v217
    v_fmac_f32 v170, v122, v218
    v_fmac_f32 v171, v123, v219
    v_fmac_f32 v172, v124, v220
    v_fmac_f32 v173, v125, v221
    v_fmac_f32 v174, v126, v222
    v_fmac_f32 v175, v127, v223
    v_cvt_pk_bf16_f32 v180, v168, v169
    v_cvt_pk_bf16_f32 v181, v170, v171
    v_cvt_pk_bf16_f32 v182, v172, v173
    v_cvt_pk_bf16_f32 v183, v174, v175
    s_nop 0
    v_permlane32_swap_b32 v180, v182
    v_permlane32_swap_b32 v181, v183
    buffer_store_dwordx4 v[180:183], v11, s[32:35], 0 offen offset:32
    s_endpgm
L_rare43:
    s_nop 1
    s_mov_b32 s24, s50
    s_mov_b32 s25, s51
    s_mov_b32 s26, 1204224
    s_mov_b32 s71, 86016
    s_mul_i32 s95, s42, 3
    s_add_u32 s95, s95, s81
    s_lshl_b32 s95, s95, 7
    s_lshl_b32 s81, s81, 2
    v_add_u32 v83, s81, v80
    v_min_u32_e64 v83, 13, v83
    v_mul_u32_u24 v2, 2688, v81
    s_mul_i32 s101, s42, 448
    s_add_u32 s72, s101, 224
    s_mov_b32 s94, 7
    v_lshl_add_u32 v82, v77, 2, v78
    v_min_u32 v82, 6, v82
    s_mul_i32 s80, s4, 112
    v_lshl_add_u32 v82, v82, 3, s80
    v_lshrrev_b32_e64 v85, 7, v82
    v_mul_u32_u24 v85, 1920, v85
    v_xor_b32_e64 v84, v82, v79
    v_add3_u32 v5, v85, v84, v76
    v_add_u32 v82, 56, v82
    v_lshrrev_b32 v85, 7, v82
    v_mul_u32_u24 v85, 1920, v85
    v_xor_b32_e64 v84, v82, v79
    v_add3_u32 v6, v85, v84, v76
    s_nop 1
    s_branch L_back44
L_rare46:
    s_nop 1
    s_add_u32 m0, s46, 156672
    s_nop 0
    buffer_load_dwordx4 v14, s[16:19], s93 offen lds
    s_nop 1
    s_branch L_back47
L_rare48:
    s_nop 1
    s_mov_b32 s79, 65536
L_vpl50:
    s_sleep 4
    buffer_load_dwordx4 v[84:87], v56, s[36:39], s96 offen sc1
    s_sub_u32 s79, s79, 1
    s_waitcnt vmcnt(0)
    s_cbranch_scc1 L_vpd51
    v_cmp_ne_u64 vcc, s[44:45], v[84:85]
    v_cmp_ne_u64 s[84:85], s[44:45], v[86:87]
    s_nop 0
    s_or_b64 vcc, vcc, s[84:85]
    s_cbranch_vccnz L_vpl50
L_vpd51:
    s_nop 1
    s_branch L_back49
L_rare54:
    s_nop 1
    buffer_load_dwordx4 v[56:59], v11, s[8:11], 0 offen
    buffer_load_dwordx4 v[84:87], v11, s[8:11], 0 offen offset:32
    s_nop 1
    s_branch L_back55
L_spr59:
    s_mov_b32 s79, 65536
L_spl61:
    s_sleep 1
    s_buffer_load_dwordx16 s[84:99], s[36:39], s78 offset:0 glc
    s_sub_u32 s79, s79, 1
    s_waitcnt lgkmcnt(0)
    s_cbranch_scc1 L_spb60
    s_cmp_eq_u64 s[84:85], s[44:45]
    s_cbranch_scc0 L_spl61
    s_cmp_eq_u64 s[86:87], s[44:45]
    s_cbranch_scc0 L_spl61
    s_cmp_eq_u64 s[88:89], s[44:45]
    s_cbranch_scc0 L_spl61
    s_cmp_eq_u64 s[90:91], s[44:45]
    s_cbranch_scc0 L_spl61
    s_cmp_eq_u64 s[92:93], s[44:45]
    s_cbranch_scc0 L_spl61
    s_cmp_eq_u64 s[94:95], s[44:45]
    s_cbranch_scc0 L_spl61
    s_cmp_eq_u64 s[96:97], s[44:45]
    s_cbranch_scc0 L_spl61
    s_branch L_spb60
L_spr63:
    s_mov_b32 s79, 65536
L_spl65:
    s_sleep 1
    s_buffer_load_dwordx16 s[84:99], s[36:39], s78 offset:0 glc
    s_sub_u32 s79, s79, 1
    s_waitcnt lgkmcnt(0)
    s_cbranch_scc1 L_spb64
    s_cmp_eq_u64 s[84:85], s[44:45]
    s_cbranch_scc0 L_spl65
    s_cmp_eq_u64 s[86:87], s[44:45]
    s_cbranch_scc0 L_spl65
    s_cmp_eq_u64 s[88:89], s[44:45]
    s_cbranch_scc0 L_spl65
    s_cmp_eq_u64 s[90:91], s[44:45]
    s_cbranch_scc0 L_spl65
    s_cmp_eq_u64 s[92:93], s[44:45]
    s_cbranch_scc0 L_spl65
    s_cmp_eq_u64 s[94:95], s[44:45]
    s_cbranch_scc0 L_spl65
    s_cmp_eq_u64 s[96:97], s[44:45]
    s_cbranch_scc0 L_spl65
    s_branch L_spb64
L_spr68:
    s_mov_b32 s79, 65536
L_spl70:
    s_sleep 1
    s_buffer_load_dwordx2 s[84:85], s[36:39], s47 offset:0 glc
    s_sub_u32 s79, s79, 1
    s_waitcnt lgkmcnt(0)
    s_cbranch_scc1 L_spb69
    s_cmp_eq_u64 s[84:85], s[44:45]
    s_cbranch_scc0 L_spl70
    s_branch L_spb69
L_QA:
    s_setprio 2
    ds_read_b128 v[144:147], v60 offset:0
    ds_read_b128 v[148:151], v61 offset:0
    ds_read_b64_tr_b16 v[88:89], v7 offset:49152
    ds_read_b64_tr_b16 v[90:91], v7 offset:49664
    ds_read_b64_tr_b16 v[92:93], v8 offset:49152
    ds_read_b64_tr_b16 v[94:95], v8 offset:49664
    ds_read_b128 v[152:155], v62 offset:0
    ds_read_b128 v[156:159], v63 offset:0
    ds_read_b64_tr_b16 v[96:97], v7 offset:53248
    ds_read_b64_tr_b16 v[98:99], v7 offset:53760
    ds_read_b64_tr_b16 v[100:101], v8 offset:53248
    ds_read_b64_tr_b16 v[102:103], v8 offset:53760
    ds_read_b64_tr_b16 v[104:105], v7 offset:57344
    ds_read_b64_tr_b16 v[106:107], v7 offset:57856
    s_waitcnt lgkmcnt(10)
    v_mfma_f32_32x32x16_bf16 v[112:127], v[88:91], v[144:147], 0
    ds_read_b64_tr_b16 v[108:109], v8 offset:57344
    ds_read_b64_tr_b16 v[110:111], v8 offset:57856
    s_waitcnt lgkmcnt(10)
    v_mfma_f32_32x32x16_bf16 v[128:143], v[92:95], v[144:147], 0
    ds_read_b128 v[160:163], v60 offset:16384
    ds_read_b128 v[164:167], v61 offset:16384
    ds_read_b128 v[168:171], v62 offset:16384
    ds_read_b64_tr_b16 v[88:89], v7 offset:61440
    ds_read_b64_tr_b16 v[90:91], v7 offset:61952
    s_waitcnt lgkmcnt(11)
    v_mfma_f32_32x32x16_bf16 v[112:127], v[96:99], v[148:151], v[112:127]
    ds_read_b64_tr_b16 v[92:93], v8 offset:61440
    ds_read_b64_tr_b16 v[94:95], v8 offset:61952
    s_waitcnt lgkmcnt(11)
    v_mfma_f32_32x32x16_bf16 v[128:143], v[100:103], v[148:151], v[128:143]
    ds_read_b128 v[172:175], v63 offset:16384
    ds_read_b128 v[176:179], v60 offset:32768
    ds_read_b128 v[180:183], v61 offset:32768
    ds_read_b64_tr_b16 v[96:97], v9 offset:0
    s_waitcnt lgkmcnt(14)
    ds_read_b64_tr_b16 v[98:99], v9 offset:512
    s_waitcnt lgkmcnt(14)
    v_mfma_f32_32x32x16_bf16 v[112:127], v[104:107], v[152:155], v[112:127]
    ds_read_b64_tr_b16 v[100:101], v10 offset:0
    s_waitcnt lgkmcnt(14)
    ds_read_b64_tr_b16 v[102:103], v10 offset:512
    s_waitcnt lgkmcnt(14)
    v_mfma_f32_32x32x16_bf16 v[128:143], v[108:111], v[152:155], v[128:143]
    ds_read_b128 v[184:187], v62 offset:32768
    s_waitcnt lgkmcnt(14)
    ds_read_b128 v[188:191], v63 offset:32768
    s_waitcnt lgkmcnt(14)
    ds_read_b128 v[192:195], v60 offset:49152
    s_waitcnt lgkmcnt(14)
    ds_read_b64_tr_b16 v[104:105], v9 offset:4096
    s_waitcnt lgkmcnt(14)
    ds_read_b64_tr_b16 v[106:107], v9 offset:4608
    s_waitcnt lgkmcnt(14)
    v_mfma_f32_32x32x16_bf16 v[112:127], v[88:91], v[156:159], v[112:127]
    ds_read_b64_tr_b16 v[108:109], v10 offset:4096
    s_waitcnt lgkmcnt(14)
    ds_read_b64_tr_b16 v[110:111], v10 offset:4608
    s_waitcnt lgkmcnt(14)
    v_mfma_f32_32x32x16_bf16 v[128:143], v[92:95], v[156:159], v[128:143]
    ds_read_b128 v[196:199], v61 offset:49152
    s_waitcnt lgkmcnt(14)
    ds_read_b128 v[200:203], v62 offset:49152
    s_waitcnt lgkmcnt(14)
    ds_read_b128 v[204:207], v63 offset:49152
    s_waitcnt lgkmcnt(14)
    ds_read_b64_tr_b16 v[88:89], v9 offset:8192
    s_waitcnt lgkmcnt(14)
    ds_read_b64_tr_b16 v[90:91], v9 offset:8704
    s_waitcnt lgkmcnt(14)
    v_mfma_f32_32x32x16_bf16 v[112:127], v[96:99], v[160:163], v[112:127]
    ds_read_b64_tr_b16 v[92:93], v10 offset:8192
    s_waitcnt lgkmcnt(14)
    ds_read_b64_tr_b16 v[94:95], v10 offset:8704
    s_waitcnt lgkmcnt(14)
    v_mfma_f32_32x32x16_bf16 v[128:143], v[100:103], v[160:163], v[128:143]
    s_waitcnt lgkmcnt(4)
    s_barrier
    ds_read_b128 v[208:211], v64 offset:0
    ds_read_b128 v[212:215], v65 offset:0
    ds_read_b64_tr_b16 v[96:97], v9 offset:12288
    ds_read_b64_tr_b16 v[98:99], v9 offset:12800
    v_mfma_f32_32x32x16_bf16 v[112:127], v[104:107], v[164:167], v[112:127]
    ds_read_b64_tr_b16 v[100:101], v10 offset:12288
    ds_read_b64_tr_b16 v[102:103], v10 offset:12800
    v_mfma_f32_32x32x16_bf16 v[128:143], v[108:111], v[164:167], v[128:143]
    ds_read_b128 v[216:219], v66 offset:0
    ds_read_b128 v[220:223], v67 offset:0
    ds_read_b64_tr_b16 v[104:105], v9 offset:16384
    ds_read_b64_tr_b16 v[106:107], v9 offset:16896
    s_waitcnt lgkmcnt(12)
    v_mfma_f32_32x32x16_bf16 v[112:127], v[88:91], v[168:171], v[112:127]
    ds_read_b64_tr_b16 v[108:109], v10 offset:16384
    ds_read_b64_tr_b16 v[110:111], v10 offset:16896
    s_waitcnt lgkmcnt(12)
    v_mfma_f32_32x32x16_bf16 v[128:143], v[92:95], v[168:171], v[128:143]
    ds_read_b128 v[224:227], v64 offset:16384
    ds_read_b128 v[228:231], v65 offset:16384
    s_add_u32 m0, s100, 40960
    s_add_u32 s80, s73, 40960
    buffer_load_dwordx4 v14, s[36:39], s80 offen sc1 lds
    ds_read_b64_tr_b16 v[88:89], v9 offset:20480
    s_waitcnt lgkmcnt(14)
    ds_read_b64_tr_b16 v[90:91], v9 offset:20992
    s_waitcnt lgkmcnt(12)
    v_mfma_f32_32x32x16_bf16 v[112:127], v[96:99], v[172:175], v[112:127]
    ds_read_b64_tr_b16 v[92:93], v10 offset:20480
    ds_read_b64_tr_b16 v[94:95], v10 offset:20992
    s_waitcnt lgkmcnt(12)
    s_nop 0
    v_mfma_f32_32x32x16_bf16 v[128:143], v[100:103], v[172:175], v[128:143]
    ds_read_b128 v[232:235], v66 offset:16384
    ds_read_b128 v[236:239], v67 offset:16384
    s_add_u32 m0, s100, 45056
    s_add_u32 s80, s73, 45056
    buffer_load_dwordx4 v14, s[36:39], s80 offen sc1 lds
    s_waitcnt lgkmcnt(10)
    v_mfma_f32_32x32x16_bf16 v[112:127], v[104:107], v[176:179], v[112:127]
    s_waitcnt lgkmcnt(8)
    v_mfma_f32_32x32x16_bf16 v[128:143], v[108:111], v[176:179], v[128:143]
    ds_read_b128 v[240:243], v64 offset:32768
    ds_read_b128 v[244:247], v65 offset:32768
    s_add_u32 m0, s100, 49152
    s_add_u32 s80, s73, 49152
    buffer_load_dwordx4 v14, s[36:39], s80 offen sc1 lds
    s_waitcnt lgkmcnt(6)
    v_mfma_f32_32x32x16_bf16 v[112:127], v[88:91], v[180:183], v[112:127]
    s_waitcnt lgkmcnt(4)
    v_mfma_f32_32x32x16_bf16 v[128:143], v[92:95], v[180:183], v[128:143]
    ds_read_b128 v[248:251], v66 offset:32768
    ds_read_b128 v[252:255], v67 offset:32768
    ds_read_b32 v69, v68
    s_add_u32 m0, s100, 53248
    s_add_u32 s80, s73, 53248
    buffer_load_dwordx4 v14, s[36:39], s80 offen sc1 lds
    s_setprio 0
    s_waitcnt lgkmcnt(0)
    v_rcp_f32 v19, v69
    v_mul_f32 v17, v69, v69
    v_mul_f32 v18, 0x3fb8aa3b, v19
    s_barrier
    s_nop 0
    s_add_u32 m0, s100, 57344
    s_add_u32 s80, s101, 430080
    buffer_load_dwordx4 v2, s[24:27], s80 offen  lds
    s_add_u32 m0, s100, 61440
    s_add_u32 s80, s101, 473088
    buffer_load_dwordx4 v2, s[24:27], s80 offen  lds
    s_add_u32 m0, s100, 65536
    s_add_u32 s80, s101, 516096
    buffer_load_dwordx4 v2, s[24:27], s80 offen  lds
    s_add_u32 m0, s100, 69632
    s_add_u32 s80, s101, 559104
    buffer_load_dwordx4 v2, s[24:27], s80 offen  lds
    s_add_u32 m0, s100, 73728
    s_add_u32 s80, s101, 602112
    buffer_load_dwordx4 v2, s[24:27], s80 offen  lds
    s_add_u32 m0, s100, 77824
    s_add_u32 s80, s101, 645120
    buffer_load_dwordx4 v2, s[24:27], s80 offen  lds
    s_add_u32 m0, s100, 81920
    s_add_u32 s80, s101, 688128
    buffer_load_dwordx4 v2, s[24:27], s80 offen  lds
    s_add_u32 m0, s100, 86016
    s_add_u32 s80, s101, 731136
    buffer_load_dwordx4 v2, s[24:27], s80 offen  lds
    v_lshrrev_b32_e64 v84, 5, v0
    v_bfe_u32 v85, v0, 2, 2
    v_lshl_add_u32 v86, v84, 2, v85
    v_lshlrev_b32 v86, 7, v86
    v_lshrrev_b32 v85, 1, v85
    v_lshl_add_u32 v84, v85, 2, v84
    v_lshlrev_b32_e64 v84, 4, v84
    v_bfe_u32 v85, v0, 4, 1
    v_lshlrev_b32 v85, 5, v85
    v_and_b32 v87, 3, v0
    v_lshl_add_u32 v85, v87, 3, v85
    s_and_b32 s81, s3, 1
    s_lshl_b32 s80, s81, 6
    v_add_u32 v85, s80, v85
    v_xor_b32_e64 v84, v84, v85
    s_mov_b32 s80, 0
    v_add3_u32 v84, v84, v86, s80
    v_xor_b32_e64 v85, 32, v84
    v_add_u32 v86, 16384, v14
    s_lshl_b32 s80, s43, 4
    s_add_u32 s80, s80, s6
    s_lshl_b32 s73, s80, 1
    s_add_u32 s73, s73, s81
    s_lshl_b32 s73, s73, 11
    s_add_u32 s73, s73, 14680064
    s_lshl_b32 s80, s80, 4
    s_add_u32 s80, s80, s81
    s_lshl_b32 s80, s80, 3
    s_add_u32 s47, s80, 16941056
    s_waitcnt vmcnt(8)
    s_barrier
    s_cmp_eq_u32 s4, 1
    s_cbranch_scc1 L_QV
L_QK:
    s_setprio 2
    s_nop 0
    ds_read_b64_tr_b16 v[88:89], v12 offset:0
    ds_read_b64_tr_b16 v[90:91], v12 offset:256
    ds_read_b64_tr_b16 v[92:93], v12 offset:1024
    ds_read_b64_tr_b16 v[94:95], v12 offset:1280
    ds_read_b64_tr_b16 v[96:97], v12 offset:2048
    ds_read_b64_tr_b16 v[98:99], v12 offset:2304
    ds_read_b64_tr_b16 v[100:101], v12 offset:3072
    ds_read_b64_tr_b16 v[102:103], v12 offset:3328
    ds_read_b64_tr_b16 v[104:105], v12 offset:8192
    ds_read_b64_tr_b16 v[106:107], v12 offset:8448
    ds_read_b64_tr_b16 v[108:109], v12 offset:9216
    ds_read_b64_tr_b16 v[110:111], v12 offset:9472
    s_waitcnt lgkmcnt(10)
    v_mfma_f32_32x32x16_bf16 v[24:39], v[88:91], v[144:147], 0
    ds_read_b64_tr_b16 v[88:89], v12 offset:10240
    ds_read_b64_tr_b16 v[90:91], v12 offset:10496
    s_waitcnt lgkmcnt(10)
    v_mfma_f32_32x32x16_bf16 v[24:39], v[92:95], v[148:151], v[24:39]
    ds_read_b64_tr_b16 v[92:93], v12 offset:11264
    ds_read_b64_tr_b16 v[94:95], v12 offset:11520
    s_waitcnt lgkmcnt(10)
    v_mfma_f32_32x32x16_bf16 v[24:39], v[96:99], v[152:155], v[24:39]
    ds_read_b64_tr_b16 v[96:97], v12 offset:16384
    ds_read_b64_tr_b16 v[98:99], v12 offset:16640
    s_waitcnt lgkmcnt(10)
    v_mfma_f32_32x32x16_bf16 v[24:39], v[100:103], v[156:159], v[24:39]
    ds_read_b64_tr_b16 v[100:101], v12 offset:17408
    ds_read_b64_tr_b16 v[102:103], v12 offset:17664
    s_waitcnt lgkmcnt(10)
    v_mfma_f32_32x32x16_bf16 v[24:39], v[104:107], v[160:163], v[24:39]
    ds_read_b64_tr_b16 v[104:105], v12 offset:18432
    ds_read_b64_tr_b16 v[106:107], v12 offset:18688
    s_waitcnt lgkmcnt(10)
    v_mfma_f32_32x32x16_bf16 v[24:39], v[108:111], v[164:167], v[24:39]
    ds_read_b64_tr_b16 v[108:109], v12 offset:19456
    ds_read_b64_tr_b16 v[110:111], v12 offset:19712
    s_waitcnt lgkmcnt(10)
    v_mfma_f32_32x32x16_bf16 v[24:39], v[88:91], v[168:171], v[24:39]
    ds_read_b64_tr_b16 v[88:89], v12 offset:24576
    ds_read_b64_tr_b16 v[90:91], v12 offset:24832
    s_waitcnt lgkmcnt(10)
    v_mfma_f32_32x32x16_bf16 v[24:39], v[92:95], v[172:175], v[24:39]
    ds_read_b64_tr_b16 v[92:93], v12 offset:25600
    ds_read_b64_tr_b16 v[94:95], v12 offset:25856
    s_waitcnt lgkmcnt(10)
    v_mfma_f32_32x32x16_bf16 v[24:39], v[96:99], v[176:179], v[24:39]
    ds_read_b64_tr_b16 v[96:97], v12 offset:26624
    ds_read_b64_tr_b16 v[98:99], v12 offset:26880
    s_waitcnt lgkmcnt(10)
    v_mfma_f32_32x32x16_bf16 v[24:39], v[100:103], v[180:183], v[24:39]
    ds_read_b64_tr_b16 v[100:101], v12 offset:27648
    ds_read_b64_tr_b16 v[102:103], v12 offset:27904
    s_waitcnt lgkmcnt(10)
    v_mfma_f32_32x32x16_bf16 v[24:39], v[104:107], v[184:187], v[24:39]
    ds_read_b64_tr_b16 v[104:105], v12 offset:32768
    ds_read_b64_tr_b16 v[106:107], v12 offset:33024
    s_waitcnt lgkmcnt(10)
    v_mfma_f32_32x32x16_bf16 v[24:39], v[108:111], v[188:191], v[24:39]
    ds_read_b64_tr_b16 v[108:109], v12 offset:33792
    ds_read_b64_tr_b16 v[110:111], v12 offset:34048
    s_waitcnt lgkmcnt(10)
    v_mfma_f32_32x32x16_bf16 v[24:39], v[88:91], v[192:195], v[24:39]
    ds_read_b64_tr_b16 v[88:89], v12 offset:34816
    ds_read_b64_tr_b16 v[90:91], v12 offset:35072
    s_waitcnt lgkmcnt(10)
    v_mfma_f32_32x32x16_bf16 v[24:39], v[92:95], v[196:199], v[24:39]
    ds_read_b64_tr_b16 v[92:93], v12 offset:35840
    ds_read_b64_tr_b16 v[94:95], v12 offset:36096
    s_waitcnt lgkmcnt(10)
    v_mfma_f32_32x32x16_bf16 v[24:39], v[96:99], v[200:203], v[24:39]
    ds_read_b64_tr_b16 v[96:97], v12 offset:40960
    ds_read_b64_tr_b16 v[98:99], v12 offset:41216
    s_waitcnt lgkmcnt(10)
    v_mfma_f32_32x32x16_bf16 v[24:39], v[100:103], v[204:207], v[24:39]
    ds_read_b64_tr_b16 v[100:101], v12 offset:41984
    ds_read_b64_tr_b16 v[102:103], v12 offset:42240
    s_waitcnt lgkmcnt(10)
    v_mfma_f32_32x32x16_bf16 v[24:39], v[104:107], v[208:211], v[24:39]
    ds_read_b64_tr_b16 v[104:105], v12 offset:43008
    ds_read_b64_tr_b16 v[106:107], v12 offset:43264
    s_waitcnt lgkmcnt(10)
    v_mfma_f32_32x32x16_bf16 v[24:39], v[108:111], v[212:215], v[24:39]
    ds_read_b64_tr_b16 v[108:109], v12 offset:44032
    ds_read_b64_tr_b16 v[110:111], v12 offset:44288
    s_waitcnt lgkmcnt(10)
    s_nop 0
    v_mfma_f32_32x32x16_bf16 v[24:39], v[88:91], v[216:219], v[24:39]
    s_add_u32 m0, s100, 122880
    s_add_u32 s80, s101, 1118208
    buffer_load_dwordx4 v2, s[24:27], s80 offen  lds
    ds_read_b64_tr_b16 v[88:89], v12 offset:49152
    ds_read_b64_tr_b16 v[90:91], v12 offset:49408
    s_waitcnt lgkmcnt(10)
    v_mfma_f32_32x32x16_bf16 v[24:39], v[92:95], v[220:223], v[24:39]
    ds_read_b64_tr_b16 v[92:93], v12 offset:50176
    ds_read_b64_tr_b16 v[94:95], v12 offset:50432
    s_waitcnt lgkmcnt(10)
    v_mfma_f32_32x32x16_bf16 v[24:39], v[96:99], v[224:227], v[24:39]
    s_add_u32 m0, s100, 126976
    s_add_u32 s80, s101, 1161216
    buffer_load_dwordx4 v2, s[24:27], s80 offen  lds
    ds_read_b64_tr_b16 v[96:97], v12 offset:51200
    ds_read_b64_tr_b16 v[98:99], v12 offset:51456
    s_waitcnt lgkmcnt(10)
    v_mfma_f32_32x32x16_bf16 v[24:39], v[100:103], v[228:231], v[24:39]
    ds_read_b64_tr_b16 v[100:101], v12 offset:52224
    ds_read_b64_tr_b16 v[102:103], v12 offset:52480
    s_waitcnt lgkmcnt(10)
    v_mfma_f32_32x32x16_bf16 v[24:39], v[104:107], v[232:235], v[24:39]
    s_waitcnt lgkmcnt(8)
    v_mfma_f32_32x32x16_bf16 v[24:39], v[108:111], v[236:239], v[24:39]
    ds_read_b64_tr_b16 v[60:61], v75 offset:0
    ds_read_b64_tr_b16 v[62:63], v75 offset:448
    ds_read_b64_tr_b16 v[64:65], v75 offset:896
    ds_read_b64_tr_b16 v[66:67], v75 offset:1344
    s_waitcnt lgkmcnt(10)
    v_mfma_f32_32x32x16_bf16 v[24:39], v[88:91], v[240:243], v[24:39]
    s_waitcnt lgkmcnt(8)
    v_mfma_f32_32x32x16_bf16 v[24:39], v[92:95], v[244:247], v[24:39]
    s_waitcnt lgkmcnt(6)
    v_mfma_f32_32x32x16_bf16 v[24:39], v[96:99], v[248:251], v[24:39]
    s_waitcnt lgkmcnt(4)
    v_mfma_f32_32x32x16_bf16 v[24:39], v[100:103], v[252:255], v[24:39]
    s_waitcnt lgkmcnt(0)
    v_cndmask_b32 v66, v66, 0, s[68:69]
    v_cndmask_b32 v67, v67, 0, s[68:69]
    s_nop 8
    s_nop 0
    v_cvt_pk_bf16_f32 v96, v24, v25
    v_cvt_pk_bf16_f32 v97, v26, v27
    v_cvt_pk_bf16_f32 v98, v28, v29
    v_cvt_pk_bf16_f32 v99, v30, v31
    v_cvt_pk_bf16_f32 v100, v32, v33
    v_cvt_pk_bf16_f32 v101, v34, v35
    v_cvt_pk_bf16_f32 v102, v36, v37
    v_cvt_pk_bf16_f32 v103, v38, v39
    v_mfma_f32_32x32x16_bf16 v[40:55], v[60:63], v[96:99], 0
    s_nop 0
    v_mfma_f32_32x32x16_bf16 v[40:55], v[64:67], v[100:103], v[40:55]
    s_setprio 0
    s_nop 10
    s_nop 0
    v_max3_f32 v104, v40, v41, v42
    v_min3_f32 v105, v40, v41, v42
    v_cndmask_b32 v52, v52, v54, s[68:69]
    v_cndmask_b32 v53, v53, v55, s[68:69]
    v_max3_f32 v104, v104, v43, v44
    v_min3_f32 v105, v105, v43, v44
    v_max3_f32 v104, v104, v45, v46
    v_min3_f32 v105, v105, v45, v46
    v_max3_f32 v104, v104, v47, v48
    v_min3_f32 v105, v105, v47, v48
    v_max3_f32 v104, v104, v49, v50
    v_min3_f32 v105, v105, v49, v50
    v_max3_f32 v104, v104, v51, v52
    v_min3_f32 v105, v105, v51, v52
    v_max_f32 v104, v104, v53
    v_min_f32 v105, v105, v53
    v_mul_f32 v106, v104, v18
    v_mul_f32 v107, v105, v18
    v_mul_f32 v104, v104, v18
    v_mul_f32 v105, v105, v18
    s_nop 0
    v_permlane32_swap_b32 v104, v106
    v_permlane32_swap_b32 v105, v107
    v_max_f32 v104, v104, v106
    v_min_f32_e64 v105, v105, v107
    v_fma_f32 v24, v40, v18, -v104
    v_fma_f32 v40, -v40, v18, v105
    v_fma_f32 v25, v41, v18, -v104
    v_fma_f32 v41, -v41, v18, v105
    v_fma_f32 v26, v42, v18, -v104
    v_fma_f32 v42, -v42, v18, v105
    v_fma_f32 v27, v43, v18, -v104
    v_fma_f32 v43, -v43, v18, v105
    v_fma_f32 v28, v44, v18, -v104
    v_fma_f32 v44, -v44, v18, v105
    v_fma_f32 v29, v45, v18, -v104
    v_fma_f32 v45, -v45, v18, v105
    v_fma_f32 v30, v46, v18, -v104
    v_fma_f32 v46, -v46, v18, v105
    v_fma_f32 v31, v47, v18, -v104
    v_fma_f32 v47, -v47, v18, v105
    v_fma_f32 v32, v48, v18, -v104
    v_fma_f32 v48, -v48, v18, v105
    v_fma_f32 v33, v49, v18, -v104
    v_fma_f32 v49, -v49, v18, v105
    v_fma_f32 v34, v50, v18, -v104
    v_fma_f32 v50, -v50, v18, v105
    v_fma_f32 v35, v51, v18, -v104
    v_fma_f32 v51, -v51, v18, v105
    v_fma_f32 v36, v52, v18, -v104
    v_fma_f32 v52, -v52, v18, v105
    v_fma_f32 v37, v53, v18, -v104
    v_fma_f32 v53, -v53, v18, v105
    v_exp_f32 v24, v24
    v_exp_f32 v40, v40
    v_exp_f32 v25, v25
    v_exp_f32 v41, v41
    v_exp_f32 v26, v26
    v_exp_f32 v42, v42
    v_exp_f32 v27, v27
    v_exp_f32 v43, v43
    v_exp_f32 v28, v28
    v_exp_f32 v44, v44
    v_exp_f32 v29, v29
    v_exp_f32 v45, v45
    v_exp_f32 v30, v30
    v_exp_f32 v46, v46
    v_exp_f32 v31, v31
    v_exp_f32 v47, v47
    v_exp_f32 v32, v32
    v_exp_f32 v48, v48
    v_exp_f32 v33, v33
    v_exp_f32 v49, v49
    v_exp_f32 v34, v34
    v_exp_f32 v50, v50
    v_exp_f32 v35, v35
    v_exp_f32 v51, v51
    v_exp_f32 v36, v36
    v_exp_f32 v52, v52
    v_exp_f32 v37, v37
    v_exp_f32 v53, v53
    v_add_f32 v104, v24, v25
    v_add_f32 v105, v26, v27
    v_add_f32 v106, v40, v41
    v_add_f32 v107, v42, v43
    v_add_f32 v104, v104, v28
    v_add_f32 v106, v106, v44
    v_add_f32 v105, v105, v29
    v_add_f32 v107, v107, v45
    v_add_f32 v104, v104, v30
    v_add_f32 v106, v106, v46
    v_add_f32 v105, v105, v31
    v_add_f32 v107, v107, v47
    v_add_f32 v104, v104, v32
    v_add_f32 v106, v106, v48
    v_add_f32 v105, v105, v33
    v_add_f32 v107, v107, v49
    v_add_f32 v104, v104, v34
    s_setprio 3
    s_waitcnt vmcnt(0)
    s_barrier
    v_add_f32 v106, v106, v50
    v_add_f32 v105, v105, v35
    v_add_f32 v107, v107, v51
    v_add_f32 v104, v104, v36
    v_add_f32 v106, v106, v52
    v_add_f32 v105, v105, v37
    v_add_f32 v107, v107, v53
    v_add_f32 v104, v104, v105
    v_add_f32 v106, v106, v107
    s_nop 1
    v_permlane32_swap_b32 v104, v106
    v_add_f32 v104, v104, v106
    v_rcp_f32 v104, v104
    s_nop 0
    v_mul_f32 v106, v104, v19
    v_mul_f32 v104, v104, v19
    s_nop 1
    v_permlane32_swap_b32 v104, v106
    v_mul_f32 v24, v24, v104
    v_mul_f32 v25, v25, v104
    v_mul_f32 v26, v26, v104
    v_mul_f32 v27, v27, v104
    v_mul_f32 v28, v28, v104
    v_mul_f32 v29, v29, v104
    v_mul_f32 v30, v30, v104
    v_mul_f32 v31, v31, v104
    v_mul_f32 v32, v32, v104
    v_mul_f32 v33, v33, v104
    v_mul_f32 v34, v34, v104
    v_mul_f32 v35, v35, v104
    v_mul_f32 v36, v36, v104
    v_mul_f32 v37, v37, v104
    v_cvt_pk_bf16_f32 v88, v24, v25
    v_cvt_pk_bf16_f32 v89, v26, v27
    v_cvt_pk_bf16_f32 v90, v28, v29
    v_cvt_pk_bf16_f32 v91, v30, v31
    v_cvt_pk_bf16_f32 v92, v32, v33
    v_cvt_pk_bf16_f32 v93, v34, v35
    v_cvt_pk_bf16_f32 v94, v36, v37
    ds_write_b64 v76, v[88:89]
    ds_write_b64 v77, v[90:91]
    ds_write_b64 v78, v[92:93]
    ds_write_b64 v79, v[94:95]
    v_mul_f32 v40, v40, v106
    v_mul_f32 v41, v41, v106
    v_mul_f32 v42, v42, v106
    v_mul_f32 v43, v43, v106
    v_mul_f32 v44, v44, v106
    v_mul_f32 v45, v45, v106
    v_mul_f32 v46, v46, v106
    v_mul_f32 v47, v47, v106
    v_mul_f32 v48, v48, v106
    v_mul_f32 v49, v49, v106
    v_mul_f32 v50, v50, v106
    v_mul_f32 v51, v51, v106
    v_mul_f32 v52, v52, v106
    v_mul_f32 v53, v53, v106
    v_cvt_pk_bf16_f32 v96, v40, v41
    v_cvt_pk_bf16_f32 v97, v42, v43
    v_cvt_pk_bf16_f32 v98, v44, v45
    v_cvt_pk_bf16_f32 v99, v46, v47
    v_cvt_pk_bf16_f32 v100, v48, v49
    v_cvt_pk_bf16_f32 v101, v50, v51
    v_cvt_pk_bf16_f32 v102, v52, v53
    ds_write_b64 v80, v[96:97]
    ds_write_b64 v81, v[98:99]
    ds_write_b64 v82, v[100:101]
    ds_write_b64 v83, v[102:103]
    s_setprio 0
    s_waitcnt lgkmcnt(0)
    s_barrier
    s_cmp_ge_u32 s3, 4
    s_cbranch_scc1 L_nokv74
    s_setprio 3
    ds_read_b64_tr_b16 v[24:25], v84 offset:0
    ds_read_b64_tr_b16 v[26:27], v85 offset:1024
    ds_read_b128 v[28:31], v86 offset:0
    ds_read_b64_tr_b16 v[32:33], v84 offset:2048
    ds_read_b64_tr_b16 v[34:35], v85 offset:3072
    ds_read_b128 v[36:39], v86 offset:1024
    ds_read_b64_tr_b16 v[40:41], v84 offset:4096
    ds_read_b64_tr_b16 v[42:43], v85 offset:5120
    ds_read_b128 v[44:47], v86 offset:2048
    ds_read_b64_tr_b16 v[48:49], v84 offset:6144
    ds_read_b64_tr_b16 v[50:51], v85 offset:7168
    ds_read_b128 v[52:55], v86 offset:3072
    ds_read_b64_tr_b16 v[88:89], v84 offset:8192
    ds_read_b64_tr_b16 v[90:91], v85 offset:9216
    ds_read_b128 v[92:95], v86 offset:4096
    s_waitcnt lgkmcnt(12)
    v_mfma_f32_32x32x16_bf16 v[60:75], v[24:27], v[28:31], 0
    ds_read_b64_tr_b16 v[96:97], v84 offset:10240
    ds_read_b64_tr_b16 v[98:99], v85 offset:11264
    ds_read_b128 v[100:103], v86 offset:5120
    s_waitcnt lgkmcnt(12)
    v_mfma_f32_32x32x16_bf16 v[60:75], v[32:35], v[36:39], v[60:75]
    ds_read_b64_tr_b16 v[104:105], v84 offset:12288
    ds_read_b64_tr_b16 v[106:107], v85 offset:13312
    ds_read_b128 v[108:111], v86 offset:6144
    s_waitcnt lgkmcnt(12)
    v_mfma_f32_32x32x16_bf16 v[60:75], v[40:43], v[44:47], v[60:75]
    ds_read_b64_tr_b16 v[24:25], v84 offset:14336
    ds_read_b64_tr_b16 v[26:27], v85 offset:15360
    ds_read_b128 v[28:31], v86 offset:7168
    s_waitcnt lgkmcnt(12)
    v_mfma_f32_32x32x16_bf16 v[60:75], v[48:51], v[52:55], v[60:75]
    s_waitcnt lgkmcnt(9)
    v_mfma_f32_32x32x16_bf16 v[60:75], v[88:91], v[92:95], v[60:75]
    s_waitcnt lgkmcnt(6)
    v_mfma_f32_32x32x16_bf16 v[60:75], v[96:99], v[100:103], v[60:75]
    s_waitcnt lgkmcnt(3)
    v_mfma_f32_32x32x16_bf16 v[60:75], v[104:107], v[108:111], v[60:75]
    s_waitcnt lgkmcnt(0)
    v_mfma_f32_32x32x16_bf16 v[60:75], v[24:27], v[28:31], v[60:75]
    s_nop 11
    s_nop 0
    v_cvt_pk_bf16_f32 v60, v60, v61
    v_cvt_pk_bf16_f32 v61, v62, v63
    v_cvt_pk_bf16_f32 v62, v64, v65
    v_cvt_pk_bf16_f32 v63, v66, v67
    v_cvt_pk_bf16_f32 v64, v68, v69
    v_cvt_pk_bf16_f32 v65, v70, v71
    v_cvt_pk_bf16_f32 v66, v72, v73
    v_mov_b32_e64 v67, 0
    buffer_store_dwordx4 v[60:63], v14, s[36:39], s73 offen offset:0 sc1
    buffer_store_dwordx4 v[64:67], v14, s[36:39], s73 offen offset:1024 sc1
    s_setprio 0
L_nokv74:
    s_nop 0
    s_add_u32 m0, s100, 24576
    s_add_u32 s80, s72, 258048
    buffer_load_dwordx4 v2, s[24:27], s80 offen  lds
    s_add_u32 m0, s100, 28672
    s_add_u32 s80, s72, 301056
    buffer_load_dwordx4 v2, s[24:27], s80 offen  lds
    s_add_u32 m0, s100, 32768
    s_add_u32 s80, s72, 344064
    buffer_load_dwordx4 v2, s[24:27], s80 offen  lds
    s_add_u32 m0, s100, 36864
    s_add_u32 s80, s72, 387072
    buffer_load_dwordx4 v2, s[24:27], s80 offen  lds
    s_add_u32 m0, s100, 40960
    s_add_u32 s80, s72, 430080
    buffer_load_dwordx4 v2, s[24:27], s80 offen  lds
    s_add_u32 m0, s100, 45056
    s_add_u32 s80, s72, 473088
    buffer_load_dwordx4 v2, s[24:27], s80 offen  lds
    s_add_u32 m0, s100, 49152
    s_add_u32 s80, s72, 516096
    buffer_load_dwordx4 v2, s[24:27], s80 offen  lds
    s_add_u32 m0, s100, 53248
    s_add_u32 s80, s72, 559104
    buffer_load_dwordx4 v2, s[24:27], s80 offen  lds
    s_setprio 1
    s_nop 0
    ds_read_b64_tr_b16 v[88:89], v5 offset:57344
    ds_read_b64_tr_b16 v[90:91], v5 offset:57856
    ds_read_b64_tr_b16 v[92:93], v6 offset:57344
    ds_read_b64_tr_b16 v[94:95], v6 offset:57856
    ds_read_b64_tr_b16 v[96:97], v5 offset:61440
    ds_read_b64_tr_b16 v[98:99], v5 offset:61952
    ds_read_b64_tr_b16 v[100:101], v6 offset:61440
    ds_read_b64_tr_b16 v[102:103], v6 offset:61952
    ds_read_b64_tr_b16 v[104:105], v7 offset:0
    ds_read_b64_tr_b16 v[106:107], v7 offset:512
    s_waitcnt lgkmcnt(8)
    v_mfma_f32_32x32x16_bf16 v[112:127], v[88:91], v[184:187], v[112:127]
    ds_read_b64_tr_b16 v[108:109], v8 offset:0
    ds_read_b64_tr_b16 v[110:111], v8 offset:512
    s_waitcnt lgkmcnt(8)
    v_mfma_f32_32x32x16_bf16 v[128:143], v[92:95], v[184:187], v[128:143]
    ds_read_b64_tr_b16 v[88:89], v7 offset:4096
    ds_read_b64_tr_b16 v[90:91], v7 offset:4608
    s_waitcnt lgkmcnt(8)
    v_mfma_f32_32x32x16_bf16 v[112:127], v[96:99], v[188:191], v[112:127]
    ds_read_b64_tr_b16 v[92:93], v8 offset:4096
    ds_read_b64_tr_b16 v[94:95], v8 offset:4608
    s_waitcnt lgkmcnt(8)
    v_mfma_f32_32x32x16_bf16 v[128:143], v[100:103], v[188:191], v[128:143]
    ds_read_b64_tr_b16 v[96:97], v7 offset:8192
    ds_read_b64_tr_b16 v[98:99], v7 offset:8704
    s_waitcnt lgkmcnt(8)
    v_mfma_f32_32x32x16_bf16 v[112:127], v[104:107], v[192:195], v[112:127]
    ds_read_b64_tr_b16 v[100:101], v8 offset:8192
    ds_read_b64_tr_b16 v[102:103], v8 offset:8704
    s_waitcnt lgkmcnt(8)
    v_mfma_f32_32x32x16_bf16 v[128:143], v[108:111], v[192:195], v[128:143]
    ds_read_b64_tr_b16 v[104:105], v7 offset:12288
    ds_read_b64_tr_b16 v[106:107], v7 offset:12800
    s_waitcnt lgkmcnt(8)
    v_mfma_f32_32x32x16_bf16 v[112:127], v[88:91], v[196:199], v[112:127]
    ds_read_b64_tr_b16 v[108:109], v8 offset:12288
    ds_read_b64_tr_b16 v[110:111], v8 offset:12800
    s_waitcnt lgkmcnt(8)
    v_mfma_f32_32x32x16_bf16 v[128:143], v[92:95], v[196:199], v[128:143]
    ds_read_b64_tr_b16 v[88:89], v7 offset:16384
    ds_read_b64_tr_b16 v[90:91], v7 offset:16896
    s_waitcnt lgkmcnt(8)
    v_mfma_f32_32x32x16_bf16 v[112:127], v[96:99], v[200:203], v[112:127]
    ds_read_b64_tr_b16 v[92:93], v8 offset:16384
    ds_read_b64_tr_b16 v[94:95], v8 offset:16896
    s_waitcnt lgkmcnt(8)
    v_mfma_f32_32x32x16_bf16 v[128:143], v[100:103], v[200:203], v[128:143]
    s_cmp_lt_u32 s3, 4
    s_cbranch_scc1 L_rare76
L_back77:
    ds_read_b64_tr_b16 v[96:97], v7 offset:20480
    ds_read_b64_tr_b16 v[98:99], v7 offset:20992
    s_waitcnt lgkmcnt(8)
    v_mfma_f32_32x32x16_bf16 v[112:127], v[104:107], v[204:207], v[112:127]
    ds_read_b64_tr_b16 v[100:101], v8 offset:20480
    ds_read_b64_tr_b16 v[102:103], v8 offset:20992
    s_waitcnt lgkmcnt(8)
    v_mfma_f32_32x32x16_bf16 v[128:143], v[108:111], v[204:207], v[128:143]
    ds_read_b64_tr_b16 v[104:105], v7 offset:24576
    ds_read_b64_tr_b16 v[106:107], v7 offset:25088
    s_waitcnt lgkmcnt(8)
    v_mfma_f32_32x32x16_bf16 v[112:127], v[88:91], v[208:211], v[112:127]
    ds_read_b64_tr_b16 v[108:109], v8 offset:24576
    ds_read_b64_tr_b16 v[110:111], v8 offset:25088
    s_waitcnt lgkmcnt(8)
    v_mfma_f32_32x32x16_bf16 v[128:143], v[92:95], v[208:211], v[128:143]
    ds_read_b64_tr_b16 v[88:89], v7 offset:28672
    ds_read_b64_tr_b16 v[90:91], v7 offset:29184
    s_waitcnt lgkmcnt(8)
    v_mfma_f32_32x32x16_bf16 v[112:127], v[96:99], v[212:215], v[112:127]
    ds_read_b64_tr_b16 v[92:93], v8 offset:28672
    ds_read_b64_tr_b16 v[94:95], v8 offset:29184
    s_waitcnt lgkmcnt(8)
    v_mfma_f32_32x32x16_bf16 v[128:143], v[100:103], v[212:215], v[128:143]
    s_barrier
    ds_read_b64_tr_b16 v[96:97], v7 offset:32768
    ds_read_b64_tr_b16 v[98:99], v7 offset:33280
    s_waitcnt lgkmcnt(8)
    v_mfma_f32_32x32x16_bf16 v[112:127], v[104:107], v[216:219], v[112:127]
    ds_read_b64_tr_b16 v[100:101], v8 offset:32768
    ds_read_b64_tr_b16 v[102:103], v8 offset:33280
    s_waitcnt lgkmcnt(8)
    s_nop 0
    v_mfma_f32_32x32x16_bf16 v[128:143], v[108:111], v[216:219], v[128:143]
    s_add_u32 m0, s100, 57344
    s_add_u32 s80, s72, 602112
    buffer_load_dwordx4 v2, s[24:27], s80 offen  lds
    ds_read_b64_tr_b16 v[104:105], v7 offset:36864
    ds_read_b64_tr_b16 v[106:107], v7 offset:37376
    s_waitcnt lgkmcnt(8)
    v_mfma_f32_32x32x16_bf16 v[112:127], v[88:91], v[220:223], v[112:127]
    ds_read_b64_tr_b16 v[108:109], v8 offset:36864
    ds_read_b64_tr_b16 v[110:111], v8 offset:37376
    s_waitcnt lgkmcnt(8)
    v_mfma_f32_32x32x16_bf16 v[128:143], v[92:95], v[220:223], v[128:143]
    s_add_u32 m0, s100, 61440
    s_add_u32 s80, s72, 645120
    buffer_load_dwordx4 v2, s[24:27], s80 offen  lds
    ds_read_b64_tr_b16 v[88:89], v7 offset:40960
    ds_read_b64_tr_b16 v[90:91], v7 offset:41472
    s_waitcnt lgkmcnt(8)
    v_mfma_f32_32x32x16_bf16 v[112:127], v[96:99], v[224:227], v[112:127]
    ds_read_b64_tr_b16 v[92:93], v8 offset:40960
    ds_read_b64_tr_b16 v[94:95], v8 offset:41472
    s_waitcnt lgkmcnt(8)
    v_mfma_f32_32x32x16_bf16 v[128:143], v[100:103], v[224:227], v[128:143]
    s_add_u32 m0, s100, 65536
    s_add_u32 s80, s72, 688128
    buffer_load_dwordx4 v2, s[24:27], s80 offen  lds
    ds_read_b64_tr_b16 v[96:97], v7 offset:45056
    ds_read_b64_tr_b16 v[98:99], v7 offset:45568
    s_waitcnt lgkmcnt(8)
    v_mfma_f32_32x32x16_bf16 v[112:127], v[104:107], v[228:231], v[112:127]
    ds_read_b64_tr_b16 v[100:101], v8 offset:45056
    ds_read_b64_tr_b16 v[102:103], v8 offset:45568
    s_waitcnt lgkmcnt(8)
    v_mfma_f32_32x32x16_bf16 v[128:143], v[108:111], v[228:231], v[128:143]
    s_add_u32 m0, s100, 69632
    s_add_u32 s80, s72, 731136
    buffer_load_dwordx4 v2, s[24:27], s80 offen  lds
    ds_read_b64_tr_b16 v[104:105], v7 offset:49152
    ds_read_b64_tr_b16 v[106:107], v7 offset:49664
    s_waitcnt lgkmcnt(8)
    v_mfma_f32_32x32x16_bf16 v[112:127], v[88:91], v[232:235], v[112:127]
    ds_read_b64_tr_b16 v[108:109], v8 offset:49152
    ds_read_b64_tr_b16 v[110:111], v8 offset:49664
    s_waitcnt lgkmcnt(8)
    v_mfma_f32_32x32x16_bf16 v[128:143], v[92:95], v[232:235], v[128:143]
    s_add_u32 m0, s100, 73728
    s_add_u32 s80, s72, 774144
    buffer_load_dwordx4 v2, s[24:27], s80 offen  lds
    ds_read_b64_tr_b16 v[88:89], v7 offset:53248
    ds_read_b64_tr_b16 v[90:91], v7 offset:53760
    s_waitcnt lgkmcnt(8)
    v_mfma_f32_32x32x16_bf16 v[112:127], v[96:99], v[236:239], v[112:127]
    ds_read_b64_tr_b16 v[92:93], v8 offset:53248
    ds_read_b64_tr_b16 v[94:95], v8 offset:53760
    s_waitcnt lgkmcnt(8)
    v_mfma_f32_32x32x16_bf16 v[128:143], v[100:103], v[236:239], v[128:143]
    s_add_u32 m0, s100, 77824
    s_add_u32 s80, s72, 817152
    buffer_load_dwordx4 v2, s[24:27], s80 offen  lds
    ds_read_b64_tr_b16 v[96:97], v7 offset:57344
    ds_read_b64_tr_b16 v[98:99], v7 offset:57856
    s_waitcnt lgkmcnt(8)
    v_mfma_f32_32x32x16_bf16 v[112:127], v[104:107], v[240:243], v[112:127]
    ds_read_b64_tr_b16 v[100:101], v8 offset:57344
    ds_read_b64_tr_b16 v[102:103], v8 offset:57856
    s_waitcnt lgkmcnt(8)
    v_mfma_f32_32x32x16_bf16 v[128:143], v[108:111], v[240:243], v[128:143]
    s_add_u32 m0, s100, 81920
    s_add_u32 s80, s72, 860160
    buffer_load_dwordx4 v2, s[24:27], s80 offen  lds
    ds_read_b64_tr_b16 v[104:105], v7 offset:61440
    ds_read_b64_tr_b16 v[106:107], v7 offset:61952
    s_waitcnt lgkmcnt(8)
    v_mfma_f32_32x32x16_bf16 v[112:127], v[88:91], v[244:247], v[112:127]
    ds_read_b64_tr_b16 v[108:109], v8 offset:61440
    ds_read_b64_tr_b16 v[110:111], v8 offset:61952
    s_waitcnt lgkmcnt(8)
    v_mfma_f32_32x32x16_bf16 v[128:143], v[92:95], v[244:247], v[128:143]
    s_add_u32 m0, s100, 86016
    s_add_u32 s80, s72, 903168
    buffer_load_dwordx4 v2, s[24:27], s80 offen  lds
    s_waitcnt vmcnt(8) lgkmcnt(0)
    s_barrier
    v_mfma_f32_32x32x16_bf16 v[112:127], v[96:99], v[248:251], v[112:127]
    v_mfma_f32_32x32x16_bf16 v[128:143], v[100:103], v[248:251], v[128:143]
    s_mul_i32 s83, s4, 3136
    s_add_u32 s83, s83, 156672
    v_add_u32_e64 v12, s83, v3
    ds_read_b64_tr_b16 v[76:77], v12 offset:0
    ds_read_b64_tr_b16 v[78:79], v12 offset:448
    ds_read_b64_tr_b16 v[80:81], v12 offset:896
    ds_read_b64_tr_b16 v[82:83], v12 offset:1344
    v_mfma_f32_32x32x16_bf16 v[112:127], v[104:107], v[252:255], v[112:127]
    v_mfma_f32_32x32x16_bf16 v[128:143], v[108:111], v[252:255], v[128:143]
    s_setprio 0
    s_nop 9
    v_cvt_pk_bf16_f32 v40, v112, v113
    v_cvt_pk_bf16_f32 v41, v114, v115
    v_cvt_pk_bf16_f32 v42, v116, v117
    v_cvt_pk_bf16_f32 v43, v118, v119
    v_cvt_pk_bf16_f32 v44, v120, v121
    v_cvt_pk_bf16_f32 v45, v122, v123
    v_cvt_pk_bf16_f32 v46, v124, v125
    v_cvt_pk_bf16_f32 v47, v126, v127
    s_waitcnt lgkmcnt(0)
    v_cndmask_b32 v82, v82, 0, s[68:69]
    v_cndmask_b32 v83, v83, 0, s[68:69]
    s_setprio 3
    v_mfma_f32_32x32x16_bf16 v[112:127], v[76:79], v[40:43], 0
    v_mfma_f32_32x32x16_bf16 v[112:127], v[80:83], v[44:47], v[112:127]
    s_setprio 0
    s_nop 0
    ds_read_b64_tr_b16 v[88:89], v12 offset:1568
    ds_read_b64_tr_b16 v[90:91], v12 offset:2016
    ds_read_b64_tr_b16 v[92:93], v12 offset:2464
    ds_read_b64_tr_b16 v[94:95], v12 offset:2912
    v_cvt_pk_bf16_f32 v48, v128, v129
    v_cvt_pk_bf16_f32 v49, v130, v131
    v_cvt_pk_bf16_f32 v50, v132, v133
    v_cvt_pk_bf16_f32 v51, v134, v135
    v_cvt_pk_bf16_f32 v52, v136, v137
    v_cvt_pk_bf16_f32 v53, v138, v139
    v_cvt_pk_bf16_f32 v54, v140, v141
    v_cvt_pk_bf16_f32 v55, v142, v143
    s_waitcnt lgkmcnt(0)
    v_cndmask_b32 v94, v94, 0, s[68:69]
    v_cndmask_b32 v95, v95, 0, s[68:69]
    s_setprio 3
    v_mfma_f32_32x32x16_bf16 v[60:75], v[88:91], v[48:51], 0
    v_mfma_f32_32x32x16_bf16 v[60:75], v[92:95], v[52:55], v[60:75]
    s_setprio 0
    s_nop 0
    v_max3_f32 v104, v112, v113, v114
    v_min3_f32 v105, v112, v113, v114
    v_cndmask_b32 v124, v124, v126, s[68:69]
    v_cndmask_b32 v125, v125, v127, s[68:69]
    v_max3_f32 v104, v104, v115, v116
    v_min3_f32 v105, v105, v115, v116
    v_max3_f32 v104, v104, v117, v118
    v_min3_f32 v105, v105, v117, v118
    v_max3_f32 v104, v104, v119, v120
    v_min3_f32 v105, v105, v119, v120
    v_max3_f32 v104, v104, v121, v122
    v_min3_f32 v105, v105, v121, v122
    v_max3_f32 v104, v104, v123, v124
    v_min3_f32 v105, v105, v123, v124
    v_max_f32 v104, v104, v125
    v_min_f32 v105, v105, v125
    v_mul_f32 v106, v104, v18
    v_mul_f32 v107, v105, v18
    v_mul_f32 v104, v104, v18
    v_mul_f32 v105, v105, v18
    s_nop 0
    v_permlane32_swap_b32 v104, v106
    v_permlane32_swap_b32 v105, v107
    v_max_f32 v104, v104, v106
    v_min_f32_e64 v105, v105, v107
    v_fma_f32 v88, v112, v18, -v104
    v_fma_f32 v112, -v112, v18, v105
    v_fma_f32 v89, v113, v18, -v104
    v_fma_f32 v113, -v113, v18, v105
    v_fma_f32 v90, v114, v18, -v104
    v_fma_f32 v114, -v114, v18, v105
    v_fma_f32 v91, v115, v18, -v104
    v_fma_f32 v115, -v115, v18, v105
    v_fma_f32 v92, v116, v18, -v104
    v_fma_f32 v116, -v116, v18, v105
    v_fma_f32 v93, v117, v18, -v104
    v_fma_f32 v117, -v117, v18, v105
    v_fma_f32 v94, v118, v18, -v104
    v_fma_f32 v118, -v118, v18, v105
    v_fma_f32 v95, v119, v18, -v104
    v_fma_f32 v119, -v119, v18, v105
    v_fma_f32 v96, v120, v18, -v104
    v_fma_f32 v120, -v120, v18, v105
    v_fma_f32 v97, v121, v18, -v104
    v_fma_f32 v121, -v121, v18, v105
    v_fma_f32 v98, v122, v18, -v104
    v_fma_f32 v122, -v122, v18, v105
    v_fma_f32 v99, v123, v18, -v104
    v_fma_f32 v123, -v123, v18, v105
    v_fma_f32 v100, v124, v18, -v104
    v_fma_f32 v124, -v124, v18, v105
    v_fma_f32 v101, v125, v18, -v104
    v_fma_f32 v125, -v125, v18, v105
    v_exp_f32 v88, v88
    v_exp_f32 v112, v112
    v_exp_f32 v89, v89
    v_exp_f32 v113, v113
    v_exp_f32 v90, v90
    v_exp_f32 v114, v114
    v_exp_f32 v91, v91
    v_exp_f32 v115, v115
    v_exp_f32 v92, v92
    v_exp_f32 v116, v116
    v_exp_f32 v93, v93
    v_exp_f32 v117, v117
    v_exp_f32 v94, v94
    v_exp_f32 v118, v118
    v_exp_f32 v95, v95
    v_exp_f32 v119, v119
    v_exp_f32 v96, v96
    v_exp_f32 v120, v120
    v_exp_f32 v97, v97
    v_exp_f32 v121, v121
    v_exp_f32 v98, v98
    v_exp_f32 v122, v122
    v_exp_f32 v99, v99
    v_exp_f32 v123, v123
    v_exp_f32 v100, v100
    v_exp_f32 v124, v124
    v_exp_f32 v101, v101
    v_exp_f32 v125, v125
    v_mov_b32 v31, 0
    v_mov_b32 v39, 0
    v_cvt_pk_bf16_f32 v24, v88, v89
    v_cvt_pk_bf16_f32 v25, v90, v91
    v_cvt_pk_bf16_f32 v26, v92, v93
    v_cvt_pk_bf16_f32 v27, v94, v95
    v_cvt_pk_bf16_f32 v28, v96, v97
    v_cvt_pk_bf16_f32 v29, v98, v99
    v_cvt_pk_bf16_f32 v30, v100, v101
    v_cvt_pk_bf16_f32 v32, v112, v113
    v_cvt_pk_bf16_f32 v33, v114, v115
    v_cvt_pk_bf16_f32 v34, v116, v117
    v_cvt_pk_bf16_f32 v35, v118, v119
    v_cvt_pk_bf16_f32 v36, v120, v121
    v_cvt_pk_bf16_f32 v37, v122, v123
    v_cvt_pk_bf16_f32 v38, v124, v125
    s_setprio 1
    s_nop 0
    ds_read_b64_tr_b16 v[88:89], v9 offset:0
    ds_read_b64_tr_b16 v[90:91], v9 offset:512
    ds_read_b64_tr_b16 v[92:93], v10 offset:0
    ds_read_b64_tr_b16 v[94:95], v10 offset:512
    ds_read_b64_tr_b16 v[96:97], v9 offset:4096
    ds_read_b64_tr_b16 v[98:99], v9 offset:4608
    ds_read_b64_tr_b16 v[100:101], v10 offset:4096
    ds_read_b64_tr_b16 v[102:103], v10 offset:4608
    ds_read_b64_tr_b16 v[104:105], v9 offset:8192
    ds_read_b64_tr_b16 v[106:107], v9 offset:8704
    s_waitcnt lgkmcnt(8)
    v_mfma_f32_32x32x16_bf16 v[112:127], v[88:91], v[144:147], 0
    ds_read_b64_tr_b16 v[108:109], v10 offset:8192
    ds_read_b64_tr_b16 v[110:111], v10 offset:8704
    s_waitcnt lgkmcnt(8)
    v_mfma_f32_32x32x16_bf16 v[128:143], v[92:95], v[144:147], 0
    ds_read_b64_tr_b16 v[88:89], v9 offset:12288
    ds_read_b64_tr_b16 v[90:91], v9 offset:12800
    s_waitcnt lgkmcnt(8)
    v_mfma_f32_32x32x16_bf16 v[112:127], v[96:99], v[148:151], v[112:127]
    ds_read_b64_tr_b16 v[92:93], v10 offset:12288
    ds_read_b64_tr_b16 v[94:95], v10 offset:12800
    s_waitcnt lgkmcnt(8)
    v_mfma_f32_32x32x16_bf16 v[128:143], v[100:103], v[148:151], v[128:143]
    ds_read_b64_tr_b16 v[96:97], v9 offset:16384
    ds_read_b64_tr_b16 v[98:99], v9 offset:16896
    s_waitcnt lgkmcnt(8)
    v_mfma_f32_32x32x16_bf16 v[112:127], v[104:107], v[152:155], v[112:127]
    ds_read_b64_tr_b16 v[100:101], v10 offset:16384
    ds_read_b64_tr_b16 v[102:103], v10 offset:16896
    s_waitcnt lgkmcnt(8)
    v_mfma_f32_32x32x16_bf16 v[128:143], v[108:111], v[152:155], v[128:143]
    ds_read_b64_tr_b16 v[104:105], v9 offset:20480
    ds_read_b64_tr_b16 v[106:107], v9 offset:20992
    s_waitcnt lgkmcnt(8)
    v_mfma_f32_32x32x16_bf16 v[112:127], v[88:91], v[156:159], v[112:127]
    ds_read_b64_tr_b16 v[108:109], v10 offset:20480
    ds_read_b64_tr_b16 v[110:111], v10 offset:20992
    s_waitcnt lgkmcnt(8)
    v_mfma_f32_32x32x16_bf16 v[128:143], v[92:95], v[156:159], v[128:143]
    ds_read_b64_tr_b16 v[88:89], v5 offset:24576
    ds_read_b64_tr_b16 v[90:91], v5 offset:25088
    s_waitcnt lgkmcnt(8)
    v_mfma_f32_32x32x16_bf16 v[112:127], v[96:99], v[160:163], v[112:127]
    ds_read_b64_tr_b16 v[92:93], v6 offset:24576
    ds_read_b64_tr_b16 v[94:95], v6 offset:25088
    s_waitcnt lgkmcnt(8)
    v_mfma_f32_32x32x16_bf16 v[128:143], v[100:103], v[160:163], v[128:143]
    ds_read_b64_tr_b16 v[96:97], v5 offset:28672
    ds_read_b64_tr_b16 v[98:99], v5 offset:29184
    s_waitcnt lgkmcnt(8)
    v_mfma_f32_32x32x16_bf16 v[112:127], v[104:107], v[164:167], v[112:127]
    ds_read_b64_tr_b16 v[100:101], v6 offset:28672
    ds_read_b64_tr_b16 v[102:103], v6 offset:29184
    s_waitcnt lgkmcnt(8)
    v_mfma_f32_32x32x16_bf16 v[128:143], v[108:111], v[164:167], v[128:143]
    ds_read_b64_tr_b16 v[104:105], v5 offset:32768
    ds_read_b64_tr_b16 v[106:107], v5 offset:33280
    s_waitcnt lgkmcnt(8)
    v_mfma_f32_32x32x16_bf16 v[112:127], v[88:91], v[168:171], v[112:127]
    ds_read_b64_tr_b16 v[108:109], v6 offset:32768
    ds_read_b64_tr_b16 v[110:111], v6 offset:33280
    s_waitcnt lgkmcnt(8)
    v_mfma_f32_32x32x16_bf16 v[128:143], v[92:95], v[168:171], v[128:143]
    ds_read_b64_tr_b16 v[88:89], v5 offset:36864
    ds_read_b64_tr_b16 v[90:91], v5 offset:37376
    s_waitcnt lgkmcnt(8)
    v_mfma_f32_32x32x16_bf16 v[112:127], v[96:99], v[172:175], v[112:127]
    ds_read_b64_tr_b16 v[92:93], v6 offset:36864
    ds_read_b64_tr_b16 v[94:95], v6 offset:37376
    s_waitcnt lgkmcnt(8)
    v_mfma_f32_32x32x16_bf16 v[128:143], v[100:103], v[172:175], v[128:143]
    ds_read_b64_tr_b16 v[96:97], v5 offset:40960
    ds_read_b64_tr_b16 v[98:99], v5 offset:41472
    s_waitcnt lgkmcnt(8)
    v_mfma_f32_32x32x16_bf16 v[112:127], v[104:107], v[176:179], v[112:127]
    ds_read_b64_tr_b16 v[100:101], v6 offset:40960
    ds_read_b64_tr_b16 v[102:103], v6 offset:41472
    s_waitcnt lgkmcnt(8)
    v_mfma_f32_32x32x16_bf16 v[128:143], v[108:111], v[176:179], v[128:143]
    ds_read_b64_tr_b16 v[104:105], v5 offset:45056
    ds_read_b64_tr_b16 v[106:107], v5 offset:45568
    s_waitcnt lgkmcnt(8)
    v_mfma_f32_32x32x16_bf16 v[112:127], v[88:91], v[180:183], v[112:127]
    ds_read_b64_tr_b16 v[108:109], v6 offset:45056
    ds_read_b64_tr_b16 v[110:111], v6 offset:45568
    s_waitcnt lgkmcnt(8)
    v_mfma_f32_32x32x16_bf16 v[128:143], v[92:95], v[180:183], v[128:143]
    ds_read_b64_tr_b16 v[88:89], v5 offset:49152
    ds_read_b64_tr_b16 v[90:91], v5 offset:49664
    s_waitcnt lgkmcnt(8)
    v_mfma_f32_32x32x16_bf16 v[112:127], v[96:99], v[184:187], v[112:127]
    ds_read_b64_tr_b16 v[92:93], v6 offset:49152
    ds_read_b64_tr_b16 v[94:95], v6 offset:49664
    s_waitcnt lgkmcnt(8)
    v_mfma_f32_32x32x16_bf16 v[128:143], v[100:103], v[184:187], v[128:143]
    ds_read_b64_tr_b16 v[96:97], v5 offset:53248
    ds_read_b64_tr_b16 v[98:99], v5 offset:53760
    s_waitcnt lgkmcnt(8)
    v_mfma_f32_32x32x16_bf16 v[112:127], v[104:107], v[188:191], v[112:127]
    ds_read_b64_tr_b16 v[100:101], v6 offset:53248
    ds_read_b64_tr_b16 v[102:103], v6 offset:53760
    s_waitcnt lgkmcnt(8)
    v_mfma_f32_32x32x16_bf16 v[128:143], v[108:111], v[188:191], v[128:143]
    s_waitcnt vmcnt(0) lgkmcnt(0)
    s_barrier
    v_mfma_f32_32x32x16_bf16 v[112:127], v[88:91], v[192:195], v[112:127]
    v_mfma_f32_32x32x16_bf16 v[128:143], v[92:95], v[192:195], v[128:143]
    v_mfma_f32_32x32x16_bf16 v[112:127], v[96:99], v[196:199], v[112:127]
    v_mfma_f32_32x32x16_bf16 v[128:143], v[100:103], v[196:199], v[128:143]
    s_setprio 0
    s_nop 0
    v_max3_f32 v104, v60, v61, v62
    v_min3_f32 v105, v60, v61, v62
    v_cndmask_b32 v72, v72, v74, s[68:69]
    v_cndmask_b32 v73, v73, v75, s[68:69]
    v_max3_f32 v104, v104, v63, v64
    v_min3_f32 v105, v105, v63, v64
    v_max3_f32 v104, v104, v65, v66
    v_min3_f32 v105, v105, v65, v66
    v_max3_f32 v104, v104, v67, v68
    v_min3_f32 v105, v105, v67, v68
    v_max3_f32 v104, v104, v69, v70
    v_min3_f32 v105, v105, v69, v70
    v_max3_f32 v104, v104, v71, v72
    v_min3_f32 v105, v105, v71, v72
    v_max_f32 v104, v104, v73
    v_min_f32 v105, v105, v73
    v_mul_f32 v106, v104, v18
    v_mul_f32 v107, v105, v18
    v_mul_f32 v104, v104, v18
    v_mul_f32 v105, v105, v18
    s_nop 0
    v_permlane32_swap_b32 v104, v106
    v_permlane32_swap_b32 v105, v107
    v_max_f32 v104, v104, v106
    v_min_f32_e64 v105, v105, v107
    v_fma_f32 v88, v60, v18, -v104
    v_fma_f32 v60, -v60, v18, v105
    v_fma_f32 v89, v61, v18, -v104
    v_fma_f32 v61, -v61, v18, v105
    v_fma_f32 v90, v62, v18, -v104
    v_fma_f32 v62, -v62, v18, v105
    v_fma_f32 v91, v63, v18, -v104
    v_fma_f32 v63, -v63, v18, v105
    v_fma_f32 v92, v64, v18, -v104
    v_fma_f32 v64, -v64, v18, v105
    v_fma_f32 v93, v65, v18, -v104
    v_fma_f32 v65, -v65, v18, v105
    v_fma_f32 v94, v66, v18, -v104
    v_fma_f32 v66, -v66, v18, v105
    v_fma_f32 v95, v67, v18, -v104
    v_fma_f32 v67, -v67, v18, v105
    v_fma_f32 v96, v68, v18, -v104
    v_fma_f32 v68, -v68, v18, v105
    v_fma_f32 v97, v69, v18, -v104
    v_fma_f32 v69, -v69, v18, v105
    v_fma_f32 v98, v70, v18, -v104
    v_fma_f32 v70, -v70, v18, v105
    v_fma_f32 v99, v71, v18, -v104
    v_fma_f32 v71, -v71, v18, v105
    v_fma_f32 v100, v72, v18, -v104
    v_fma_f32 v72, -v72, v18, v105
    v_fma_f32 v101, v73, v18, -v104
    v_fma_f32 v73, -v73, v18, v105
    v_exp_f32 v88, v88
    v_exp_f32 v60, v60
    v_exp_f32 v89, v89
    v_exp_f32 v61, v61
    v_exp_f32 v90, v90
    v_exp_f32 v62, v62
    v_exp_f32 v91, v91
    v_exp_f32 v63, v63
    v_exp_f32 v92, v92
    v_exp_f32 v64, v64
    v_exp_f32 v93, v93
    v_exp_f32 v65, v65
    v_exp_f32 v94, v94
    v_exp_f32 v66, v66
    v_exp_f32 v95, v95
    v_exp_f32 v67, v67
    v_exp_f32 v96, v96
    v_exp_f32 v68, v68
    v_exp_f32 v97, v97
    v_exp_f32 v69, v69
    v_exp_f32 v98, v98
    v_exp_f32 v70, v70
    v_exp_f32 v99, v99
    v_exp_f32 v71, v71
    v_exp_f32 v100, v100
    v_exp_f32 v72, v72
    v_exp_f32 v101, v101
    v_exp_f32 v73, v73
    v_mov_b32 v47, 0
    v_mov_b32 v55, 0
    v_cvt_pk_bf16_f32 v40, v88, v89
    v_cvt_pk_bf16_f32 v41, v90, v91
    v_cvt_pk_bf16_f32 v42, v92, v93
    v_cvt_pk_bf16_f32 v43, v94, v95
    v_cvt_pk_bf16_f32 v44, v96, v97
    v_cvt_pk_bf16_f32 v45, v98, v99
    v_cvt_pk_bf16_f32 v46, v100, v101
    v_cvt_pk_bf16_f32 v48, v60, v61
    v_cvt_pk_bf16_f32 v49, v62, v63
    v_cvt_pk_bf16_f32 v50, v64, v65
    v_cvt_pk_bf16_f32 v51, v66, v67
    v_cvt_pk_bf16_f32 v52, v68, v69
    v_cvt_pk_bf16_f32 v53, v70, v71
    v_cvt_pk_bf16_f32 v54, v72, v73
    s_setprio 1
    s_nop 0
    ds_read_b64_tr_b16 v[88:89], v5 offset:57344
    ds_read_b64_tr_b16 v[90:91], v5 offset:57856
    ds_read_b64_tr_b16 v[92:93], v6 offset:57344
    ds_read_b64_tr_b16 v[94:95], v6 offset:57856
    ds_read_b64_tr_b16 v[96:97], v5 offset:61440
    ds_read_b64_tr_b16 v[98:99], v5 offset:61952
    ds_read_b64_tr_b16 v[100:101], v6 offset:61440
    ds_read_b64_tr_b16 v[102:103], v6 offset:61952
    ds_read_b64_tr_b16 v[104:105], v7 offset:0
    ds_read_b64_tr_b16 v[106:107], v7 offset:512
    s_waitcnt lgkmcnt(8)
    v_mfma_f32_32x32x16_bf16 v[112:127], v[88:91], v[200:203], v[112:127]
    ds_read_b64_tr_b16 v[108:109], v8 offset:0
    ds_read_b64_tr_b16 v[110:111], v8 offset:512
    s_waitcnt lgkmcnt(8)
    v_mfma_f32_32x32x16_bf16 v[128:143], v[92:95], v[200:203], v[128:143]
    ds_read_b64_tr_b16 v[88:89], v7 offset:4096
    ds_read_b64_tr_b16 v[90:91], v7 offset:4608
    s_waitcnt lgkmcnt(8)
    v_mfma_f32_32x32x16_bf16 v[112:127], v[96:99], v[204:207], v[112:127]
    ds_read_b64_tr_b16 v[92:93], v8 offset:4096
    ds_read_b64_tr_b16 v[94:95], v8 offset:4608
    s_waitcnt lgkmcnt(8)
    v_mfma_f32_32x32x16_bf16 v[128:143], v[100:103], v[204:207], v[128:143]
    ds_read_b64_tr_b16 v[96:97], v7 offset:8192
    ds_read_b64_tr_b16 v[98:99], v7 offset:8704
    s_waitcnt lgkmcnt(8)
    v_mfma_f32_32x32x16_bf16 v[112:127], v[104:107], v[208:211], v[112:127]
    ds_read_b64_tr_b16 v[100:101], v8 offset:8192
    ds_read_b64_tr_b16 v[102:103], v8 offset:8704
    s_waitcnt lgkmcnt(8)
    v_mfma_f32_32x32x16_bf16 v[128:143], v[108:111], v[208:211], v[128:143]
    ds_read_b64_tr_b16 v[104:105], v7 offset:12288
    ds_read_b64_tr_b16 v[106:107], v7 offset:12800
    s_waitcnt lgkmcnt(8)
    v_mfma_f32_32x32x16_bf16 v[112:127], v[88:91], v[212:215], v[112:127]
    ds_read_b64_tr_b16 v[108:109], v8 offset:12288
    ds_read_b64_tr_b16 v[110:111], v8 offset:12800
    s_waitcnt lgkmcnt(8)
    v_mfma_f32_32x32x16_bf16 v[128:143], v[92:95], v[212:215], v[128:143]
    ds_read_b64_tr_b16 v[88:89], v7 offset:16384
    ds_read_b64_tr_b16 v[90:91], v7 offset:16896
    s_waitcnt lgkmcnt(8)
    v_mfma_f32_32x32x16_bf16 v[112:127], v[96:99], v[216:219], v[112:127]
    ds_read_b64_tr_b16 v[92:93], v8 offset:16384
    ds_read_b64_tr_b16 v[94:95], v8 offset:16896
    s_waitcnt lgkmcnt(8)
    v_mfma_f32_32x32x16_bf16 v[128:143], v[100:103], v[216:219], v[128:143]
    ds_read_b64_tr_b16 v[96:97], v7 offset:20480
    ds_read_b64_tr_b16 v[98:99], v7 offset:20992
    s_waitcnt lgkmcnt(8)
    v_mfma_f32_32x32x16_bf16 v[112:127], v[104:107], v[220:223], v[112:127]
    ds_read_b64_tr_b16 v[100:101], v8 offset:20480
    ds_read_b64_tr_b16 v[102:103], v8 offset:20992
    s_waitcnt lgkmcnt(8)
    v_mfma_f32_32x32x16_bf16 v[128:143], v[108:111], v[220:223], v[128:143]
    ds_read_b64_tr_b16 v[104:105], v5 offset:0
    ds_read_b64_tr_b16 v[106:107], v5 offset:512
    s_waitcnt lgkmcnt(8)
    v_mfma_f32_32x32x16_bf16 v[112:127], v[88:91], v[224:227], v[112:127]
    ds_read_b64_tr_b16 v[108:109], v6 offset:0
    ds_read_b64_tr_b16 v[110:111], v6 offset:512
    s_waitcnt lgkmcnt(8)
    v_mfma_f32_32x32x16_bf16 v[128:143], v[92:95], v[224:227], v[128:143]
    ds_read_b64_tr_b16 v[88:89], v5 offset:4096
    ds_read_b64_tr_b16 v[90:91], v5 offset:4608
    s_waitcnt lgkmcnt(8)
    v_mfma_f32_32x32x16_bf16 v[112:127], v[96:99], v[228:231], v[112:127]
    ds_read_b64_tr_b16 v[92:93], v6 offset:4096
    ds_read_b64_tr_b16 v[94:95], v6 offset:4608
    s_waitcnt lgkmcnt(8)
    v_mfma_f32_32x32x16_bf16 v[128:143], v[100:103], v[228:231], v[128:143]
    ds_read_b64_tr_b16 v[96:97], v5 offset:8192
    ds_read_b64_tr_b16 v[98:99], v5 offset:8704
    s_waitcnt lgkmcnt(8)
    v_mfma_f32_32x32x16_bf16 v[112:127], v[104:107], v[232:235], v[112:127]
    ds_read_b64_tr_b16 v[100:101], v6 offset:8192
    ds_read_b64_tr_b16 v[102:103], v6 offset:8704
    s_waitcnt lgkmcnt(8)
    v_mfma_f32_32x32x16_bf16 v[128:143], v[108:111], v[232:235], v[128:143]
    ds_read_b64_tr_b16 v[104:105], v5 offset:12288
    ds_read_b64_tr_b16 v[106:107], v5 offset:12800
    s_waitcnt lgkmcnt(8)
    v_mfma_f32_32x32x16_bf16 v[112:127], v[88:91], v[236:239], v[112:127]
    ds_read_b64_tr_b16 v[108:109], v6 offset:12288
    ds_read_b64_tr_b16 v[110:111], v6 offset:12800
    s_waitcnt lgkmcnt(8)
    v_mfma_f32_32x32x16_bf16 v[128:143], v[92:95], v[236:239], v[128:143]
    ds_read_b64_tr_b16 v[88:89], v5 offset:16384
    ds_read_b64_tr_b16 v[90:91], v5 offset:16896
    s_waitcnt lgkmcnt(8)
    v_mfma_f32_32x32x16_bf16 v[112:127], v[96:99], v[240:243], v[112:127]
    ds_read_b64_tr_b16 v[92:93], v6 offset:16384
    ds_read_b64_tr_b16 v[94:95], v6 offset:16896
    s_waitcnt lgkmcnt(8)
    v_mfma_f32_32x32x16_bf16 v[128:143], v[100:103], v[240:243], v[128:143]
    ds_read_b64_tr_b16 v[96:97], v5 offset:20480
    ds_read_b64_tr_b16 v[98:99], v5 offset:20992
    s_waitcnt lgkmcnt(8)
    v_mfma_f32_32x32x16_bf16 v[112:127], v[104:107], v[244:247], v[112:127]
    ds_read_b64_tr_b16 v[100:101], v6 offset:20480
    ds_read_b64_tr_b16 v[102:103], v6 offset:20992
    s_waitcnt lgkmcnt(8)
    v_mfma_f32_32x32x16_bf16 v[128:143], v[108:111], v[244:247], v[128:143]
    s_waitcnt lgkmcnt(6)
    v_mfma_f32_32x32x16_bf16 v[112:127], v[88:91], v[248:251], v[112:127]
    s_waitcnt lgkmcnt(4)
    v_mfma_f32_32x32x16_bf16 v[128:143], v[92:95], v[248:251], v[128:143]
    s_mul_i32 s83, s4, 3136
    s_add_u32 s83, s83, 114688
    v_add_u32_e64 v12, s83, v3
    ds_read_b64_tr_b16 v[76:77], v12 offset:0
    ds_read_b64_tr_b16 v[78:79], v12 offset:448
    ds_read_b64_tr_b16 v[80:81], v12 offset:896
    ds_read_b64_tr_b16 v[82:83], v12 offset:1344
    s_waitcnt lgkmcnt(6)
    v_mfma_f32_32x32x16_bf16 v[112:127], v[96:99], v[252:255], v[112:127]
    s_waitcnt lgkmcnt(4)
    v_mfma_f32_32x32x16_bf16 v[128:143], v[100:103], v[252:255], v[128:143]
    s_setprio 0
    s_lshl_b32 s80, s4, 13
    v_add_u32 v11, s80, v14
    s_lshl_b32 s80, s6, 2
    s_add_u32 s80, s80, s5
    s_lshl_b32 s80, s80, 1
    s_add_u32 s80, s80, s42
    s_lshl_b32 s77, s80, 4
    s_add_u32 s77, s77, s4
    s_lshl_b32 s77, s77, 3
    s_add_u32 s77, s77, 17039360
    s_lshl_b32 s80, s80, 2
    s_add_u32 s80, s80, s4
    s_lshl_b32 s80, s80, 12
    s_nop 0
    s_add_u32 s48, s80, 8388608
    s_add_u32 s49, s48, 8192
    v_cvt_pk_bf16_f32 v160, v112, v113
    v_cvt_pk_bf16_f32 v161, v114, v115
    v_cvt_pk_bf16_f32 v162, v116, v117
    v_cvt_pk_bf16_f32 v163, v118, v119
    v_cvt_pk_bf16_f32 v164, v120, v121
    v_cvt_pk_bf16_f32 v165, v122, v123
    v_cvt_pk_bf16_f32 v166, v124, v125
    v_cvt_pk_bf16_f32 v167, v126, v127
    s_waitcnt lgkmcnt(0)
    v_cndmask_b32 v82, v82, 0, s[68:69]
    v_cndmask_b32 v83, v83, 0, s[68:69]
    s_setprio 3
    v_mfma_f32_32x32x16_bf16 v[112:127], v[76:79], v[160:163], 0
    v_mfma_f32_32x32x16_bf16 v[112:127], v[80:83], v[164:167], v[112:127]
    s_setprio 0
    s_nop 0
    ds_read_b64_tr_b16 v[88:89], v12 offset:1568
    ds_read_b64_tr_b16 v[90:91], v12 offset:2016
    ds_read_b64_tr_b16 v[92:93], v12 offset:2464
    ds_read_b64_tr_b16 v[94:95], v12 offset:2912
    v_cvt_pk_bf16_f32 v168, v128, v129
    v_cvt_pk_bf16_f32 v169, v130, v131
    v_cvt_pk_bf16_f32 v170, v132, v133
    v_cvt_pk_bf16_f32 v171, v134, v135
    v_cvt_pk_bf16_f32 v172, v136, v137
    v_cvt_pk_bf16_f32 v173, v138, v139
    v_cvt_pk_bf16_f32 v174, v140, v141
    v_cvt_pk_bf16_f32 v175, v142, v143
    s_waitcnt lgkmcnt(0)
    v_cndmask_b32 v94, v94, 0, s[68:69]
    v_cndmask_b32 v95, v95, 0, s[68:69]
    s_setprio 3
    v_mfma_f32_32x32x16_bf16 v[60:75], v[88:91], v[168:171], 0
    v_mfma_f32_32x32x16_bf16 v[60:75], v[92:95], v[172:175], v[60:75]
    s_setprio 0
    s_nop 0
    v_max3_f32 v104, v112, v113, v114
    v_min3_f32 v105, v112, v113, v114
    v_cndmask_b32 v124, v124, v126, s[68:69]
    v_cndmask_b32 v125, v125, v127, s[68:69]
    v_max3_f32 v104, v104, v115, v116
    v_min3_f32 v105, v105, v115, v116
    v_max3_f32 v104, v104, v117, v118
    v_min3_f32 v105, v105, v117, v118
    v_max3_f32 v104, v104, v119, v120
    v_min3_f32 v105, v105, v119, v120
    v_max3_f32 v104, v104, v121, v122
    v_min3_f32 v105, v105, v121, v122
    v_max3_f32 v104, v104, v123, v124
    v_min3_f32 v105, v105, v123, v124
    v_max_f32 v104, v104, v125
    v_min_f32 v105, v105, v125
    v_mul_f32 v106, v104, v18
    v_mul_f32 v107, v105, v18
    v_mul_f32 v104, v104, v18
    v_mul_f32 v105, v105, v18
    s_nop 0
    v_permlane32_swap_b32 v104, v106
    v_permlane32_swap_b32 v105, v107
    v_max_f32 v104, v104, v106
    v_min_f32_e64 v105, v105, v107
    v_fma_f32 v88, v112, v18, -v104
    v_fma_f32 v112, -v112, v18, v105
    v_fma_f32 v89, v113, v18, -v104
    v_fma_f32 v113, -v113, v18, v105
    v_fma_f32 v90, v114, v18, -v104
    v_fma_f32 v114, -v114, v18, v105
    v_fma_f32 v91, v115, v18, -v104
    v_fma_f32 v115, -v115, v18, v105
    v_fma_f32 v92, v116, v18, -v104
    v_fma_f32 v116, -v116, v18, v105
    v_fma_f32 v93, v117, v18, -v104
    v_fma_f32 v117, -v117, v18, v105
    v_fma_f32 v94, v118, v18, -v104
    v_fma_f32 v118, -v118, v18, v105
    v_fma_f32 v95, v119, v18, -v104
    v_fma_f32 v119, -v119, v18, v105
    v_fma_f32 v96, v120, v18, -v104
    v_fma_f32 v120, -v120, v18, v105
    v_fma_f32 v97, v121, v18, -v104
    v_fma_f32 v121, -v121, v18, v105
    v_fma_f32 v98, v122, v18, -v104
    v_fma_f32 v122, -v122, v18, v105
    v_fma_f32 v99, v123, v18, -v104
    v_fma_f32 v123, -v123, v18, v105
    v_fma_f32 v100, v124, v18, -v104
    v_fma_f32 v124, -v124, v18, v105
    v_fma_f32 v101, v125, v18, -v104
    v_fma_f32 v125, -v125, v18, v105
    v_exp_f32 v88, v88
    v_exp_f32 v112, v112
    v_exp_f32 v89, v89
    v_exp_f32 v113, v113
    v_exp_f32 v90, v90
    v_exp_f32 v114, v114
    v_exp_f32 v91, v91
    v_exp_f32 v115, v115
    v_exp_f32 v92, v92
    v_exp_f32 v116, v116
    v_exp_f32 v93, v93
    v_exp_f32 v117, v117
    v_exp_f32 v94, v94
    v_exp_f32 v118, v118
    v_exp_f32 v95, v95
    v_exp_f32 v119, v119
    v_exp_f32 v96, v96
    v_exp_f32 v120, v120
    v_exp_f32 v97, v97
    v_exp_f32 v121, v121
    v_exp_f32 v98, v98
    v_exp_f32 v122, v122
    v_exp_f32 v99, v99
    v_exp_f32 v123, v123
    v_exp_f32 v100, v100
    v_exp_f32 v124, v124
    v_exp_f32 v101, v101
    v_exp_f32 v125, v125
    v_mov_b32 v151, 0
    v_mov_b32 v159, 0
    v_cvt_pk_bf16_f32 v144, v88, v89
    v_cvt_pk_bf16_f32 v145, v90, v91
    v_cvt_pk_bf16_f32 v146, v92, v93
    v_cvt_pk_bf16_f32 v147, v94, v95
    v_cvt_pk_bf16_f32 v148, v96, v97
    v_cvt_pk_bf16_f32 v149, v98, v99
    v_cvt_pk_bf16_f32 v150, v100, v101
    v_cvt_pk_bf16_f32 v152, v112, v113
    v_cvt_pk_bf16_f32 v153, v114, v115
    v_cvt_pk_bf16_f32 v154, v116, v117
    v_cvt_pk_bf16_f32 v155, v118, v119
    v_cvt_pk_bf16_f32 v156, v120, v121
    v_cvt_pk_bf16_f32 v157, v122, v123
    v_cvt_pk_bf16_f32 v158, v124, v125
    s_barrier
    s_nop 0
    ds_read_b128 v[112:115], v11 offset:24576
    ds_read_b128 v[116:119], v11 offset:25600
    ds_read_b128 v[120:123], v11 offset:26624
    ds_read_b128 v[124:127], v11 offset:27648
    ds_read_b128 v[128:131], v11 offset:28672
    ds_read_b128 v[132:135], v11 offset:29696
    ds_read_b128 v[136:139], v11 offset:30720
    ds_read_b128 v[140:143], v11 offset:31744
    s_waitcnt lgkmcnt(4)
    v_mfma_f32_32x32x16_bf16 v[176:191], v[112:115], v[24:27], 0
    v_mfma_f32_32x32x16_bf16 v[192:207], v[120:123], v[32:35], 0
    v_mfma_f32_32x32x16_bf16 v[176:191], v[116:119], v[28:31], v[176:191]
    v_mfma_f32_32x32x16_bf16 v[192:207], v[124:127], v[36:39], v[192:207]
    s_waitcnt lgkmcnt(0)
    v_mfma_f32_32x32x16_bf16 v[208:223], v[128:131], v[40:43], 0
    v_mfma_f32_32x32x16_bf16 v[224:239], v[136:139], v[48:51], 0
    v_mfma_f32_32x32x16_bf16 v[208:223], v[132:135], v[44:47], v[208:223]
    v_mfma_f32_32x32x16_bf16 v[224:239], v[140:143], v[52:55], v[224:239]
    ds_read_b128 v[112:115], v11 offset:40960
    ds_read_b128 v[116:119], v11 offset:41984
    ds_read_b128 v[120:123], v11 offset:43008
    ds_read_b128 v[124:127], v11 offset:44032
    ds_read_b128 v[128:131], v11 offset:45056
    ds_read_b128 v[132:135], v11 offset:46080
    ds_read_b128 v[136:139], v11 offset:47104
    ds_read_b128 v[140:143], v11 offset:48128
    v_rcp_f32 v108, v191
    v_rcp_f32 v109, v207
    v_mov_b32_e64 v247, 0
    v_fmaak_f32 v110, v108, v190, 0x358637bd
    v_fmac_f32 v110, v109, v206
    v_rcp_f32 v110, v110
    s_nop 0
    v_mul_f32 v108, v108, v110
    v_mul_f32 v109, v109, v110
    v_mul_f32 v176, v176, v108
    v_mul_f32 v177, v177, v108
    v_mul_f32 v178, v178, v108
    v_mul_f32 v179, v179, v108
    v_mul_f32 v180, v180, v108
    v_mul_f32 v181, v181, v108
    v_mul_f32 v182, v182, v108
    v_mul_f32 v183, v183, v108
    v_mul_f32 v184, v184, v108
    v_mul_f32 v185, v185, v108
    v_mul_f32 v186, v186, v108
    v_mul_f32 v187, v187, v108
    v_mul_f32 v188, v188, v108
    v_mul_f32 v189, v189, v108
    v_fmac_f32 v176, v192, v109
    v_fmac_f32 v177, v193, v109
    v_fmac_f32 v178, v194, v109
    v_fmac_f32 v179, v195, v109
    v_fmac_f32 v180, v196, v109
    v_fmac_f32 v181, v197, v109
    v_fmac_f32 v182, v198, v109
    v_fmac_f32 v183, v199, v109
    v_fmac_f32 v184, v200, v109
    v_fmac_f32 v185, v201, v109
    v_fmac_f32 v186, v202, v109
    v_fmac_f32 v187, v203, v109
    v_fmac_f32 v188, v204, v109
    v_fmac_f32_e64 v189, v205, v109
    v_cvt_pk_bf16_f32 v240, v176, v177
    v_cvt_pk_bf16_f32 v241, v178, v179
    v_cvt_pk_bf16_f32 v242, v180, v181
    v_cvt_pk_bf16_f32 v243, v182, v183
    v_cvt_pk_bf16_f32 v244, v184, v185
    v_cvt_pk_bf16_f32 v245, v186, v187
    v_cvt_pk_bf16_f32 v246, v188, v189
    buffer_store_dwordx4 v[240:243], v14, s[36:39], s48 offen offset:0 sc1
    buffer_store_dwordx4 v[244:247], v14, s[36:39], s48 offen offset:1024 sc1
    s_waitcnt lgkmcnt(4)
    v_mfma_f32_32x32x16_bf16 v[176:191], v[112:115], v[144:147], 0
    v_mfma_f32_32x32x16_bf16 v[192:207], v[120:123], v[152:155], 0
    v_mfma_f32_32x32x16_bf16 v[176:191], v[116:119], v[148:151], v[176:191]
    v_mfma_f32_32x32x16_bf16 v[192:207], v[124:127], v[156:159], v[192:207]
    v_rcp_f32 v108, v223
    v_rcp_f32 v109, v239
    v_mov_b32 v255, 0
    v_fmaak_f32 v110, v108, v222, 0x358637bd
    v_fmac_f32 v110, v109, v238
    v_rcp_f32 v110, v110
    s_nop 0
    v_mul_f32 v108, v108, v110
    v_mul_f32 v109, v109, v110
    v_mul_f32 v208, v208, v108
    v_mul_f32 v209, v209, v108
    v_mul_f32 v210, v210, v108
    v_mul_f32 v211, v211, v108
    v_mul_f32 v212, v212, v108
    v_mul_f32 v213, v213, v108
    v_mul_f32 v214, v214, v108
    v_mul_f32 v215, v215, v108
    v_mul_f32 v216, v216, v108
    v_mul_f32 v217, v217, v108
    v_mul_f32 v218, v218, v108
    v_mul_f32 v219, v219, v108
    v_mul_f32 v220, v220, v108
    v_mul_f32 v221, v221, v108
    v_fmac_f32 v208, v224, v109
    v_fmac_f32 v209, v225, v109
    v_fmac_f32 v210, v226, v109
    v_fmac_f32 v211, v227, v109
    v_fmac_f32 v212, v228, v109
    v_fmac_f32 v213, v229, v109
    v_fmac_f32 v214, v230, v109
    v_fmac_f32 v215, v231, v109
    v_fmac_f32 v216, v232, v109
    v_fmac_f32 v217, v233, v109
    v_fmac_f32 v218, v234, v109
    v_fmac_f32 v219, v235, v109
    v_fmac_f32 v220, v236, v109
    v_fmac_f32_e64 v221, v237, v109
    v_cvt_pk_bf16_f32 v248, v208, v209
    v_cvt_pk_bf16_f32 v249, v210, v211
    v_cvt_pk_bf16_f32 v250, v212, v213
    v_cvt_pk_bf16_f32 v251, v214, v215
    v_cvt_pk_bf16_f32 v252, v216, v217
    v_cvt_pk_bf16_f32 v253, v218, v219
    v_cvt_pk_bf16_f32 v254, v220, v221
    buffer_store_dwordx4 v[248:251], v14, s[36:39], s48 offen offset:2048 sc1
    buffer_store_dwordx4 v[252:255], v14, s[36:39], s48 offen offset:3072 sc1
    s_waitcnt lgkmcnt(0)
    s_nop 0
    v_max3_f32 v104, v60, v61, v62
    v_min3_f32 v105, v60, v61, v62
    v_cndmask_b32 v72, v72, v74, s[68:69]
    v_cndmask_b32 v73, v73, v75, s[68:69]
    v_max3_f32 v104, v104, v63, v64
    v_min3_f32 v105, v105, v63, v64
    v_max3_f32 v104, v104, v65, v66
    v_min3_f32 v105, v105, v65, v66
    v_max3_f32 v104, v104, v67, v68
    v_min3_f32 v105, v105, v67, v68
    v_max3_f32 v104, v104, v69, v70
    v_min3_f32 v105, v105, v69, v70
    v_max3_f32 v104, v104, v71, v72
    v_min3_f32 v105, v105, v71, v72
    v_max_f32 v104, v104, v73
    v_min_f32 v105, v105, v73
    v_mul_f32 v106, v104, v18
    v_mul_f32 v107, v105, v18
    v_mul_f32 v104, v104, v18
    v_mul_f32 v105, v105, v18
    s_nop 0
    v_permlane32_swap_b32 v104, v106
    v_permlane32_swap_b32 v105, v107
    v_max_f32 v104, v104, v106
    v_min_f32_e64 v105, v105, v107
    v_fma_f32 v88, v60, v18, -v104
    v_fma_f32 v60, -v60, v18, v105
    v_fma_f32 v89, v61, v18, -v104
    v_fma_f32 v61, -v61, v18, v105
    v_fma_f32 v90, v62, v18, -v104
    v_fma_f32 v62, -v62, v18, v105
    v_fma_f32 v91, v63, v18, -v104
    v_fma_f32 v63, -v63, v18, v105
    v_fma_f32 v92, v64, v18, -v104
    v_fma_f32 v64, -v64, v18, v105
    v_fma_f32 v93, v65, v18, -v104
    v_fma_f32 v65, -v65, v18, v105
    v_fma_f32 v94, v66, v18, -v104
    v_fma_f32 v66, -v66, v18, v105
    v_fma_f32 v95, v67, v18, -v104
    v_fma_f32 v67, -v67, v18, v105
    v_fma_f32 v96, v68, v18, -v104
    v_fma_f32 v68, -v68, v18, v105
    v_fma_f32 v97, v69, v18, -v104
    v_fma_f32 v69, -v69, v18, v105
    v_fma_f32 v98, v70, v18, -v104
    v_fma_f32 v70, -v70, v18, v105
    v_fma_f32 v99, v71, v18, -v104
    v_fma_f32 v71, -v71, v18, v105
    v_fma_f32 v100, v72, v18, -v104
    v_fma_f32 v72, -v72, v18, v105
    v_fma_f32 v101, v73, v18, -v104
    v_fma_f32 v73, -v73, v18, v105
    v_exp_f32 v88, v88
    v_exp_f32 v60, v60
    v_exp_f32 v89, v89
    v_exp_f32 v61, v61
    v_exp_f32 v90, v90
    v_exp_f32 v62, v62
    v_exp_f32 v91, v91
    v_exp_f32 v63, v63
    v_exp_f32 v92, v92
    v_exp_f32 v64, v64
    v_exp_f32 v93, v93
    v_exp_f32 v65, v65
    v_exp_f32 v94, v94
    v_exp_f32 v66, v66
    v_exp_f32 v95, v95
    v_exp_f32 v67, v67
    v_exp_f32 v96, v96
    v_exp_f32 v68, v68
    v_exp_f32 v97, v97
    v_exp_f32 v69, v69
    v_exp_f32 v98, v98
    v_exp_f32 v70, v70
    v_exp_f32 v99, v99
    v_exp_f32 v71, v71
    v_exp_f32 v100, v100
    v_exp_f32 v72, v72
    v_exp_f32 v101, v101
    v_exp_f32 v73, v73
    v_mov_b32 v167, 0
    v_mov_b32 v175, 0
    v_cvt_pk_bf16_f32 v160, v88, v89
    v_cvt_pk_bf16_f32 v161, v90, v91
    v_cvt_pk_bf16_f32 v162, v92, v93
    v_cvt_pk_bf16_f32 v163, v94, v95
    v_cvt_pk_bf16_f32 v164, v96, v97
    v_cvt_pk_bf16_f32 v165, v98, v99
    v_cvt_pk_bf16_f32 v166, v100, v101
    v_cvt_pk_bf16_f32 v168, v60, v61
    v_cvt_pk_bf16_f32 v169, v62, v63
    v_cvt_pk_bf16_f32 v170, v64, v65
    v_cvt_pk_bf16_f32 v171, v66, v67
    v_cvt_pk_bf16_f32 v172, v68, v69
    v_cvt_pk_bf16_f32 v173, v70, v71
    v_cvt_pk_bf16_f32 v174, v72, v73
    s_waitcnt vmcnt(0)
    v_mov_b32 v22, s44
    v_mov_b32 v23, s45
    s_mov_b64 exec, 1
    buffer_store_dwordx2 v[22:23], off, s[36:39], s77 sc1
    s_mov_b64 exec, -1
    v_mfma_f32_32x32x16_bf16 v[208:223], v[128:131], v[160:163], 0
    v_mfma_f32_32x32x16_bf16 v[224:239], v[136:139], v[168:171], 0
    v_mfma_f32_32x32x16_bf16 v[208:223], v[132:135], v[164:167], v[208:223]
    v_mfma_f32_32x32x16_bf16 v[224:239], v[140:143], v[172:175], v[224:239]
    v_rcp_f32 v108, v191
    v_rcp_f32 v109, v207
    v_mov_b32 v247, 0
    v_fmaak_f32 v110, v108, v190, 0x358637bd
    v_fmac_f32 v110, v109, v206
    v_rcp_f32 v110, v110
    s_nop 0
    v_mul_f32 v108, v108, v110
    v_mul_f32 v109, v109, v110
    v_mul_f32 v176, v176, v108
    v_mul_f32 v177, v177, v108
    v_mul_f32 v178, v178, v108
    v_mul_f32 v179, v179, v108
    v_mul_f32 v180, v180, v108
    v_mul_f32 v181, v181, v108
    v_mul_f32 v182, v182, v108
    v_mul_f32 v183, v183, v108
    v_mul_f32 v184, v184, v108
    v_mul_f32 v185, v185, v108
    v_mul_f32 v186, v186, v108
    v_mul_f32 v187, v187, v108
    v_mul_f32 v188, v188, v108
    v_mul_f32 v189, v189, v108
    v_fmac_f32 v176, v192, v109
    v_fmac_f32 v177, v193, v109
    v_fmac_f32 v178, v194, v109
    v_fmac_f32 v179, v195, v109
    v_fmac_f32 v180, v196, v109
    v_fmac_f32 v181, v197, v109
    v_fmac_f32 v182, v198, v109
    v_fmac_f32 v183, v199, v109
    v_fmac_f32 v184, v200, v109
    v_fmac_f32 v185, v201, v109
    v_fmac_f32 v186, v202, v109
    v_fmac_f32 v187, v203, v109
    v_fmac_f32 v188, v204, v109
    v_fmac_f32_e64 v189, v205, v109
    v_cvt_pk_bf16_f32 v240, v176, v177
    v_cvt_pk_bf16_f32 v241, v178, v179
    v_cvt_pk_bf16_f32 v242, v180, v181
    v_cvt_pk_bf16_f32 v243, v182, v183
    v_cvt_pk_bf16_f32 v244, v184, v185
    v_cvt_pk_bf16_f32 v245, v186, v187
    v_cvt_pk_bf16_f32 v246, v188, v189
    buffer_store_dwordx4 v[240:243], v14, s[36:39], s49 offen offset:0 sc1
    buffer_store_dwordx4 v[244:247], v14, s[36:39], s49 offen offset:1024 sc1
    v_rcp_f32 v108, v223
    v_rcp_f32 v109, v239
    v_mov_b32_e64 v255, 0
    v_fmaak_f32 v110, v108, v222, 0x358637bd
    v_fmac_f32 v110, v109, v238
    v_rcp_f32 v110, v110
    s_nop 0
    v_mul_f32 v108, v108, v110
    v_mul_f32 v109, v109, v110
    v_mul_f32 v208, v208, v108
    v_mul_f32 v209, v209, v108
    v_mul_f32 v210, v210, v108
    v_mul_f32 v211, v211, v108
    v_mul_f32 v212, v212, v108
    v_mul_f32 v213, v213, v108
    v_mul_f32 v214, v214, v108
    v_mul_f32 v215, v215, v108
    v_mul_f32 v216, v216, v108
    v_mul_f32 v217, v217, v108
    v_mul_f32 v218, v218, v108
    v_mul_f32 v219, v219, v108
    v_mul_f32 v220, v220, v108
    v_mul_f32 v221, v221, v108
    v_fmac_f32 v208, v224, v109
    v_fmac_f32 v209, v225, v109
    v_fmac_f32 v210, v226, v109
    v_fmac_f32 v211, v227, v109
    v_fmac_f32 v212, v228, v109
    v_fmac_f32 v213, v229, v109
    v_fmac_f32 v214, v230, v109
    v_fmac_f32 v215, v231, v109
    v_fmac_f32 v216, v232, v109
    v_fmac_f32 v217, v233, v109
    v_fmac_f32 v218, v234, v109
    v_fmac_f32 v219, v235, v109
    v_fmac_f32 v220, v236, v109
    v_fmac_f32_e64 v221, v237, v109
    v_cvt_pk_bf16_f32 v248, v208, v209
    v_cvt_pk_bf16_f32 v249, v210, v211
    v_cvt_pk_bf16_f32 v250, v212, v213
    v_cvt_pk_bf16_f32 v251, v214, v215
    v_cvt_pk_bf16_f32 v252, v216, v217
    v_cvt_pk_bf16_f32 v253, v218, v219
    v_cvt_pk_bf16_f32 v254, v220, v221
    buffer_store_dwordx4 v[248:251], v14, s[36:39], s49 offen offset:2048 sc1
    buffer_store_dwordx4 v[252:255], v14, s[36:39], s49 offen offset:3072 sc1
    s_waitcnt vmcnt(0)
    s_add_u32 s77, s77, 16
    v_mov_b32 v22, s44
    v_mov_b32_e64 v23, s45
    s_mov_b64 exec, 1
    buffer_store_dwordx2 v[22:23], off, s[36:39], s77 sc1
    s_mov_b64 exec, -1
    s_endpgm
L_rare76:
    s_nop 1
    s_waitcnt vmcnt(8)
    v_mov_b32 v22, s44
    v_mov_b32_e64 v23, s45
    s_mov_b64 exec, 1
    buffer_store_dwordx2 v[22:23], off, s[36:39], s47 sc1
    s_mov_b64 exec, -1
    s_nop 1
    s_branch L_back77
L_QB:
    s_nop 0
    ds_read_b64 v[72:73], v74
    ds_read_b128 v[144:147], v60 offset:0
    ds_read_b128 v[148:151], v61 offset:0
    ds_read_b128 v[152:155], v62 offset:0
    ds_read_b128 v[156:159], v63 offset:0
    ds_read_b128 v[160:163], v60 offset:16384
    ds_read_b128 v[164:167], v61 offset:16384
    ds_read_b128 v[168:171], v62 offset:16384
    ds_read_b128 v[172:175], v63 offset:16384
    ds_read_b128 v[176:179], v60 offset:32768
    ds_read_b128 v[180:183], v61 offset:32768
    ds_read_b128 v[184:187], v62 offset:32768
    ds_read_b128 v[188:191], v63 offset:32768
    ds_read_b128 v[192:195], v60 offset:49152
    ds_read_b128 v[196:199], v61 offset:49152
    s_waitcnt lgkmcnt(14)
    ds_read_b128 v[200:203], v62 offset:49152
    s_waitcnt lgkmcnt(14)
    ds_read_b128 v[204:207], v63 offset:49152
    v_readfirstlane_b32 s44, v72
    v_readfirstlane_b32 s45, v73
    s_waitcnt vmcnt(0)
    s_nop 0
    v_cmp_ne_u64 vcc, s[44:45], v[84:85]
    v_cmp_ne_u64 s[84:85], s[44:45], v[86:87]
    s_nop 0
    s_or_b64 vcc, vcc, s[84:85]
    s_cbranch_vccnz L_rare80
L_back81:
    s_waitcnt lgkmcnt(0)
    s_barrier
    ds_read_b128 v[208:211], v64 offset:0
    s_add_u32 m0, s100, 0
    s_add_u32 s80, s73, 0
    buffer_load_dwordx4 v14, s[36:39], s80 offen sc1 lds
    ds_read_b128 v[212:215], v65 offset:0
    s_add_u32 m0, s100, 4096
    s_add_u32 s80, s73, 4096
    buffer_load_dwordx4 v14, s[36:39], s80 offen sc1 lds
    ds_read_b128 v[216:219], v66 offset:0
    s_add_u32 m0, s100, 8192
    s_add_u32 s80, s73, 8192
    buffer_load_dwordx4 v14, s[36:39], s80 offen sc1 lds
    ds_read_b128 v[220:223], v67 offset:0
    s_add_u32 m0, s100, 12288
    s_add_u32 s80, s73, 12288
    buffer_load_dwordx4 v14, s[36:39], s80 offen sc1 lds
    ds_read_b128 v[224:227], v64 offset:16384
    s_add_u32 m0, s100, 16384
    s_add_u32 s80, s73, 16384
    buffer_load_dwordx4 v14, s[36:39], s80 offen sc1 lds
    ds_read_b128 v[228:231], v65 offset:16384
    s_add_u32 m0, s100, 20480
    s_add_u32 s80, s73, 20480
    buffer_load_dwordx4 v14, s[36:39], s80 offen sc1 lds
    ds_read_b128 v[232:235], v66 offset:16384
    s_add_u32 m0, s100, 24576
    s_add_u32 s80, s73, 24576
    buffer_load_dwordx4 v14, s[36:39], s80 offen sc1 lds
    ds_read_b128 v[236:239], v67 offset:16384
    s_add_u32 m0, s100, 28672
    s_add_u32 s80, s73, 28672
    buffer_load_dwordx4 v14, s[36:39], s80 offen sc1 lds
    ds_read_b128 v[240:243], v64 offset:32768
    s_add_u32 m0, s100, 32768
    s_add_u32 s80, s73, 32768
    buffer_load_dwordx4 v14, s[36:39], s80 offen sc1 lds
    ds_read_b128 v[244:247], v65 offset:32768
    s_add_u32 m0, s100, 36864
    s_add_u32 s80, s73, 36864
    buffer_load_dwordx4 v14, s[36:39], s80 offen sc1 lds
    ds_read_b128 v[248:251], v66 offset:32768
    ds_read_b128 v[252:255], v67 offset:32768
    ds_read_b32 v69, v68
    s_waitcnt lgkmcnt(0)
    s_barrier
    s_setprio 1
    s_nop 0
    ds_read_b64_tr_b16 v[88:89], v7 offset:49152
    ds_read_b64_tr_b16 v[90:91], v7 offset:49664
    ds_read_b64_tr_b16 v[92:93], v8 offset:49152
    ds_read_b64_tr_b16 v[94:95], v8 offset:49664
    ds_read_b64_tr_b16 v[96:97], v7 offset:53248
    ds_read_b64_tr_b16 v[98:99], v7 offset:53760
    ds_read_b64_tr_b16 v[100:101], v8 offset:53248
    ds_read_b64_tr_b16 v[102:103], v8 offset:53760
    ds_read_b64_tr_b16 v[104:105], v7 offset:57344
    ds_read_b64_tr_b16 v[106:107], v7 offset:57856
    s_waitcnt lgkmcnt(8)
    v_mfma_f32_32x32x16_bf16 v[112:127], v[88:91], v[144:147], 0
    ds_read_b64_tr_b16 v[108:109], v8 offset:57344
    ds_read_b64_tr_b16 v[110:111], v8 offset:57856
    s_waitcnt lgkmcnt(8)
    v_mfma_f32_32x32x16_bf16 v[128:143], v[92:95], v[144:147], 0
    v_rcp_f32 v19, v69
    v_mul_f32 v17, v69, v69
    ds_read_b64_tr_b16 v[88:89], v7 offset:61440
    ds_read_b64_tr_b16 v[90:91], v7 offset:61952
    s_waitcnt lgkmcnt(8)
    v_mfma_f32_32x32x16_bf16 v[112:127], v[96:99], v[148:151], v[112:127]
    ds_read_b64_tr_b16 v[92:93], v8 offset:61440
    ds_read_b64_tr_b16 v[94:95], v8 offset:61952
    s_waitcnt lgkmcnt(8)
    v_mfma_f32_32x32x16_bf16 v[128:143], v[100:103], v[148:151], v[128:143]
    v_mul_f32 v18, 0x3fb8aa3b, v19
    ds_read_b64_tr_b16 v[96:97], v9 offset:0
    ds_read_b64_tr_b16 v[98:99], v9 offset:512
    s_waitcnt lgkmcnt(8)
    v_mfma_f32_32x32x16_bf16 v[112:127], v[104:107], v[152:155], v[112:127]
    ds_read_b64_tr_b16 v[100:101], v10 offset:0
    ds_read_b64_tr_b16 v[102:103], v10 offset:512
    s_waitcnt lgkmcnt(8)
    v_mfma_f32_32x32x16_bf16 v[128:143], v[108:111], v[152:155], v[128:143]
    ds_read_b64_tr_b16 v[104:105], v9 offset:4096
    ds_read_b64_tr_b16 v[106:107], v9 offset:4608
    s_waitcnt lgkmcnt(8)
    v_mfma_f32_32x32x16_bf16 v[112:127], v[88:91], v[156:159], v[112:127]
    ds_read_b64_tr_b16 v[108:109], v10 offset:4096
    ds_read_b64_tr_b16 v[110:111], v10 offset:4608
    s_waitcnt lgkmcnt(8)
    v_mfma_f32_32x32x16_bf16 v[128:143], v[92:95], v[156:159], v[128:143]
    ds_read_b64_tr_b16 v[88:89], v9 offset:8192
    ds_read_b64_tr_b16 v[90:91], v9 offset:8704
    s_waitcnt lgkmcnt(8)
    v_mfma_f32_32x32x16_bf16 v[112:127], v[96:99], v[160:163], v[112:127]
    ds_read_b64_tr_b16 v[92:93], v10 offset:8192
    ds_read_b64_tr_b16 v[94:95], v10 offset:8704
    s_waitcnt lgkmcnt(8)
    v_mfma_f32_32x32x16_bf16 v[128:143], v[100:103], v[160:163], v[128:143]
    ds_read_b64_tr_b16 v[96:97], v9 offset:12288
    ds_read_b64_tr_b16 v[98:99], v9 offset:12800
    s_waitcnt lgkmcnt(8)
    v_mfma_f32_32x32x16_bf16 v[112:127], v[104:107], v[164:167], v[112:127]
    ds_read_b64_tr_b16 v[100:101], v10 offset:12288
    ds_read_b64_tr_b16 v[102:103], v10 offset:12800
    s_waitcnt lgkmcnt(8)
    v_mfma_f32_32x32x16_bf16 v[128:143], v[108:111], v[164:167], v[128:143]
    ds_read_b64_tr_b16 v[104:105], v9 offset:16384
    ds_read_b64_tr_b16 v[106:107], v9 offset:16896
    s_waitcnt lgkmcnt(8)
    v_mfma_f32_32x32x16_bf16 v[112:127], v[88:91], v[168:171], v[112:127]
    ds_read_b64_tr_b16 v[108:109], v10 offset:16384
    ds_read_b64_tr_b16 v[110:111], v10 offset:16896
    s_waitcnt lgkmcnt(8)
    v_mfma_f32_32x32x16_bf16 v[128:143], v[92:95], v[168:171], v[128:143]
    ds_read_b64_tr_b16 v[88:89], v9 offset:20480
    ds_read_b64_tr_b16 v[90:91], v9 offset:20992
    s_waitcnt lgkmcnt(8)
    v_mfma_f32_32x32x16_bf16 v[112:127], v[96:99], v[172:175], v[112:127]
    ds_read_b64_tr_b16 v[92:93], v10 offset:20480
    ds_read_b64_tr_b16 v[94:95], v10 offset:20992
    s_waitcnt lgkmcnt(8)
    v_mfma_f32_32x32x16_bf16 v[128:143], v[100:103], v[172:175], v[128:143]
    s_waitcnt vmcnt(0) lgkmcnt(0)
    s_barrier
    v_mfma_f32_32x32x16_bf16 v[112:127], v[104:107], v[176:179], v[112:127]
    v_mfma_f32_32x32x16_bf16 v[128:143], v[108:111], v[176:179], v[128:143]
    v_mfma_f32_32x32x16_bf16 v[112:127], v[88:91], v[180:183], v[112:127]
    v_mfma_f32_32x32x16_bf16 v[128:143], v[92:95], v[180:183], v[128:143]
    s_setprio 0
    s_cmp_eq_u32 s4, 0
    s_cbranch_scc1 L_QK
L_QV:
    s_nop 0
    s_add_u32 m0, s100, 90112
    s_add_u32 s80, s101, 774144
    buffer_load_dwordx4 v2, s[24:27], s80 offen  lds
    s_add_u32 m0, s100, 94208
    s_add_u32 s80, s101, 817152
    buffer_load_dwordx4 v2, s[24:27], s80 offen  lds
    s_add_u32 m0, s100, 98304
    s_add_u32 s80, s101, 860160
    buffer_load_dwordx4 v2, s[24:27], s80 offen  lds
    s_add_u32 m0, s100, 102400
    s_add_u32 s80, s101, 903168
    buffer_load_dwordx4 v2, s[24:27], s80 offen  lds
    s_add_u32 m0, s100, 106496
    s_add_u32 s80, s101, 946176
    buffer_load_dwordx4 v2, s[24:27], s80 offen  lds
    s_add_u32 m0, s100, 110592
    s_add_u32 s80, s101, 989184
    buffer_load_dwordx4 v2, s[24:27], s80 offen  lds
    s_add_u32 m0, s100, 114688
    s_add_u32 s80, s101, 1032192
    buffer_load_dwordx4 v2, s[24:27], s80 offen  lds
    s_add_u32 m0, s100, 118784
    s_add_u32 s80, s101, 1075200
    buffer_load_dwordx4 v2, s[24:27], s80 offen  lds
    v_lshrrev_b32 v21, 5, v0
    v_lshlrev_b32_e64 v21, 3, v21
    s_lshl_b32 s80, s5, 6
    s_add_u32 s80, s80, 156160
    v_add_u32 v21, s80, v21
    s_lshl_b32 s80, s5, 11
    s_add_u32 s80, s80, 16384
    v_add_u32_e64 v76, s80, v14
    ds_read_b64 v[68:69], v21 offset:0
    ds_read_b64 v[70:71], v21 offset:16
    ds_read_b64 v[72:73], v21 offset:32
    ds_read_b64 v[74:75], v21 offset:48
    s_lshr_b32 s80, s6, 1
    s_lshl_b32 s81, s42, 3
    s_add_u32 s80, s80, s81
    s_and_b32 s81, s6, 1
    s_lshl_b32 s82, s81, 3
    s_lshl_b32 s50, s80, 11
    s_add_u32 s50, s50, s82
    s_add_u32 s50, s50, 16941056
    s_and_b32 s83, s3, 3
    s_add_u32 s82, s82, s83
    s_lshl_b32 s82, s82, 8
    s_lshl_b32 s51, s80, 16
    s_add_u32 s51, s51, s82
    s_add_u32 s51, s51, 14680064
    s_lshl_b32 s52, s80, 12
    s_add_u32 s52, s52, s82
    s_add_u32 s52, s52, 16777216
    s_lshl_b32 s80, s80, 1
    s_add_u32 s80, s80, s81
    s_lshl_b32 s80, s80, 4
    s_add_u32 s80, s80, s83
    s_lshl_b32 s80, s80, 3
    s_add_u32 s53, s80, 17055744
    s_bitcmp1_b32 s3, 0
    s_cselect_b32 s54, 0x8800, 0
    s_cselect_b32 s80, 10, 16
    s_mov_b32 s55, 0
    v_and_b32 v22, 15, v0
    v_lshlrev_b32 v4, 7, v22
    v_and_b32 v21, 2, v0
    v_cmp_eq_u32 vcc, 0, v21
    v_and_b32 v21, 1, v0
    v_lshlrev_b32 v21, 4, v21
    v_mov_b32 v11, 0x3f80
    v_lshlrev_b32 v21, v21, v11
    v_cndmask_b32 v15, 0, v21, vcc
    v_cndmask_b32 v11, v21, 0, vcc
    v_add_u32 v21, -2, v22
    v_cndmask_b32 v21, 12, v21, vcc
    v_cmp_le_u32 vcc, s80, v22
    s_nop 1
    v_cndmask_b32 v22, v22, v21, vcc
    v_lshrrev_b32 v21, 4, v0
    v_lshlrev_b32_e64 v22, 4, v22
    v_lshl_add_u32 v1, v21, 12, v22
    s_setprio 1
    s_nop 0
    ds_read_b64_tr_b16 v[88:89], v12 offset:0
    ds_read_b64_tr_b16 v[90:91], v12 offset:256
    ds_read_b64_tr_b16 v[92:93], v12 offset:1024
    ds_read_b64_tr_b16 v[94:95], v12 offset:1280
    ds_read_b64_tr_b16 v[96:97], v12 offset:2048
    ds_read_b64_tr_b16 v[98:99], v12 offset:2304
    ds_read_b64_tr_b16 v[100:101], v12 offset:3072
    ds_read_b64_tr_b16 v[102:103], v12 offset:3328
    ds_read_b64_tr_b16 v[104:105], v12 offset:8192
    ds_read_b64_tr_b16 v[106:107], v12 offset:8448
    ds_read_b64_tr_b16 v[108:109], v12 offset:9216
    s_waitcnt lgkmcnt(14)
    ds_read_b64_tr_b16 v[110:111], v12 offset:9472
    s_waitcnt lgkmcnt(10)
    v_mfma_f32_32x32x16_bf16 v[24:39], v[144:147], v[88:91], 0
    ds_read_b64_tr_b16 v[88:89], v12 offset:10240
    ds_read_b64_tr_b16 v[90:91], v12 offset:10496
    s_waitcnt lgkmcnt(10)
    v_mfma_f32_32x32x16_bf16 v[24:39], v[148:151], v[92:95], v[24:39]
    ds_read_b64_tr_b16 v[92:93], v12 offset:11264
    ds_read_b64_tr_b16 v[94:95], v12 offset:11520
    s_waitcnt lgkmcnt(10)
    v_mfma_f32_32x32x16_bf16 v[24:39], v[152:155], v[96:99], v[24:39]
    ds_read_b64_tr_b16 v[96:97], v12 offset:16384
    ds_read_b64_tr_b16 v[98:99], v12 offset:16640
    s_waitcnt lgkmcnt(10)
    v_mfma_f32_32x32x16_bf16 v[24:39], v[156:159], v[100:103], v[24:39]
    ds_read_b64_tr_b16 v[100:101], v12 offset:17408
    ds_read_b64_tr_b16 v[102:103], v12 offset:17664
    s_waitcnt lgkmcnt(10)
    v_mfma_f32_32x32x16_bf16 v[24:39], v[160:163], v[104:107], v[24:39]
    s_add_u32 m0, s100, 131072
    s_add_u32 s80, s72, 0
    buffer_load_dwordx4 v2, s[24:27], s80 offen  lds
    ds_read_b64_tr_b16 v[104:105], v12 offset:18432
    ds_read_b64_tr_b16 v[106:107], v12 offset:18688
    s_waitcnt lgkmcnt(10)
    v_mfma_f32_32x32x16_bf16 v[24:39], v[164:167], v[108:111], v[24:39]
    ds_read_b64_tr_b16 v[108:109], v12 offset:19456
    ds_read_b64_tr_b16 v[110:111], v12 offset:19712
    s_waitcnt lgkmcnt(10)
    s_nop 0
    v_mfma_f32_32x32x16_bf16 v[24:39], v[168:171], v[88:91], v[24:39]
    s_add_u32 m0, s100, 135168
    s_add_u32 s80, s72, 43008
    buffer_load_dwordx4 v2, s[24:27], s80 offen  lds
    ds_read_b64_tr_b16 v[88:89], v12 offset:24576
    ds_read_b64_tr_b16 v[90:91], v12 offset:24832
    s_waitcnt lgkmcnt(10)
    v_mfma_f32_32x32x16_bf16 v[24:39], v[172:175], v[92:95], v[24:39]
    ds_read_b64_tr_b16 v[92:93], v12 offset:25600
    ds_read_b64_tr_b16 v[94:95], v12 offset:25856
    s_waitcnt lgkmcnt(10)
    v_mfma_f32_32x32x16_bf16 v[24:39], v[176:179], v[96:99], v[24:39]
    s_add_u32 m0, s100, 139264
    s_add_u32 s80, s72, 86016
    buffer_load_dwordx4 v2, s[24:27], s80 offen  lds
    ds_read_b64_tr_b16 v[96:97], v12 offset:26624
    ds_read_b64_tr_b16 v[98:99], v12 offset:26880
    s_waitcnt lgkmcnt(10)
    v_mfma_f32_32x32x16_bf16 v[24:39], v[180:183], v[100:103], v[24:39]
    ds_read_b64_tr_b16 v[100:101], v12 offset:27648
    ds_read_b64_tr_b16 v[102:103], v12 offset:27904
    s_waitcnt lgkmcnt(10)
    v_mfma_f32_32x32x16_bf16 v[24:39], v[184:187], v[104:107], v[24:39]
    s_add_u32 m0, s100, 143360
    s_add_u32 s80, s72, 129024
    buffer_load_dwordx4 v2, s[24:27], s80 offen  lds
    ds_read_b64_tr_b16 v[104:105], v12 offset:32768
    ds_read_b64_tr_b16 v[106:107], v12 offset:33024
    s_waitcnt lgkmcnt(10)
    v_mfma_f32_32x32x16_bf16 v[24:39], v[188:191], v[108:111], v[24:39]
    ds_read_b64_tr_b16 v[108:109], v12 offset:33792
    ds_read_b64_tr_b16 v[110:111], v12 offset:34048
    s_waitcnt lgkmcnt(10)
    v_mfma_f32_32x32x16_bf16 v[24:39], v[192:195], v[88:91], v[24:39]
    s_add_u32 m0, s100, 147456
    s_add_u32 s80, s72, 172032
    buffer_load_dwordx4 v2, s[24:27], s80 offen  lds
    ds_read_b64_tr_b16 v[88:89], v12 offset:34816
    ds_read_b64_tr_b16 v[90:91], v12 offset:35072
    s_waitcnt lgkmcnt(10)
    v_mfma_f32_32x32x16_bf16 v[24:39], v[196:199], v[92:95], v[24:39]
    ds_read_b64_tr_b16 v[92:93], v12 offset:35840
    ds_read_b64_tr_b16 v[94:95], v12 offset:36096
    s_waitcnt lgkmcnt(10)
    v_mfma_f32_32x32x16_bf16 v[24:39], v[200:203], v[96:99], v[24:39]
    s_add_u32 m0, s100, 151552
    s_add_u32 s80, s72, 215040
    buffer_load_dwordx4 v2, s[24:27], s80 offen  lds
    ds_read_b64_tr_b16 v[96:97], v12 offset:40960
    ds_read_b64_tr_b16 v[98:99], v12 offset:41216
    s_waitcnt lgkmcnt(10)
    v_mfma_f32_32x32x16_bf16 v[24:39], v[204:207], v[100:103], v[24:39]
    ds_read_b64_tr_b16 v[100:101], v12 offset:41984
    ds_read_b64_tr_b16 v[102:103], v12 offset:42240
    s_waitcnt lgkmcnt(10)
    v_mfma_f32_32x32x16_bf16 v[24:39], v[208:211], v[104:107], v[24:39]
    ds_read_b64_tr_b16 v[104:105], v12 offset:43008
    ds_read_b64_tr_b16 v[106:107], v12 offset:43264
    s_waitcnt lgkmcnt(10)
    v_mfma_f32_32x32x16_bf16 v[24:39], v[212:215], v[108:111], v[24:39]
    ds_read_b64_tr_b16 v[108:109], v12 offset:44032
    ds_read_b64_tr_b16 v[110:111], v12 offset:44288
    s_waitcnt lgkmcnt(10)
    v_mfma_f32_32x32x16_bf16 v[24:39], v[216:219], v[88:91], v[24:39]
    ds_read_b64_tr_b16 v[88:89], v12 offset:49152
    ds_read_b64_tr_b16 v[90:91], v12 offset:49408
    s_waitcnt lgkmcnt(10)
    v_mfma_f32_32x32x16_bf16 v[24:39], v[220:223], v[92:95], v[24:39]
    ds_read_b64_tr_b16 v[92:93], v12 offset:50176
    ds_read_b64_tr_b16 v[94:95], v12 offset:50432
    s_waitcnt lgkmcnt(10)
    v_mfma_f32_32x32x16_bf16 v[24:39], v[224:227], v[96:99], v[24:39]
    ds_read_b64_tr_b16 v[96:97], v12 offset:51200
    ds_read_b64_tr_b16 v[98:99], v12 offset:51456
    s_waitcnt lgkmcnt(10)
    v_mfma_f32_32x32x16_bf16 v[24:39], v[228:231], v[100:103], v[24:39]
    ds_read_b64_tr_b16 v[100:101], v12 offset:52224
    ds_read_b64_tr_b16 v[102:103], v12 offset:52480
    s_waitcnt lgkmcnt(10)
    v_mfma_f32_32x32x16_bf16 v[24:39], v[232:235], v[104:107], v[24:39]
    s_waitcnt lgkmcnt(8)
    v_mfma_f32_32x32x16_bf16 v[24:39], v[236:239], v[108:111], v[24:39]
    s_waitcnt lgkmcnt(6)
    v_mfma_f32_32x32x16_bf16 v[24:39], v[240:243], v[88:91], v[24:39]
    s_waitcnt vmcnt(6) lgkmcnt(0)
    s_barrier
    v_mfma_f32_32x32x16_bf16 v[24:39], v[244:247], v[92:95], v[24:39]
    ds_read_b64_tr_b16 v[104:105], v5 offset:57344
    ds_read_b64_tr_b16 v[106:107], v5 offset:57856
    ds_read_b64_tr_b16 v[108:109], v6 offset:57344
    ds_read_b64_tr_b16 v[110:111], v6 offset:57856
    v_mfma_f32_32x32x16_bf16 v[24:39], v[248:251], v[96:99], v[24:39]
    ds_read_b64_tr_b16 v[88:89], v5 offset:61440
    ds_read_b64_tr_b16 v[90:91], v5 offset:61952
    ds_read_b64_tr_b16 v[92:93], v6 offset:61440
    ds_read_b64_tr_b16 v[94:95], v6 offset:61952
    v_mfma_f32_32x32x16_bf16 v[24:39], v[252:255], v[100:103], v[24:39]
    s_setprio 0
    s_setprio 2
    ds_read_b64_tr_b16 v[96:97], v7 offset:0
    ds_read_b64_tr_b16 v[98:99], v7 offset:512
    s_waitcnt lgkmcnt(8)
    v_mfma_f32_32x32x16_bf16 v[112:127], v[104:107], v[184:187], v[112:127]
    ds_read_b64_tr_b16 v[100:101], v8 offset:0
    ds_read_b64_tr_b16 v[102:103], v8 offset:512
    s_waitcnt lgkmcnt(8)
    v_mfma_f32_32x32x16_bf16 v[128:143], v[108:111], v[184:187], v[128:143]
    s_mov_b32 exec_lo, 0xefffffff
    s_mov_b32 exec_hi, 0xefffffff
    v_cvt_pk_bf16_f32 v68, v24, v25
    v_cvt_pk_bf16_f32 v69, v26, v27
    v_cvt_pk_bf16_f32 v70, v28, v29
    v_cvt_pk_bf16_f32 v71, v30, v31
    v_cvt_pk_bf16_f32 v72, v32, v33
    v_cvt_pk_bf16_f32 v73, v34, v35
    v_cvt_pk_bf16_f32 v74, v36, v37
    v_cvt_pk_bf16_f32 v75, v38, v39
    s_mov_b64 exec, -1
    ds_write_b128 v76, v[68:71] offset:0
    ds_write_b128 v76, v[72:75] offset:1024
    ds_read_b64_tr_b16 v[104:105], v7 offset:4096
    ds_read_b64_tr_b16 v[106:107], v7 offset:4608
    s_waitcnt lgkmcnt(10)
    v_mfma_f32_32x32x16_bf16 v[112:127], v[88:91], v[188:191], v[112:127]
    ds_read_b64_tr_b16 v[108:109], v8 offset:4096
    ds_read_b64_tr_b16 v[110:111], v8 offset:4608
    s_waitcnt lgkmcnt(10)
    v_mfma_f32_32x32x16_bf16 v[128:143], v[92:95], v[188:191], v[128:143]
    ds_read_b64_tr_b16 v[88:89], v7 offset:8192
    ds_read_b64_tr_b16 v[90:91], v7 offset:8704
    s_waitcnt lgkmcnt(10)
    v_mfma_f32_32x32x16_bf16 v[112:127], v[96:99], v[192:195], v[112:127]
    ds_read_b64_tr_b16 v[92:93], v8 offset:8192
    ds_read_b64_tr_b16 v[94:95], v8 offset:8704
    s_waitcnt lgkmcnt(10)
    v_mfma_f32_32x32x16_bf16 v[128:143], v[100:103], v[192:195], v[128:143]
    ds_read_b64_tr_b16 v[96:97], v7 offset:12288
    ds_read_b64_tr_b16 v[98:99], v7 offset:12800
    s_waitcnt lgkmcnt(8)
    v_mfma_f32_32x32x16_bf16 v[112:127], v[104:107], v[196:199], v[112:127]
    ds_read_b64_tr_b16 v[100:101], v8 offset:12288
    ds_read_b64_tr_b16 v[102:103], v8 offset:12800
    s_waitcnt lgkmcnt(8)
    v_mfma_f32_32x32x16_bf16 v[128:143], v[108:111], v[196:199], v[128:143]
    ds_read_b64_tr_b16 v[104:105], v7 offset:16384
    ds_read_b64_tr_b16 v[106:107], v7 offset:16896
    s_waitcnt lgkmcnt(8)
    v_mfma_f32_32x32x16_bf16 v[112:127], v[88:91], v[200:203], v[112:127]
    ds_read_b64_tr_b16 v[108:109], v8 offset:16384
    ds_read_b64_tr_b16 v[110:111], v8 offset:16896
    s_waitcnt lgkmcnt(8)
    v_mfma_f32_32x32x16_bf16 v[128:143], v[92:95], v[200:203], v[128:143]
    ds_read_b64_tr_b16 v[88:89], v7 offset:20480
    ds_read_b64_tr_b16 v[90:91], v7 offset:20992
    s_waitcnt lgkmcnt(8)
    v_mfma_f32_32x32x16_bf16 v[112:127], v[96:99], v[204:207], v[112:127]
    ds_read_b64_tr_b16 v[92:93], v8 offset:20480
    ds_read_b64_tr_b16 v[94:95], v8 offset:20992
    s_waitcnt lgkmcnt(8)
    v_mfma_f32_32x32x16_bf16 v[128:143], v[100:103], v[204:207], v[128:143]
    ds_read_b64_tr_b16 v[96:97], v7 offset:24576
    ds_read_b64_tr_b16 v[98:99], v7 offset:25088
    s_waitcnt lgkmcnt(8)
    v_mfma_f32_32x32x16_bf16 v[112:127], v[104:107], v[208:211], v[112:127]
    ds_read_b64_tr_b16 v[100:101], v8 offset:24576
    ds_read_b64_tr_b16 v[102:103], v8 offset:25088
    s_waitcnt lgkmcnt(8)
    v_mfma_f32_32x32x16_bf16 v[128:143], v[108:111], v[208:211], v[128:143]
    ds_read_b64_tr_b16 v[104:105], v7 offset:28672
    ds_read_b64_tr_b16 v[106:107], v7 offset:29184
    s_waitcnt lgkmcnt(8)
    v_mfma_f32_32x32x16_bf16 v[112:127], v[88:91], v[212:215], v[112:127]
    ds_read_b64_tr_b16 v[108:109], v8 offset:28672
    ds_read_b64_tr_b16 v[110:111], v8 offset:29184
    s_waitcnt lgkmcnt(8)
    v_mfma_f32_32x32x16_bf16 v[128:143], v[92:95], v[212:215], v[128:143]
    s_barrier
    ds_read_b64_tr_b16 v[88:89], v7 offset:32768
    ds_read_b64_tr_b16 v[90:91], v7 offset:33280
    s_waitcnt lgkmcnt(8)
    v_mfma_f32_32x32x16_bf16 v[112:127], v[96:99], v[216:219], v[112:127]
    ds_read_b64_tr_b16 v[92:93], v8 offset:32768
    ds_read_b64_tr_b16 v[94:95], v8 offset:33280
    s_waitcnt lgkmcnt(8)
    v_mfma_f32_32x32x16_bf16 v[128:143], v[100:103], v[216:219], v[128:143]
    ds_read_b64_tr_b16 v[96:97], v7 offset:36864
    ds_read_b64_tr_b16 v[98:99], v7 offset:37376
    s_waitcnt lgkmcnt(8)
    v_mfma_f32_32x32x16_bf16 v[112:127], v[104:107], v[220:223], v[112:127]
    ds_read_b64_tr_b16 v[100:101], v8 offset:36864
    ds_read_b64_tr_b16 v[102:103], v8 offset:37376
    s_waitcnt lgkmcnt(8)
    v_mfma_f32_32x32x16_bf16 v[128:143], v[108:111], v[220:223], v[128:143]
    ds_read_b64_tr_b16 v[104:105], v7 offset:40960
    ds_read_b64_tr_b16 v[106:107], v7 offset:41472
    s_waitcnt lgkmcnt(8)
    v_mfma_f32_32x32x16_bf16 v[112:127], v[88:91], v[224:227], v[112:127]
    ds_read_b64_tr_b16 v[108:109], v8 offset:40960
    ds_read_b64_tr_b16 v[110:111], v8 offset:41472
    s_waitcnt lgkmcnt(8)
    v_mfma_f32_32x32x16_bf16 v[128:143], v[92:95], v[224:227], v[128:143]
    ds_read_b64_tr_b16 v[88:89], v7 offset:45056
    ds_read_b64_tr_b16 v[90:91], v7 offset:45568
    s_waitcnt lgkmcnt(8)
    v_mfma_f32_32x32x16_bf16 v[112:127], v[96:99], v[228:231], v[112:127]
    ds_read_b64_tr_b16 v[92:93], v8 offset:45056
    ds_read_b64_tr_b16 v[94:95], v8 offset:45568
    s_waitcnt lgkmcnt(8)
    v_mfma_f32_32x32x16_bf16 v[128:143], v[100:103], v[228:231], v[128:143]
    ds_read_b64_tr_b16 v[96:97], v7 offset:49152
    ds_read_b64_tr_b16 v[98:99], v7 offset:49664
    s_waitcnt lgkmcnt(8)
    v_mfma_f32_32x32x16_bf16 v[112:127], v[104:107], v[232:235], v[112:127]
    ds_read_b64_tr_b16 v[100:101], v8 offset:49152
    ds_read_b64_tr_b16 v[102:103], v8 offset:49664
    s_waitcnt lgkmcnt(8)
    v_mfma_f32_32x32x16_bf16 v[128:143], v[108:111], v[232:235], v[128:143]
    ds_read_b64_tr_b16 v[104:105], v7 offset:53248
    ds_read_b64_tr_b16 v[106:107], v7 offset:53760
    s_waitcnt lgkmcnt(8)
    v_mfma_f32_32x32x16_bf16 v[112:127], v[88:91], v[236:239], v[112:127]
    ds_read_b64_tr_b16 v[108:109], v8 offset:53248
    ds_read_b64_tr_b16 v[110:111], v8 offset:53760
    s_waitcnt lgkmcnt(8)
    v_mfma_f32_32x32x16_bf16 v[128:143], v[92:95], v[236:239], v[128:143]
    ds_read_b64_tr_b16 v[88:89], v7 offset:57344
    ds_read_b64_tr_b16 v[90:91], v7 offset:57856
    s_waitcnt lgkmcnt(8)
    v_mfma_f32_32x32x16_bf16 v[112:127], v[96:99], v[240:243], v[112:127]
    ds_read_b64_tr_b16 v[92:93], v8 offset:57344
    ds_read_b64_tr_b16 v[94:95], v8 offset:57856
    s_waitcnt lgkmcnt(8)
    v_mfma_f32_32x32x16_bf16 v[128:143], v[100:103], v[240:243], v[128:143]
    ds_read_b64_tr_b16 v[96:97], v7 offset:61440
    ds_read_b64_tr_b16 v[98:99], v7 offset:61952
    s_waitcnt lgkmcnt(8)
    v_mfma_f32_32x32x16_bf16 v[112:127], v[104:107], v[244:247], v[112:127]
    ds_read_b64_tr_b16 v[100:101], v8 offset:61440
    ds_read_b64_tr_b16 v[102:103], v8 offset:61952
    s_waitcnt lgkmcnt(8)
    v_mfma_f32_32x32x16_bf16 v[128:143], v[108:111], v[244:247], v[128:143]
    s_waitcnt lgkmcnt(6)
    v_mfma_f32_32x32x16_bf16 v[112:127], v[88:91], v[248:251], v[112:127]
    s_waitcnt lgkmcnt(4)
    v_mfma_f32_32x32x16_bf16 v[128:143], v[92:95], v[248:251], v[128:143]
    s_mul_i32 s83, s4, 3136
    s_add_u32 s83, s83, 156672
    v_add_u32_e64 v12, s83, v3
    ds_read_b64_tr_b16 v[76:77], v12 offset:0
    ds_read_b64_tr_b16 v[78:79], v12 offset:448
    ds_read_b64_tr_b16 v[80:81], v12 offset:896
    ds_read_b64_tr_b16 v[82:83], v12 offset:1344
    s_waitcnt lgkmcnt(6)
    v_mfma_f32_32x32x16_bf16 v[112:127], v[96:99], v[252:255], v[112:127]
    s_waitcnt lgkmcnt(4)
    v_mfma_f32_32x32x16_bf16 v[128:143], v[100:103], v[252:255], v[128:143]
    s_setprio 0
    s_nop 8
    v_cvt_pk_bf16_f32 v40, v112, v113
    v_cvt_pk_bf16_f32 v41, v114, v115
    v_cvt_pk_bf16_f32 v42, v116, v117
    v_cvt_pk_bf16_f32 v43, v118, v119
    v_cvt_pk_bf16_f32 v44, v120, v121
    v_cvt_pk_bf16_f32 v45, v122, v123
    v_cvt_pk_bf16_f32 v46, v124, v125
    v_cvt_pk_bf16_f32 v47, v126, v127
    s_waitcnt lgkmcnt(0)
    v_cndmask_b32 v82, v82, 0, s[68:69]
    v_cndmask_b32 v83, v83, 0, s[68:69]
    s_setprio 3
    v_mfma_f32_32x32x16_bf16 v[112:127], v[76:79], v[40:43], 0
    v_mfma_f32_32x32x16_bf16 v[112:127], v[80:83], v[44:47], v[112:127]
    s_setprio 0
    s_nop 0
    ds_read_b64_tr_b16 v[88:89], v12 offset:1568
    ds_read_b64_tr_b16 v[90:91], v12 offset:2016
    ds_read_b64_tr_b16 v[92:93], v12 offset:2464
    ds_read_b64_tr_b16 v[94:95], v12 offset:2912
    v_cvt_pk_bf16_f32 v48, v128, v129
    v_cvt_pk_bf16_f32 v49, v130, v131
    v_cvt_pk_bf16_f32 v50, v132, v133
    v_cvt_pk_bf16_f32 v51, v134, v135
    v_cvt_pk_bf16_f32 v52, v136, v137
    v_cvt_pk_bf16_f32 v53, v138, v139
    v_cvt_pk_bf16_f32 v54, v140, v141
    v_cvt_pk_bf16_f32 v55, v142, v143
    s_waitcnt lgkmcnt(0)
    v_cndmask_b32 v94, v94, 0, s[68:69]
    v_cndmask_b32 v95, v95, 0, s[68:69]
    s_setprio 3
    v_mfma_f32_32x32x16_bf16 v[60:75], v[88:91], v[48:51], 0
    v_mfma_f32_32x32x16_bf16 v[60:75], v[92:95], v[52:55], v[60:75]
    s_setprio 0
    s_nop 0
    v_max3_f32 v104, v112, v113, v114
    v_min3_f32 v105, v112, v113, v114
    v_cndmask_b32 v124, v124, v126, s[68:69]
    v_cndmask_b32 v125, v125, v127, s[68:69]
    v_max3_f32 v104, v104, v115, v116
    v_min3_f32 v105, v105, v115, v116
    v_max3_f32 v104, v104, v117, v118
    v_min3_f32 v105, v105, v117, v118
    v_max3_f32 v104, v104, v119, v120
    v_min3_f32 v105, v105, v119, v120
    v_max3_f32 v104, v104, v121, v122
    v_min3_f32 v105, v105, v121, v122
    v_max3_f32 v104, v104, v123, v124
    v_min3_f32 v105, v105, v123, v124
    v_max_f32 v104, v104, v125
    v_min_f32 v105, v105, v125
    v_mul_f32 v106, v104, v18
    v_mul_f32 v107, v105, v18
    v_mul_f32 v104, v104, v18
    v_mul_f32 v105, v105, v18
    s_nop 0
    v_permlane32_swap_b32 v104, v106
    v_permlane32_swap_b32 v105, v107
    v_max_f32 v104, v104, v106
    v_min_f32_e64 v105, v105, v107
    v_fma_f32 v88, v112, v18, -v104
    v_fma_f32 v112, -v112, v18, v105
    v_fma_f32 v89, v113, v18, -v104
    v_fma_f32 v113, -v113, v18, v105
    v_fma_f32 v90, v114, v18, -v104
    v_fma_f32 v114, -v114, v18, v105
    v_fma_f32 v91, v115, v18, -v104
    v_fma_f32 v115, -v115, v18, v105
    v_fma_f32 v92, v116, v18, -v104
    v_fma_f32 v116, -v116, v18, v105
    v_fma_f32 v93, v117, v18, -v104
    v_fma_f32 v117, -v117, v18, v105
    v_fma_f32 v94, v118, v18, -v104
    v_fma_f32 v118, -v118, v18, v105
    v_fma_f32 v95, v119, v18, -v104
    v_fma_f32 v119, -v119, v18, v105
    v_fma_f32 v96, v120, v18, -v104
    v_fma_f32 v120, -v120, v18, v105
    v_fma_f32 v97, v121, v18, -v104
    v_fma_f32 v121, -v121, v18, v105
    v_fma_f32 v98, v122, v18, -v104
    v_fma_f32 v122, -v122, v18, v105
    v_fma_f32 v99, v123, v18, -v104
    v_fma_f32 v123, -v123, v18, v105
    v_fma_f32 v100, v124, v18, -v104
    v_fma_f32 v124, -v124, v18, v105
    v_fma_f32 v101, v125, v18, -v104
    v_fma_f32 v125, -v125, v18, v105
    v_exp_f32 v88, v88
    v_exp_f32 v112, v112
    s_barrier
    v_exp_f32 v89, v89
    v_exp_f32 v113, v113
    v_exp_f32 v90, v90
    v_exp_f32 v114, v114
    v_exp_f32 v91, v91
    v_exp_f32 v115, v115
    v_exp_f32 v92, v92
    v_exp_f32 v116, v116
    v_exp_f32 v93, v93
    v_exp_f32 v117, v117
    v_exp_f32 v94, v94
    v_exp_f32 v118, v118
    v_exp_f32 v95, v95
    v_exp_f32 v119, v119
    v_exp_f32 v96, v96
    v_exp_f32 v120, v120
    v_exp_f32 v97, v97
    v_exp_f32 v121, v121
    v_exp_f32 v98, v98
    v_exp_f32 v122, v122
    v_exp_f32 v99, v99
    v_exp_f32 v123, v123
    v_exp_f32 v100, v100
    v_exp_f32 v124, v124
    v_exp_f32 v101, v101
    v_exp_f32 v125, v125
    v_mov_b32 v31, 0
    v_mov_b32_e64 v39, 0
    v_cvt_pk_bf16_f32 v24, v88, v89
    v_cvt_pk_bf16_f32 v25, v90, v91
    v_cvt_pk_bf16_f32 v26, v92, v93
    v_cvt_pk_bf16_f32 v27, v94, v95
    v_cvt_pk_bf16_f32 v28, v96, v97
    v_cvt_pk_bf16_f32 v29, v98, v99
    v_cvt_pk_bf16_f32 v30, v100, v101
    v_cvt_pk_bf16_f32 v32, v112, v113
    v_cvt_pk_bf16_f32 v33, v114, v115
    v_cvt_pk_bf16_f32 v34, v116, v117
    v_cvt_pk_bf16_f32 v35, v118, v119
    v_cvt_pk_bf16_f32 v36, v120, v121
    v_cvt_pk_bf16_f32 v37, v122, v123
    v_cvt_pk_bf16_f32 v38, v124, v125
    s_waitcnt vmcnt(0) lgkmcnt(0)
    s_barrier
    s_setprio 2
    s_nop 0
    ds_read_b64_tr_b16 v[88:89], v9 offset:0
    ds_read_b64_tr_b16 v[90:91], v9 offset:512
    ds_read_b64_tr_b16 v[92:93], v10 offset:0
    ds_read_b64_tr_b16 v[94:95], v10 offset:512
    ds_read_b64_tr_b16 v[96:97], v9 offset:4096
    ds_read_b64_tr_b16 v[98:99], v9 offset:4608
    ds_read_b64_tr_b16 v[100:101], v10 offset:4096
    ds_read_b64_tr_b16 v[102:103], v10 offset:4608
    ds_read_b64_tr_b16 v[104:105], v9 offset:8192
    ds_read_b64_tr_b16 v[106:107], v9 offset:8704
    s_waitcnt lgkmcnt(8)
    v_mfma_f32_32x32x16_bf16 v[112:127], v[88:91], v[144:147], 0
    ds_read_b64_tr_b16 v[108:109], v10 offset:8192
    ds_read_b64_tr_b16 v[110:111], v10 offset:8704
    s_waitcnt lgkmcnt(8)
    v_mfma_f32_32x32x16_bf16 v[128:143], v[92:95], v[144:147], 0
    s_mul_i32 s81, s42, 12544
    s_add_u32 s81, s81, s100
    s_add_u32 m0, s100, 114688
    s_add_u32 s80, s81, 6272
    buffer_load_dwordx4 v14, s[16:19], s80 offen  lds
    ds_read_b64_tr_b16 v[88:89], v9 offset:12288
    ds_read_b64_tr_b16 v[90:91], v9 offset:12800
    s_waitcnt lgkmcnt(8)
    v_mfma_f32_32x32x16_bf16 v[112:127], v[96:99], v[148:151], v[112:127]
    ds_read_b64_tr_b16 v[92:93], v10 offset:12288
    ds_read_b64_tr_b16 v[94:95], v10 offset:12800
    s_waitcnt lgkmcnt(8)
    s_nop 0
    v_mfma_f32_32x32x16_bf16 v[128:143], v[100:103], v[148:151], v[128:143]
    s_add_u32 m0, s100, 118784
    s_add_u32 s80, s81, 10368
    buffer_load_dwordx4 v14, s[16:19], s80 offen  lds
    ds_read_b64_tr_b16 v[96:97], v9 offset:16384
    ds_read_b64_tr_b16 v[98:99], v9 offset:16896
    s_waitcnt lgkmcnt(8)
    v_mfma_f32_32x32x16_bf16 v[112:127], v[104:107], v[152:155], v[112:127]
    ds_read_b64_tr_b16 v[100:101], v10 offset:16384
    ds_read_b64_tr_b16 v[102:103], v10 offset:16896
    s_waitcnt lgkmcnt(8)
    v_mfma_f32_32x32x16_bf16 v[128:143], v[108:111], v[152:155], v[128:143]
    buffer_load_dwordx2 v[16:17], v4, s[36:39], s50 offen sc1
    s_add_u32 m0, s100, 0
    s_add_u32 s80, s72, 946176
    buffer_load_dwordx4 v2, s[24:27], s80 offen  lds
    ds_read_b64_tr_b16 v[104:105], v9 offset:20480
    ds_read_b64_tr_b16 v[106:107], v9 offset:20992
    s_waitcnt lgkmcnt(8)
    v_mfma_f32_32x32x16_bf16 v[112:127], v[88:91], v[156:159], v[112:127]
    ds_read_b64_tr_b16 v[108:109], v10 offset:20480
    ds_read_b64_tr_b16 v[110:111], v10 offset:20992
    s_waitcnt lgkmcnt(8)
    s_nop 0
    v_mfma_f32_32x32x16_bf16 v[128:143], v[92:95], v[156:159], v[128:143]
    s_add_u32 m0, s100, 4096
    s_add_u32 s80, s72, 989184
    buffer_load_dwordx4 v2, s[24:27], s80 offen  lds
    ds_read_b64_tr_b16 v[88:89], v5 offset:24576
    ds_read_b64_tr_b16 v[90:91], v5 offset:25088
    s_waitcnt lgkmcnt(8)
    v_mfma_f32_32x32x16_bf16 v[112:127], v[96:99], v[160:163], v[112:127]
    ds_read_b64_tr_b16 v[92:93], v6 offset:24576
    ds_read_b64_tr_b16 v[94:95], v6 offset:25088
    s_waitcnt lgkmcnt(8)
    v_mfma_f32_32x32x16_bf16 v[128:143], v[100:103], v[160:163], v[128:143]
    s_add_u32 m0, s100, 8192
    s_add_u32 s80, s72, 1032192
    buffer_load_dwordx4 v2, s[24:27], s80 offen  lds
    ds_read_b64_tr_b16 v[96:97], v5 offset:28672
    ds_read_b64_tr_b16 v[98:99], v5 offset:29184
    s_waitcnt lgkmcnt(8)
    v_mfma_f32_32x32x16_bf16 v[112:127], v[104:107], v[164:167], v[112:127]
    ds_read_b64_tr_b16 v[100:101], v6 offset:28672
    ds_read_b64_tr_b16 v[102:103], v6 offset:29184
    s_waitcnt lgkmcnt(8)
    v_mfma_f32_32x32x16_bf16 v[128:143], v[108:111], v[164:167], v[128:143]
    s_add_u32 m0, s100, 12288
    s_add_u32 s80, s72, 1075200
    buffer_load_dwordx4 v2, s[24:27], s80 offen  lds
    ds_read_b64_tr_b16 v[104:105], v5 offset:32768
    ds_read_b64_tr_b16 v[106:107], v5 offset:33280
    s_waitcnt lgkmcnt(8)
    v_mfma_f32_32x32x16_bf16 v[112:127], v[88:91], v[168:171], v[112:127]
    ds_read_b64_tr_b16 v[108:109], v6 offset:32768
    ds_read_b64_tr_b16 v[110:111], v6 offset:33280
    s_waitcnt lgkmcnt(8)
    v_mfma_f32_32x32x16_bf16 v[128:143], v[92:95], v[168:171], v[128:143]
    s_add_u32 m0, s100, 16384
    s_add_u32 s80, s72, 1118208
    buffer_load_dwordx4 v2, s[24:27], s80 offen  lds
    ds_read_b64_tr_b16 v[88:89], v5 offset:36864
    ds_read_b64_tr_b16 v[90:91], v5 offset:37376
    s_waitcnt lgkmcnt(8)
    v_mfma_f32_32x32x16_bf16 v[112:127], v[96:99], v[172:175], v[112:127]
    ds_read_b64_tr_b16 v[92:93], v6 offset:36864
    ds_read_b64_tr_b16 v[94:95], v6 offset:37376
    s_waitcnt lgkmcnt(8)
    v_mfma_f32_32x32x16_bf16 v[128:143], v[100:103], v[172:175], v[128:143]
    s_add_u32 m0, s100, 20480
    s_add_u32 s80, s72, 1161216
    buffer_load_dwordx4 v2, s[24:27], s80 offen  lds
    ds_read_b64_tr_b16 v[96:97], v5 offset:40960
    ds_read_b64_tr_b16 v[98:99], v5 offset:41472
    s_waitcnt lgkmcnt(8)
    v_mfma_f32_32x32x16_bf16 v[112:127], v[104:107], v[176:179], v[112:127]
    ds_read_b64_tr_b16 v[100:101], v6 offset:40960
    ds_read_b64_tr_b16 v[102:103], v6 offset:41472
    s_waitcnt lgkmcnt(8)
    v_mfma_f32_32x32x16_bf16 v[128:143], v[108:111], v[176:179], v[128:143]
    ds_read_b64_tr_b16 v[104:105], v5 offset:45056
    ds_read_b64_tr_b16 v[106:107], v5 offset:45568
    s_waitcnt lgkmcnt(8)
    v_mfma_f32_32x32x16_bf16 v[112:127], v[88:91], v[180:183], v[112:127]
    ds_read_b64_tr_b16 v[108:109], v6 offset:45056
    ds_read_b64_tr_b16 v[110:111], v6 offset:45568
    s_waitcnt lgkmcnt(8)
    v_mfma_f32_32x32x16_bf16 v[128:143], v[92:95], v[180:183], v[128:143]
    ds_read_b64_tr_b16 v[88:89], v5 offset:49152
    ds_read_b64_tr_b16 v[90:91], v5 offset:49664
    s_waitcnt lgkmcnt(8)
    v_mfma_f32_32x32x16_bf16 v[112:127], v[96:99], v[184:187], v[112:127]
    ds_read_b64_tr_b16 v[92:93], v6 offset:49152
    ds_read_b64_tr_b16 v[94:95], v6 offset:49664
    s_waitcnt lgkmcnt(8)
    v_mfma_f32_32x32x16_bf16 v[128:143], v[100:103], v[184:187], v[128:143]
    ds_read_b64_tr_b16 v[96:97], v5 offset:53248
    ds_read_b64_tr_b16 v[98:99], v5 offset:53760
    s_waitcnt lgkmcnt(8)
    v_mfma_f32_32x32x16_bf16 v[112:127], v[104:107], v[188:191], v[112:127]
    ds_read_b64_tr_b16 v[100:101], v6 offset:53248
    ds_read_b64_tr_b16 v[102:103], v6 offset:53760
    s_waitcnt lgkmcnt(8)
    v_mfma_f32_32x32x16_bf16 v[128:143], v[108:111], v[188:191], v[128:143]
    s_waitcnt lgkmcnt(6)
    v_mfma_f32_32x32x16_bf16 v[112:127], v[88:91], v[192:195], v[112:127]
    s_waitcnt lgkmcnt(4)
    v_mfma_f32_32x32x16_bf16 v[128:143], v[92:95], v[192:195], v[128:143]
    s_waitcnt vmcnt(6)
    v_cmp_ne_u64 vcc, s[44:45], v[16:17]
    s_nop 0
    s_cbranch_vccnz L_rare89
L_back90:
    buffer_load_dwordx4 v[144:147], v1, s[36:39], s51 offen offset:0 sc1
    buffer_load_dwordx4 v[160:163], v1, s[36:39], s51 offen offset:1024 sc1
    s_add_u32 s51, s51, 16384
    buffer_load_dwordx4 v[148:151], v1, s[36:39], s51 offen offset:0 sc1
    buffer_load_dwordx4 v[164:167], v1, s[36:39], s51 offen offset:1024 sc1
    s_add_u32 s51, s51, 16384
    buffer_load_dwordx4 v[152:155], v1, s[36:39], s51 offen offset:0 sc1
    buffer_load_dwordx4 v[168:171], v1, s[36:39], s51 offen offset:1024 sc1
    s_add_u32 s51, s51, 16384
    buffer_load_dwordx4 v[156:159], v1, s[36:39], s51 offen offset:0 sc1
    buffer_load_dwordx4 v[172:175], v1, s[36:39], s51 offen offset:1024 sc1
    s_waitcnt lgkmcnt(2)
    v_mfma_f32_32x32x16_bf16 v[112:127], v[96:99], v[196:199], v[112:127]
    s_waitcnt lgkmcnt(0)
    v_mfma_f32_32x32x16_bf16 v[128:143], v[100:103], v[196:199], v[128:143]
    s_setprio 0
    s_nop 0
    v_max3_f32 v104, v60, v61, v62
    v_min3_f32 v105, v60, v61, v62
    v_cndmask_b32 v72, v72, v74, s[68:69]
    v_cndmask_b32 v73, v73, v75, s[68:69]
    v_max3_f32 v104, v104, v63, v64
    v_min3_f32 v105, v105, v63, v64
    v_max3_f32 v104, v104, v65, v66
    v_min3_f32 v105, v105, v65, v66
    v_max3_f32 v104, v104, v67, v68
    v_min3_f32 v105, v105, v67, v68
    v_max3_f32 v104, v104, v69, v70
    v_min3_f32 v105, v105, v69, v70
    v_max3_f32 v104, v104, v71, v72
    v_min3_f32 v105, v105, v71, v72
    v_max_f32 v104, v104, v73
    v_min_f32 v105, v105, v73
    v_mul_f32 v106, v104, v18
    v_mul_f32 v107, v105, v18
    v_mul_f32 v104, v104, v18
    v_mul_f32 v105, v105, v18
    s_nop 0
    v_permlane32_swap_b32 v104, v106
    v_permlane32_swap_b32 v105, v107
    v_max_f32 v104, v104, v106
    v_min_f32_e64 v105, v105, v107
    v_fma_f32 v88, v60, v18, -v104
    v_fma_f32 v60, -v60, v18, v105
    v_fma_f32 v89, v61, v18, -v104
    v_fma_f32 v61, -v61, v18, v105
    v_fma_f32 v90, v62, v18, -v104
    v_fma_f32 v62, -v62, v18, v105
    v_fma_f32 v91, v63, v18, -v104
    v_fma_f32 v63, -v63, v18, v105
    v_fma_f32 v92, v64, v18, -v104
    v_fma_f32 v64, -v64, v18, v105
    v_fma_f32 v93, v65, v18, -v104
    v_fma_f32 v65, -v65, v18, v105
    v_fma_f32 v94, v66, v18, -v104
    v_fma_f32 v66, -v66, v18, v105
    v_fma_f32 v95, v67, v18, -v104
    v_fma_f32 v67, -v67, v18, v105
    v_fma_f32 v96, v68, v18, -v104
    v_fma_f32 v68, -v68, v18, v105
    v_fma_f32 v97, v69, v18, -v104
    v_fma_f32 v69, -v69, v18, v105
    v_fma_f32 v98, v70, v18, -v104
    v_fma_f32 v70, -v70, v18, v105
    v_fma_f32 v99, v71, v18, -v104
    v_fma_f32 v71, -v71, v18, v105
    v_fma_f32 v100, v72, v18, -v104
    v_fma_f32 v72, -v72, v18, v105
    v_fma_f32 v101, v73, v18, -v104
    v_fma_f32 v73, -v73, v18, v105
    v_exp_f32 v88, v88
    v_exp_f32 v60, v60
    v_exp_f32 v89, v89
    v_exp_f32 v61, v61
    v_exp_f32 v90, v90
    v_exp_f32 v62, v62
    v_exp_f32 v91, v91
    v_exp_f32 v63, v63
    v_exp_f32 v92, v92
    v_exp_f32 v64, v64
    v_exp_f32 v93, v93
    v_exp_f32 v65, v65
    v_exp_f32 v94, v94
    v_exp_f32 v66, v66
    v_exp_f32 v95, v95
    v_exp_f32 v67, v67
    v_exp_f32 v96, v96
    v_exp_f32 v68, v68
    v_exp_f32 v97, v97
    v_exp_f32 v69, v69
    v_mov_b32 v76, 0
    v_mov_b32 v77, 0
    v_mov_b32 v78, v15
    v_mov_b32 v79, v11
    v_mov_b32 v80, 0
    v_mov_b32 v81, 0
    v_mov_b32_e64 v82, s76
    s_setprio 3
    s_waitcnt vmcnt(0)
    v_mfma_f32_16x16x32_bf16 v[176:179], v[78:81], v[144:147], 0
    v_mfma_f32_16x16x32_bf16 v[180:183], v[76:79], v[144:147], 0
    v_mfma_f32_16x16x32_bf16 v[176:179], v[78:81], v[148:151], v[176:179]
    v_mfma_f32_16x16x32_bf16 v[180:183], v[76:79], v[148:151], v[180:183]
    v_mfma_f32_16x16x32_bf16 v[176:179], v[78:81], v[152:155], v[176:179]
    v_mfma_f32_16x16x32_bf16 v[180:183], v[76:79], v[152:155], v[180:183]
    v_mfma_f32_16x16x32_bf16 v[176:179], v[78:81], v[156:159], v[176:179]
    v_mfma_f32_16x16x32_bf16 v[180:183], v[76:79], v[156:159], v[180:183]
    v_mfma_f32_16x16x32_bf16 v[184:187], v[78:81], v[160:163], 0
    v_mfma_f32_16x16x32_bf16 v[188:191], v[76:79], v[160:163], 0
    v_mfma_f32_16x16x32_bf16 v[184:187], v[78:81], v[164:167], v[184:187]
    v_mfma_f32_16x16x32_bf16 v[188:191], v[76:79], v[164:167], v[188:191]
    v_mfma_f32_16x16x32_bf16 v[184:187], v[78:81], v[168:171], v[184:187]
    v_mfma_f32_16x16x32_bf16 v[188:191], v[76:79], v[168:171], v[188:191]
    v_mfma_f32_16x16x32_bf16 v[184:187], v[78:81], v[172:175], v[184:187]
    v_mfma_f32_16x16x32_bf16 v[188:191], v[76:79], v[172:175], v[188:191]
    s_setprio 0
    v_exp_f32 v98, v98
    v_exp_f32 v70, v70
    v_exp_f32 v99, v99
    v_exp_f32 v71, v71
    v_exp_f32 v100, v100
    v_exp_f32 v72, v72
    v_exp_f32 v101, v101
    v_exp_f32 v73, v73
    v_mov_b32 v47, 0
    v_cvt_pk_bf16_f32 v192, v176, v177
    v_cvt_pk_bf16_f32 v193, v178, v179
    v_cvt_pk_bf16_f32 v194, v180, v181
    v_cvt_pk_bf16_f32 v195, v182, v183
    v_cvt_pk_bf16_f32 v196, v184, v185
    v_cvt_pk_bf16_f32 v197, v186, v187
    v_cvt_pk_bf16_f32 v198, v188, v189
    v_cndmask_b32 v192, v192, v82, s[54:55]
    v_cndmask_b32 v193, v193, v82, s[54:55]
    v_cndmask_b32 v194, v194, v82, s[54:55]
    v_cndmask_b32 v195, v195, v82, s[54:55]
    v_cndmask_b32 v196, v196, v82, s[54:55]
    v_cndmask_b32 v197, v197, v82, s[54:55]
    v_cndmask_b32 v198, v198, v82, s[54:55]
    v_mov_b32_e64 v199, 0
    s_mov_b64 exec, 0xffff
    buffer_store_dwordx4 v[192:195], v14, s[36:39], s52 offen offset:0 sc1
    buffer_store_dwordx4 v[196:199], v14, s[36:39], s52 offen offset:1024 sc1
    s_mov_b64 exec, -1
    v_mov_b32 v55, 0
    v_cvt_pk_bf16_f32 v40, v88, v89
    v_cvt_pk_bf16_f32 v41, v90, v91
    v_cvt_pk_bf16_f32 v42, v92, v93
    v_cvt_pk_bf16_f32 v43, v94, v95
    v_cvt_pk_bf16_f32 v44, v96, v97
    v_cvt_pk_bf16_f32 v45, v98, v99
    v_cvt_pk_bf16_f32 v46, v100, v101
    v_cvt_pk_bf16_f32 v48, v60, v61
    v_cvt_pk_bf16_f32 v49, v62, v63
    v_cvt_pk_bf16_f32 v50, v64, v65
    v_cvt_pk_bf16_f32 v51, v66, v67
    v_cvt_pk_bf16_f32 v52, v68, v69
    v_cvt_pk_bf16_f32 v53, v70, v71
    v_cvt_pk_bf16_f32 v54, v72, v73
    s_barrier
    s_setprio 2
    ds_read_b64_tr_b16 v[88:89], v5 offset:57344
    ds_read_b64_tr_b16 v[90:91], v5 offset:57856
    ds_read_b64_tr_b16 v[92:93], v6 offset:57344
    ds_read_b64_tr_b16 v[94:95], v6 offset:57856
    ds_read_b64_tr_b16 v[96:97], v5 offset:61440
    ds_read_b64_tr_b16 v[98:99], v5 offset:61952
    ds_read_b64_tr_b16 v[100:101], v6 offset:61440
    ds_read_b64_tr_b16 v[102:103], v6 offset:61952
    ds_read_b64_tr_b16 v[104:105], v7 offset:0
    ds_read_b64_tr_b16 v[106:107], v7 offset:512
    s_waitcnt lgkmcnt(8)
    v_mfma_f32_32x32x16_bf16 v[112:127], v[88:91], v[200:203], v[112:127]
    ds_read_b64_tr_b16 v[108:109], v8 offset:0
    ds_read_b64_tr_b16 v[110:111], v8 offset:512
    s_waitcnt lgkmcnt(8)
    v_mfma_f32_32x32x16_bf16 v[128:143], v[92:95], v[200:203], v[128:143]
    ds_read_b64_tr_b16 v[88:89], v7 offset:4096
    ds_read_b64_tr_b16 v[90:91], v7 offset:4608
    s_waitcnt lgkmcnt(8)
    v_mfma_f32_32x32x16_bf16 v[112:127], v[96:99], v[204:207], v[112:127]
    ds_read_b64_tr_b16 v[92:93], v8 offset:4096
    ds_read_b64_tr_b16 v[94:95], v8 offset:4608
    s_waitcnt lgkmcnt(8)
    v_mfma_f32_32x32x16_bf16 v[128:143], v[100:103], v[204:207], v[128:143]
    ds_read_b64_tr_b16 v[96:97], v7 offset:8192
    ds_read_b64_tr_b16 v[98:99], v7 offset:8704
    s_waitcnt lgkmcnt(8)
    v_mfma_f32_32x32x16_bf16 v[112:127], v[104:107], v[208:211], v[112:127]
    ds_read_b64_tr_b16 v[100:101], v8 offset:8192
    ds_read_b64_tr_b16 v[102:103], v8 offset:8704
    s_waitcnt lgkmcnt(8)
    v_mfma_f32_32x32x16_bf16 v[128:143], v[108:111], v[208:211], v[128:143]
    s_waitcnt vmcnt(0)
    v_mov_b32 v22, s44
    v_mov_b32 v23, s45
    s_mov_b64 exec, 1
    buffer_store_dwordx2 v[22:23], off, s[36:39], s53 sc1
    s_mov_b64 exec, -1
    ds_read_b64_tr_b16 v[104:105], v7 offset:12288
    ds_read_b64_tr_b16 v[106:107], v7 offset:12800
    s_waitcnt lgkmcnt(8)
    v_mfma_f32_32x32x16_bf16 v[112:127], v[88:91], v[212:215], v[112:127]
    ds_read_b64_tr_b16 v[108:109], v8 offset:12288
    ds_read_b64_tr_b16 v[110:111], v8 offset:12800
    s_waitcnt lgkmcnt(8)
    v_mfma_f32_32x32x16_bf16 v[128:143], v[92:95], v[212:215], v[128:143]
    ds_read_b64_tr_b16 v[88:89], v7 offset:16384
    ds_read_b64_tr_b16 v[90:91], v7 offset:16896
    s_waitcnt lgkmcnt(8)
    v_mfma_f32_32x32x16_bf16 v[112:127], v[96:99], v[216:219], v[112:127]
    ds_read_b64_tr_b16 v[92:93], v8 offset:16384
    ds_read_b64_tr_b16 v[94:95], v8 offset:16896
    s_waitcnt lgkmcnt(8)
    v_mfma_f32_32x32x16_bf16 v[128:143], v[100:103], v[216:219], v[128:143]
    ds_read_b64_tr_b16 v[96:97], v7 offset:20480
    ds_read_b64_tr_b16 v[98:99], v7 offset:20992
    s_waitcnt lgkmcnt(8)
    v_mfma_f32_32x32x16_bf16 v[112:127], v[104:107], v[220:223], v[112:127]
    ds_read_b64_tr_b16 v[100:101], v8 offset:20480
    ds_read_b64_tr_b16 v[102:103], v8 offset:20992
    s_waitcnt lgkmcnt(8)
    v_mfma_f32_32x32x16_bf16 v[128:143], v[108:111], v[220:223], v[128:143]
    ds_read_b64_tr_b16 v[104:105], v5 offset:0
    ds_read_b64_tr_b16 v[106:107], v5 offset:512
    s_waitcnt lgkmcnt(8)
    v_mfma_f32_32x32x16_bf16 v[112:127], v[88:91], v[224:227], v[112:127]
    ds_read_b64_tr_b16 v[108:109], v6 offset:0
    ds_read_b64_tr_b16 v[110:111], v6 offset:512
    s_waitcnt lgkmcnt(8)
    v_mfma_f32_32x32x16_bf16 v[128:143], v[92:95], v[224:227], v[128:143]
    ds_read_b64_tr_b16 v[88:89], v5 offset:4096
    ds_read_b64_tr_b16 v[90:91], v5 offset:4608
    s_waitcnt lgkmcnt(8)
    v_mfma_f32_32x32x16_bf16 v[112:127], v[96:99], v[228:231], v[112:127]
    ds_read_b64_tr_b16 v[92:93], v6 offset:4096
    ds_read_b64_tr_b16 v[94:95], v6 offset:4608
    s_waitcnt lgkmcnt(8)
    v_mfma_f32_32x32x16_bf16 v[128:143], v[100:103], v[228:231], v[128:143]
    ds_read_b64_tr_b16 v[96:97], v5 offset:8192
    ds_read_b64_tr_b16 v[98:99], v5 offset:8704
    s_waitcnt lgkmcnt(8)
    v_mfma_f32_32x32x16_bf16 v[112:127], v[104:107], v[232:235], v[112:127]
    ds_read_b64_tr_b16 v[100:101], v6 offset:8192
    ds_read_b64_tr_b16 v[102:103], v6 offset:8704
    s_waitcnt lgkmcnt(8)
    v_mfma_f32_32x32x16_bf16 v[128:143], v[108:111], v[232:235], v[128:143]
    ds_read_b64_tr_b16 v[104:105], v5 offset:12288
    ds_read_b64_tr_b16 v[106:107], v5 offset:12800
    s_waitcnt lgkmcnt(8)
    v_mfma_f32_32x32x16_bf16 v[112:127], v[88:91], v[236:239], v[112:127]
    ds_read_b64_tr_b16 v[108:109], v6 offset:12288
    ds_read_b64_tr_b16 v[110:111], v6 offset:12800
    s_waitcnt lgkmcnt(8)
    v_mfma_f32_32x32x16_bf16 v[128:143], v[92:95], v[236:239], v[128:143]
    ds_read_b64_tr_b16 v[88:89], v5 offset:16384
    ds_read_b64_tr_b16 v[90:91], v5 offset:16896
    s_waitcnt lgkmcnt(8)
    v_mfma_f32_32x32x16_bf16 v[112:127], v[96:99], v[240:243], v[112:127]
    ds_read_b64_tr_b16 v[92:93], v6 offset:16384
    ds_read_b64_tr_b16 v[94:95], v6 offset:16896
    s_waitcnt lgkmcnt(8)
    v_mfma_f32_32x32x16_bf16 v[128:143], v[100:103], v[240:243], v[128:143]
    ds_read_b64_tr_b16 v[96:97], v5 offset:20480
    ds_read_b64_tr_b16 v[98:99], v5 offset:20992
    s_waitcnt lgkmcnt(8)
    v_mfma_f32_32x32x16_bf16 v[112:127], v[104:107], v[244:247], v[112:127]
    ds_read_b64_tr_b16 v[100:101], v6 offset:20480
    ds_read_b64_tr_b16 v[102:103], v6 offset:20992
    s_waitcnt lgkmcnt(8)
    v_mfma_f32_32x32x16_bf16 v[128:143], v[108:111], v[244:247], v[128:143]
    s_waitcnt lgkmcnt(6)
    v_mfma_f32_32x32x16_bf16 v[112:127], v[88:91], v[248:251], v[112:127]
    s_waitcnt lgkmcnt(4)
    v_mfma_f32_32x32x16_bf16 v[128:143], v[92:95], v[248:251], v[128:143]
    s_mul_i32 s83, s4, 3136
    s_add_u32 s83, s83, 114688
    v_add_u32 v12, s83, v3
    ds_read_b64_tr_b16 v[76:77], v12 offset:0
    ds_read_b64_tr_b16 v[78:79], v12 offset:448
    ds_read_b64_tr_b16 v[80:81], v12 offset:896
    ds_read_b64_tr_b16 v[82:83], v12 offset:1344
    s_waitcnt lgkmcnt(6)
    v_mfma_f32_32x32x16_bf16 v[112:127], v[96:99], v[252:255], v[112:127]
    s_waitcnt lgkmcnt(4)
    v_mfma_f32_32x32x16_bf16 v[128:143], v[100:103], v[252:255], v[128:143]
    s_setprio 0
    s_lshl_b32 s80, s4, 13
    v_add_u32 v11, s80, v14
    s_lshl_b32 s80, s6, 2
    s_add_u32 s80, s80, s5
    s_lshl_b32 s80, s80, 1
    s_add_u32 s80, s80, s42
    s_lshl_b32 s77, s80, 4
    s_add_u32 s77, s77, s4
    s_lshl_b32 s77, s77, 3
    s_add_u32 s77, s77, 17039360
    s_lshl_b32 s80, s80, 2
    s_add_u32 s80, s80, s4
    s_lshl_b32 s80, s80, 12
    s_add_u32 s48, s80, 8388608
    s_add_u32 s49, s48, 8192
    s_lshl_b32 s62, s42, 2
    s_and_b32 s63, s3, 3
    s_add_u32 s62, s62, s63
    s_lshl_b32 s63, s62, 9
    s_add_u32 s63, s63, 17055744
    v_bfe_u32 v180, v0, 1, 2
    v_and_b32 v181, 1, v0
    v_lshlrev_b32_e64 v181, 4, v181
    v_lshl_add_u32 v180, v180, 7, v181
    v_cvt_pk_bf16_f32 v160, v112, v113
    v_cvt_pk_bf16_f32 v161, v114, v115
    v_cvt_pk_bf16_f32 v162, v116, v117
    v_cvt_pk_bf16_f32 v163, v118, v119
    v_cvt_pk_bf16_f32 v164, v120, v121
    v_cvt_pk_bf16_f32 v165, v122, v123
    v_cvt_pk_bf16_f32 v166, v124, v125
    v_cvt_pk_bf16_f32 v167, v126, v127
    s_waitcnt lgkmcnt(0)
    v_cndmask_b32 v82, v82, 0, s[68:69]
    v_cndmask_b32 v83, v83, 0, s[68:69]
    s_setprio 3
    v_mfma_f32_32x32x16_bf16 v[112:127], v[76:79], v[160:163], 0
    v_mfma_f32_32x32x16_bf16 v[112:127], v[80:83], v[164:167], v[112:127]
    s_setprio 0
    s_nop 0
    ds_read_b64_tr_b16 v[88:89], v12 offset:1568
    ds_read_b64_tr_b16 v[90:91], v12 offset:2016
    ds_read_b64_tr_b16 v[92:93], v12 offset:2464
    ds_read_b64_tr_b16 v[94:95], v12 offset:2912
    v_cvt_pk_bf16_f32 v168, v128, v129
    v_cvt_pk_bf16_f32 v169, v130, v131
    v_cvt_pk_bf16_f32 v170, v132, v133
    v_cvt_pk_bf16_f32 v171, v134, v135
    v_cvt_pk_bf16_f32 v172, v136, v137
    v_cvt_pk_bf16_f32 v173, v138, v139
    v_cvt_pk_bf16_f32 v174, v140, v141
    v_cvt_pk_bf16_f32 v175, v142, v143
    s_waitcnt lgkmcnt(0)
    v_cndmask_b32 v94, v94, 0, s[68:69]
    v_cndmask_b32 v95, v95, 0, s[68:69]
    s_setprio 3
    v_mfma_f32_32x32x16_bf16 v[60:75], v[88:91], v[168:171], 0
    v_mfma_f32_32x32x16_bf16 v[60:75], v[92:95], v[172:175], v[60:75]
    s_setprio 0
    s_nop 0
    v_max3_f32 v104, v112, v113, v114
    v_min3_f32 v105, v112, v113, v114
    v_cndmask_b32 v124, v124, v126, s[68:69]
    v_cndmask_b32 v125, v125, v127, s[68:69]
    v_max3_f32 v104, v104, v115, v116
    v_min3_f32 v105, v105, v115, v116
    v_max3_f32 v104, v104, v117, v118
    v_min3_f32 v105, v105, v117, v118
    v_max3_f32 v104, v104, v119, v120
    v_min3_f32 v105, v105, v119, v120
    v_max3_f32 v104, v104, v121, v122
    v_min3_f32 v105, v105, v121, v122
    v_max3_f32 v104, v104, v123, v124
    v_min3_f32 v105, v105, v123, v124
    v_max_f32 v104, v104, v125
    v_min_f32 v105, v105, v125
    v_mul_f32 v106, v104, v18
    v_mul_f32 v107, v105, v18
    v_mul_f32_e64 v104, v104, v18
    buffer_load_dwordx4 v[176:179], v180, s[36:39], s63 offen sc1
    v_mul_f32 v105, v105, v18
    v_permlane32_swap_b32 v104, v106
    s_nop 0
    v_permlane32_swap_b32 v105, v107
    v_max_f32 v104, v104, v106
    v_min_f32 v105, v105, v107
    v_fma_f32 v88, v112, v18, -v104
    v_fma_f32 v112, -v112, v18, v105
    v_fma_f32 v89, v113, v18, -v104
    v_fma_f32 v113, -v113, v18, v105
    v_fma_f32 v90, v114, v18, -v104
    v_fma_f32 v114, -v114, v18, v105
    v_fma_f32 v91, v115, v18, -v104
    v_fma_f32 v115, -v115, v18, v105
    v_fma_f32 v92, v116, v18, -v104
    v_fma_f32 v116, -v116, v18, v105
    v_fma_f32 v93, v117, v18, -v104
    v_fma_f32 v117, -v117, v18, v105
    v_fma_f32 v94, v118, v18, -v104
    v_fma_f32 v118, -v118, v18, v105
    v_fma_f32 v95, v119, v18, -v104
    v_fma_f32 v119, -v119, v18, v105
    v_fma_f32 v96, v120, v18, -v104
    v_fma_f32 v120, -v120, v18, v105
    v_fma_f32 v97, v121, v18, -v104
    v_fma_f32 v121, -v121, v18, v105
    v_fma_f32 v98, v122, v18, -v104
    v_fma_f32 v122, -v122, v18, v105
    v_fma_f32 v99, v123, v18, -v104
    v_fma_f32 v123, -v123, v18, v105
    v_fma_f32 v100, v124, v18, -v104
    v_fma_f32 v124, -v124, v18, v105
    v_fma_f32 v101, v125, v18, -v104
    v_fma_f32 v125, -v125, v18, v105
    v_exp_f32 v88, v88
    v_exp_f32 v112, v112
    v_exp_f32 v89, v89
    v_exp_f32 v113, v113
    v_exp_f32 v90, v90
    v_exp_f32 v114, v114
    v_exp_f32 v91, v91
    v_exp_f32 v115, v115
    v_exp_f32 v92, v92
    v_exp_f32 v116, v116
    v_exp_f32 v93, v93
    v_exp_f32 v117, v117
    v_exp_f32 v94, v94
    v_exp_f32 v118, v118
    v_exp_f32 v95, v95
    v_exp_f32 v119, v119
    v_exp_f32 v96, v96
    v_exp_f32 v120, v120
    v_exp_f32 v97, v97
    v_exp_f32 v121, v121
    v_exp_f32 v98, v98
    v_exp_f32 v122, v122
    v_exp_f32 v99, v99
    v_exp_f32 v123, v123
    v_exp_f32 v100, v100
    v_exp_f32 v124, v124
    v_exp_f32 v101, v101
    v_exp_f32 v125, v125
    v_mov_b32 v151, 0
    v_mov_b32 v159, 0
    v_cvt_pk_bf16_f32 v144, v88, v89
    v_cvt_pk_bf16_f32 v145, v90, v91
    v_cvt_pk_bf16_f32 v146, v92, v93
    v_cvt_pk_bf16_f32 v147, v94, v95
    v_cvt_pk_bf16_f32 v148, v96, v97
    v_cvt_pk_bf16_f32 v149, v98, v99
    v_cvt_pk_bf16_f32 v150, v100, v101
    v_cvt_pk_bf16_f32 v152, v112, v113
    v_cvt_pk_bf16_f32 v153, v114, v115
    v_cvt_pk_bf16_f32 v154, v116, v117
    v_cvt_pk_bf16_f32 v155, v118, v119
    v_cvt_pk_bf16_f32 v156, v120, v121
    v_cvt_pk_bf16_f32 v157, v122, v123
    v_cvt_pk_bf16_f32 v158, v124, v125
    s_waitcnt vmcnt(0)
    v_cmp_ne_u64 vcc, s[44:45], v[176:177]
    v_cmp_ne_u64 s[84:85], s[44:45], v[178:179]
    s_nop 0
    s_or_b64 vcc, vcc, s[84:85]
    s_cbranch_vccnz L_rare95
L_back96:
    s_lshl_b32 s80, s62, 13
    s_add_u32 s80, s80, 16777216
    s_lshl_b32 m0, s100, 3
    s_add_u32 m0, m0, 24576
    s_nop 0
    buffer_load_dwordx4 v14, s[36:39], s80 offen offset:0 sc1 lds
    buffer_load_dwordx4 v14, s[36:39], s80 offen offset:1024 sc1 lds
    buffer_load_dwordx4 v14, s[36:39], s80 offen offset:2048 sc1 lds
    buffer_load_dwordx4 v14, s[36:39], s80 offen offset:3072 sc1 lds
    s_add_u32 m0, m0, 4096
    s_add_u32 s80, s80, 4096
    buffer_load_dwordx4 v14, s[36:39], s80 offen offset:0 sc1 lds
    buffer_load_dwordx4 v14, s[36:39], s80 offen offset:1024 sc1 lds
    buffer_load_dwordx4 v14, s[36:39], s80 offen offset:2048 sc1 lds
    buffer_load_dwordx4 v14, s[36:39], s80 offen offset:3072 sc1 lds
    v_max3_f32 v104, v60, v61, v62
    v_min3_f32 v105, v60, v61, v62
    v_cndmask_b32 v72, v72, v74, s[68:69]
    v_cndmask_b32 v73, v73, v75, s[68:69]
    v_max3_f32 v104, v104, v63, v64
    v_min3_f32 v105, v105, v63, v64
    v_max3_f32 v104, v104, v65, v66
    v_min3_f32 v105, v105, v65, v66
    v_max3_f32 v104, v104, v67, v68
    v_min3_f32 v105, v105, v67, v68
    v_max3_f32 v104, v104, v69, v70
    v_min3_f32 v105, v105, v69, v70
    v_max3_f32 v104, v104, v71, v72
    v_min3_f32 v105, v105, v71, v72
    v_max_f32 v104, v104, v73
    v_min_f32 v105, v105, v73
    v_mul_f32 v106, v104, v18
    v_mul_f32 v107, v105, v18
    v_mul_f32 v104, v104, v18
    v_mul_f32 v105, v105, v18
    s_nop 0
    v_permlane32_swap_b32 v104, v106
    v_permlane32_swap_b32 v105, v107
    v_max_f32 v104, v104, v106
    v_min_f32_e64 v105, v105, v107
    v_fma_f32 v88, v60, v18, -v104
    v_fma_f32 v60, -v60, v18, v105
    v_fma_f32 v89, v61, v18, -v104
    v_fma_f32 v61, -v61, v18, v105
    v_fma_f32 v90, v62, v18, -v104
    v_fma_f32 v62, -v62, v18, v105
    v_fma_f32 v91, v63, v18, -v104
    v_fma_f32 v63, -v63, v18, v105
    v_fma_f32 v92, v64, v18, -v104
    v_fma_f32 v64, -v64, v18, v105
    v_fma_f32 v93, v65, v18, -v104
    v_fma_f32 v65, -v65, v18, v105
    v_fma_f32 v94, v66, v18, -v104
    v_fma_f32 v66, -v66, v18, v105
    v_fma_f32 v95, v67, v18, -v104
    v_fma_f32 v67, -v67, v18, v105
    v_fma_f32 v96, v68, v18, -v104
    v_fma_f32 v68, -v68, v18, v105
    v_fma_f32 v97, v69, v18, -v104
    v_fma_f32 v69, -v69, v18, v105
    v_fma_f32 v98, v70, v18, -v104
    v_fma_f32 v70, -v70, v18, v105
    v_fma_f32 v99, v71, v18, -v104
    v_fma_f32 v71, -v71, v18, v105
    v_fma_f32 v100, v72, v18, -v104
    v_fma_f32 v72, -v72, v18, v105
    v_fma_f32 v101, v73, v18, -v104
    v_fma_f32 v73, -v73, v18, v105
    v_exp_f32 v88, v88
    v_exp_f32 v60, v60
    v_exp_f32 v89, v89
    v_exp_f32 v61, v61
    v_exp_f32 v90, v90
    v_exp_f32 v62, v62
    v_exp_f32 v91, v91
    v_exp_f32 v63, v63
    v_exp_f32 v92, v92
    v_exp_f32 v64, v64
    v_exp_f32 v93, v93
    v_exp_f32 v65, v65
    v_exp_f32 v94, v94
    v_exp_f32 v66, v66
    v_exp_f32 v95, v95
    v_exp_f32 v67, v67
    v_exp_f32 v96, v96
    v_exp_f32 v68, v68
    v_exp_f32 v97, v97
    v_exp_f32 v69, v69
    v_exp_f32 v98, v98
    v_exp_f32 v70, v70
    v_exp_f32 v99, v99
    v_exp_f32 v71, v71
    v_exp_f32 v100, v100
    v_exp_f32 v72, v72
    v_exp_f32 v101, v101
    v_exp_f32 v73, v73
    v_mov_b32 v167, 0
    v_mov_b32 v175, 0
    v_cvt_pk_bf16_f32 v160, v88, v89
    v_cvt_pk_bf16_f32 v161, v90, v91
    v_cvt_pk_bf16_f32 v162, v92, v93
    v_cvt_pk_bf16_f32 v163, v94, v95
    v_cvt_pk_bf16_f32 v164, v96, v97
    v_cvt_pk_bf16_f32 v165, v98, v99
    v_cvt_pk_bf16_f32 v166, v100, v101
    v_cvt_pk_bf16_f32 v168, v60, v61
    v_cvt_pk_bf16_f32 v169, v62, v63
    v_cvt_pk_bf16_f32 v170, v64, v65
    v_cvt_pk_bf16_f32 v171, v66, v67
    v_cvt_pk_bf16_f32 v172, v68, v69
    v_cvt_pk_bf16_f32 v173, v70, v71
    v_cvt_pk_bf16_f32 v174, v72, v73
    s_waitcnt vmcnt(0)
    s_barrier
    ds_read_b128 v[112:115], v11 offset:24576
    ds_read_b128 v[116:119], v11 offset:25600
    ds_read_b128 v[120:123], v11 offset:26624
    ds_read_b128 v[124:127], v11 offset:27648
    ds_read_b128 v[128:131], v11 offset:28672
    ds_read_b128 v[132:135], v11 offset:29696
    ds_read_b128 v[136:139], v11 offset:30720
    ds_read_b128 v[140:143], v11 offset:31744
    s_waitcnt lgkmcnt(4)
    v_mfma_f32_32x32x16_bf16 v[176:191], v[112:115], v[24:27], 0
    v_mfma_f32_32x32x16_bf16 v[192:207], v[120:123], v[32:35], 0
    v_mfma_f32_32x32x16_bf16 v[176:191], v[116:119], v[28:31], v[176:191]
    v_mfma_f32_32x32x16_bf16 v[192:207], v[124:127], v[36:39], v[192:207]
    s_waitcnt lgkmcnt(0)
    v_mfma_f32_32x32x16_bf16 v[208:223], v[128:131], v[40:43], 0
    v_mfma_f32_32x32x16_bf16 v[224:239], v[136:139], v[48:51], 0
    v_mfma_f32_32x32x16_bf16 v[208:223], v[132:135], v[44:47], v[208:223]
    v_mfma_f32_32x32x16_bf16 v[224:239], v[140:143], v[52:55], v[224:239]
    ds_read_b128 v[112:115], v11 offset:40960
    ds_read_b128 v[116:119], v11 offset:41984
    ds_read_b128 v[120:123], v11 offset:43008
    ds_read_b128 v[124:127], v11 offset:44032
    s_nop 1
    v_rcp_f32 v108, v191
    v_rcp_f32 v109, v207
    v_mov_b32 v247, 0
    v_fmaak_f32 v110, v108, v190, 0x358637bd
    v_fmac_f32 v110, v109, v206
    v_rcp_f32 v110, v110
    s_nop 0
    v_mul_f32 v108, v108, v110
    v_mul_f32 v109, v109, v110
    v_mul_f32 v176, v176, v108
    v_mul_f32 v177, v177, v108
    v_mul_f32 v178, v178, v108
    v_mul_f32 v179, v179, v108
    v_mul_f32 v180, v180, v108
    v_mul_f32 v181, v181, v108
    v_mul_f32 v182, v182, v108
    v_mul_f32 v183, v183, v108
    v_mul_f32 v184, v184, v108
    v_mul_f32 v185, v185, v108
    v_mul_f32 v186, v186, v108
    v_mul_f32 v187, v187, v108
    v_mul_f32 v188, v188, v108
    v_mul_f32 v189, v189, v108
    v_fmac_f32 v176, v192, v109
    v_fmac_f32 v177, v193, v109
    v_fmac_f32 v178, v194, v109
    v_fmac_f32 v179, v195, v109
    v_fmac_f32 v180, v196, v109
    v_fmac_f32 v181, v197, v109
    v_fmac_f32 v182, v198, v109
    v_fmac_f32 v183, v199, v109
    v_fmac_f32 v184, v200, v109
    v_fmac_f32 v185, v201, v109
    v_fmac_f32 v186, v202, v109
    v_fmac_f32 v187, v203, v109
    v_fmac_f32 v188, v204, v109
    v_fmac_f32_e64 v189, v205, v109
    v_cvt_pk_bf16_f32 v240, v176, v177
    v_cvt_pk_bf16_f32 v241, v178, v179
    v_cvt_pk_bf16_f32 v242, v180, v181
    v_cvt_pk_bf16_f32 v243, v182, v183
    v_cvt_pk_bf16_f32 v244, v184, v185
    v_cvt_pk_bf16_f32 v245, v186, v187
    v_cvt_pk_bf16_f32 v246, v188, v189
    buffer_store_dwordx4 v[240:243], v14, s[36:39], s48 offen offset:0 sc1
    buffer_store_dwordx4 v[244:247], v14, s[36:39], s48 offen offset:1024 sc1
    s_waitcnt lgkmcnt(0)
    s_nop 0
    v_mfma_f32_32x32x16_bf16 v[176:191], v[112:115], v[144:147], 0
    v_mfma_f32_32x32x16_bf16 v[192:207], v[120:123], v[152:155], 0
    v_mfma_f32_32x32x16_bf16 v[176:191], v[116:119], v[148:151], v[176:191]
    v_mfma_f32_32x32x16_bf16 v[192:207], v[124:127], v[156:159], v[192:207]
    ds_read_b128 v[128:131], v11 offset:45056
    ds_read_b128 v[132:135], v11 offset:46080
    ds_read_b128 v[136:139], v11 offset:47104
    ds_read_b128 v[140:143], v11 offset:48128
    v_rcp_f32 v108, v223
    v_rcp_f32 v109, v239
    v_mov_b32_e64 v255, 0
    v_fmaak_f32 v110, v108, v222, 0x358637bd
    v_fmac_f32 v110, v109, v238
    v_rcp_f32 v110, v110
    s_nop 0
    v_mul_f32 v108, v108, v110
    v_mul_f32 v109, v109, v110
    v_mul_f32 v208, v208, v108
    v_mul_f32 v209, v209, v108
    v_mul_f32 v210, v210, v108
    v_mul_f32 v211, v211, v108
    v_mul_f32 v212, v212, v108
    v_mul_f32 v213, v213, v108
    v_mul_f32 v214, v214, v108
    v_mul_f32 v215, v215, v108
    v_mul_f32 v216, v216, v108
    v_mul_f32 v217, v217, v108
    v_mul_f32 v218, v218, v108
    v_mul_f32 v219, v219, v108
    v_mul_f32 v220, v220, v108
    v_mul_f32 v221, v221, v108
    v_fmac_f32 v208, v224, v109
    v_fmac_f32 v209, v225, v109
    v_fmac_f32 v210, v226, v109
    v_fmac_f32 v211, v227, v109
    v_fmac_f32 v212, v228, v109
    v_fmac_f32 v213, v229, v109
    v_fmac_f32 v214, v230, v109
    v_fmac_f32 v215, v231, v109
    v_fmac_f32 v216, v232, v109
    v_fmac_f32 v217, v233, v109
    v_fmac_f32 v218, v234, v109
    v_fmac_f32 v219, v235, v109
    v_fmac_f32 v220, v236, v109
    v_fmac_f32_e64 v221, v237, v109
    v_cvt_pk_bf16_f32 v248, v208, v209
    v_cvt_pk_bf16_f32 v249, v210, v211
    v_cvt_pk_bf16_f32 v250, v212, v213
    v_cvt_pk_bf16_f32 v251, v214, v215
    v_cvt_pk_bf16_f32 v252, v216, v217
    v_cvt_pk_bf16_f32 v253, v218, v219
    v_cvt_pk_bf16_f32 v254, v220, v221
    buffer_store_dwordx4 v[248:251], v14, s[36:39], s48 offen offset:2048 sc1
    buffer_store_dwordx4 v[252:255], v14, s[36:39], s48 offen offset:3072 sc1
    s_waitcnt lgkmcnt(0)
    v_mfma_f32_32x32x16_bf16 v[208:223], v[128:131], v[160:163], 0
    v_mfma_f32_32x32x16_bf16 v[224:239], v[136:139], v[168:171], 0
    v_mfma_f32_32x32x16_bf16 v[208:223], v[132:135], v[164:167], v[208:223]
    v_mfma_f32_32x32x16_bf16 v[224:239], v[140:143], v[172:175], v[224:239]
    v_rcp_f32 v108, v191
    v_rcp_f32 v109, v207
    v_mov_b32 v247, 0
    v_fmaak_f32 v110, v108, v190, 0x358637bd
    v_fmac_f32 v110, v109, v206
    v_rcp_f32 v110, v110
    s_nop 0
    v_mul_f32 v108, v108, v110
    v_mul_f32 v109, v109, v110
    v_mul_f32 v176, v176, v108
    v_mul_f32 v177, v177, v108
    v_mul_f32 v178, v178, v108
    v_mul_f32 v179, v179, v108
    v_mul_f32 v180, v180, v108
    v_mul_f32 v181, v181, v108
    v_mul_f32 v182, v182, v108
    v_mul_f32 v183, v183, v108
    v_mul_f32 v184, v184, v108
    v_mul_f32 v185, v185, v108
    v_mul_f32 v186, v186, v108
    v_mul_f32 v187, v187, v108
    v_mul_f32 v188, v188, v108
    v_mul_f32 v189, v189, v108
    v_fmac_f32 v176, v192, v109
    v_fmac_f32 v177, v193, v109
    v_fmac_f32 v178, v194, v109
    v_fmac_f32 v179, v195, v109
    v_fmac_f32 v180, v196, v109
    v_fmac_f32 v181, v197, v109
    v_fmac_f32 v182, v198, v109
    v_fmac_f32 v183, v199, v109
    v_fmac_f32 v184, v200, v109
    v_fmac_f32 v185, v201, v109
    v_fmac_f32 v186, v202, v109
    v_fmac_f32 v187, v203, v109
    v_fmac_f32 v188, v204, v109
    v_fmac_f32_e64 v189, v205, v109
    v_cvt_pk_bf16_f32 v240, v176, v177
    v_cvt_pk_bf16_f32 v241, v178, v179
    v_cvt_pk_bf16_f32 v242, v180, v181
    v_cvt_pk_bf16_f32 v243, v182, v183
    v_cvt_pk_bf16_f32 v244, v184, v185
    v_cvt_pk_bf16_f32 v245, v186, v187
    v_cvt_pk_bf16_f32 v246, v188, v189
    buffer_store_dwordx4 v[240:243], v14, s[36:39], s49 offen offset:0 sc1
    buffer_store_dwordx4 v[244:247], v14, s[36:39], s49 offen offset:1024 sc1
    v_rcp_f32 v108, v223
    v_rcp_f32 v109, v239
    v_mov_b32_e64 v255, 0
    v_fmaak_f32 v110, v108, v222, 0x358637bd
    v_fmac_f32 v110, v109, v238
    v_rcp_f32 v110, v110
    s_nop 0
    v_mul_f32 v108, v108, v110
    v_mul_f32 v109, v109, v110
    v_mul_f32 v208, v208, v108
    v_mul_f32 v209, v209, v108
    v_mul_f32 v210, v210, v108
    v_mul_f32 v211, v211, v108
    v_mul_f32 v212, v212, v108
    v_mul_f32 v213, v213, v108
    v_mul_f32 v214, v214, v108
    v_mul_f32 v215, v215, v108
    v_mul_f32 v216, v216, v108
    v_mul_f32 v217, v217, v108
    v_mul_f32 v218, v218, v108
    v_mul_f32 v219, v219, v108
    v_mul_f32 v220, v220, v108
    v_mul_f32 v221, v221, v108
    v_fmac_f32 v208, v224, v109
    v_fmac_f32 v209, v225, v109
    v_fmac_f32 v210, v226, v109
    v_fmac_f32 v211, v227, v109
    v_fmac_f32 v212, v228, v109
    v_fmac_f32 v213, v229, v109
    v_fmac_f32 v214, v230, v109
    v_fmac_f32 v215, v231, v109
    v_fmac_f32 v216, v232, v109
    v_fmac_f32 v217, v233, v109
    v_fmac_f32 v218, v234, v109
    v_fmac_f32 v219, v235, v109
    v_fmac_f32 v220, v236, v109
    v_fmac_f32_e64 v221, v237, v109
    v_cvt_pk_bf16_f32 v248, v208, v209
    v_cvt_pk_bf16_f32 v249, v210, v211
    v_cvt_pk_bf16_f32 v250, v212, v213
    v_cvt_pk_bf16_f32 v251, v214, v215
    v_cvt_pk_bf16_f32 v252, v216, v217
    v_cvt_pk_bf16_f32 v253, v218, v219
    v_cvt_pk_bf16_f32 v254, v220, v221
    buffer_store_dwordx4 v[248:251], v14, s[36:39], s49 offen offset:2048 sc1
    buffer_store_dwordx4 v[252:255], v14, s[36:39], s49 offen offset:3072 sc1
    s_waitcnt vmcnt(4)
    v_mov_b32 v22, s44
    v_mov_b32 v23, s45
    s_mov_b64 exec, 1
    buffer_store_dwordx2 v[22:23], off, s[36:39], s77 sc1
    s_mov_b64 exec, -1
    s_waitcnt vmcnt(1)
    s_add_u32 s77, s77, 16
    v_mov_b32 v22, s44
    v_mov_b32 v23, s45
    s_mov_b64 exec, 1
    buffer_store_dwordx2 v[22:23], off, s[36:39], s77 sc1
    s_mov_b64 exec, -1
    s_endpgm
L_rare80:
    s_nop 1
    s_mov_b32 s79, 65536
L_vpl82:
    s_sleep 4
    buffer_load_dwordx4 v[84:87], v56, s[36:39], s96 offen sc1
    s_sub_u32 s79, s79, 1
    s_waitcnt vmcnt(0)
    s_cbranch_scc1 L_vpd83
    v_cmp_ne_u64 vcc, s[44:45], v[84:85]
    v_cmp_ne_u64 s[84:85], s[44:45], v[86:87]
    s_nop 0
    s_or_b64 vcc, vcc, s[84:85]
    s_cbranch_vccnz L_vpl82
L_vpd83:
    s_nop 1
    s_branch L_back81
L_rare89:
    s_nop 1
    s_mov_b32 s79, 65536
L_vpl91:
    s_sleep 4
    buffer_load_dwordx2 v[16:17], v4, s[36:39], s50 offen sc1
    s_sub_u32 s79, s79, 1
    s_waitcnt vmcnt(0)
    s_cbranch_scc1 L_vpd92
    v_cmp_ne_u64 vcc, s[44:45], v[16:17]
    s_nop 0
    s_cbranch_vccnz L_vpl91
L_vpd92:
    s_nop 1
    s_branch L_back90
L_rare95:
    s_nop 1
    s_mov_b32 s79, 65536
L_vpl97:
    s_sleep 4
    buffer_load_dwordx4 v[176:179], v180, s[36:39], s63 offen sc1
    s_sub_u32 s79, s79, 1
    s_waitcnt vmcnt(0)
    s_cbranch_scc1 L_vpd98
    v_cmp_ne_u64 vcc, s[44:45], v[176:177]
    v_cmp_ne_u64 s[84:85], s[44:45], v[178:179]
    s_nop 0
    s_or_b64 vcc, vcc, s[84:85]
    s_cbranch_vccnz L_vpl97
L_vpd98:
    s_nop 1
    s_branch L_back96
L_end:
    s_endpgm
.section .rodata,"a"
.p2align 6
.amdhsa_kernel recurrent_scan__linear_kernel_hedgehog__glu_gated_geglu__prompt_kernel
  .amdhsa_next_free_vgpr 256
  .amdhsa_next_free_sgpr 102
  .amdhsa_accum_offset 256
  .amdhsa_group_segment_fixed_size 0
  .amdhsa_kernarg_size 88
  .amdhsa_user_sgpr_count 2
  .amdhsa_user_sgpr_kernarg_segment_ptr 1
  .amdhsa_system_sgpr_workgroup_id_x 1
.end_amdhsa_kernel
```
